```python
import torch

def _softmax(x, axis=-1):
    return torch.softmax(x, dim=axis)
def _gelu(x):
    return torch.nn.functional.gelu(x, approximate="tanh")
def _silu(x):
    return torch.nn.functional.silu(x)
def _sigmoid(x):
    return torch.sigmoid(x)
def _layernorm(x, axis=-1, eps=1e-5):
    m = x.mean(dim=axis, keepdim=True)
    v = x.var(dim=axis, keepdim=True, unbiased=False)
    return (x - m) / torch.sqrt(v + eps)
def _scatter_add(tgt, idx, src, axis=0):
    return tgt.clone().index_add_(axis, idx, src)
def _segment_sum(src, seg, n):
    out = torch.zeros((n,) + src.shape[1:], dtype=src.dtype)
    return out.index_add_(0, seg, src)
def _pad(x, pw):
    flat = tuple(v for pair in reversed(pw) for v in pair)
    return torch.nn.functional.pad(x, flat)

kernel_name = 'parallel_sum__linear_attn_block__mixer_s_mlp__prompt'

def setup_inputs():

    _w = (lambda a: (lambda t: t.to(torch.bfloat16) if t.is_floating_point() else t)(torch.as_tensor(a)))
    def _A_setup():
        B, S, D = 1, 2048, 640
        return {
            "x": _w((lambda *s: torch.randn(*s, dtype=torch.bfloat16) * 0.05)(B, S, D)),
            "wqkv": _w((lambda *s: torch.randn(*s, dtype=torch.bfloat16) * 0.2)(D, 3 * D)),
            "wo": _w((lambda *s: torch.randn(*s, dtype=torch.bfloat16) * 0.1)(D, D)),
        }
    _A_in = _A_setup()

    def _B_setup():
        B, S, D, F = 1, 2048, 640, 1536
        return {
            "x":  _w((lambda *s: torch.randn(*s, dtype=torch.bfloat16) * 0.05)(B, S, D)),
            "w1": _w((lambda *s: torch.randn(*s, dtype=torch.bfloat16) * 0.8)(D, D) * (D ** -0.5)),
            "w2": _w((lambda *s: torch.randn(*s, dtype=torch.bfloat16) * 0.8)(D, D) * (D ** -0.5)),
            "w3": _w((lambda *s: torch.randn(*s, dtype=torch.bfloat16) * 0.8)(D, F) * (D ** -0.5)),
            "w4": _w((lambda *s: torch.randn(*s, dtype=torch.bfloat16) * 0.8)(F, D) * (F ** -0.5)),
        }
    _B_in = _B_setup()

    return {
        "A_x": _A_in["x"],
        "A_wqkv": _A_in["wqkv"],
        "A_wo": _A_in["wo"],
        "B_x": _B_in["x"],
        "B_w1": _B_in["w1"],
        "B_w2": _B_in["w2"],
        "B_w3": _B_in["w3"],
        "B_w4": _B_in["w4"],
    }

def reference(A_x, A_wqkv, A_wo, B_x, B_w1, B_w2, B_w3, B_w4):
    def _A_ref(x, wqkv, wo):
        B, S, D = x.shape
        H = 32; Dh = D // H
        qkv = (lambda x, *d: x.permute(*d))((x @ wqkv).reshape(B, S, 3, H, Dh), 2, 0, 3, 1, 4)
        q, k, v = qkv[0], qkv[1], qkv[2]
        phi = lambda t: torch.where(t > 0, t + 1, torch.exp(t)) + 1e-6
        pq, pk = phi(q), phi(k)
        kv = torch.einsum("bhsd,bhse->bhde", pk, v)
        z = torch.einsum("bhsd->bhd", pk)
        num = torch.einsum("bhqd,bhde->bhqe", pq, kv)
        den = torch.einsum("bhqd,bhd->bhq", pq, z)[..., None] + 1e-6
        o = num / den
        return (lambda x, *d: x.permute(*d))(o, 0, 2, 1, 3).reshape(B, S, D) @ wo

    def _B_ref(x, w1, w2, w3, w4):
        B, S, D = x.shape
        h = _gelu(_layernorm(x, axis=-1) @ w1)
        c = D // 4
        g0 = _pad(h[:, :, 0*c:1*c], ((0, 0), (1, 0), (0, 0)))[:, :S, :]
        g1 = _pad(h[:, :, 1*c:2*c], ((0, 0), (0, 1), (0, 0)))[:, 1:, :]
        g2 = _pad(h[:, :, 2*c:3*c], ((0, 0), (2, 0), (0, 0)))[:, :S, :]
        g3 = _pad(h[:, :, 3*c:   ], ((0, 0), (0, 2), (0, 0)))[:, 2:, :]
        hs = torch.concatenate([g0, g1, g2, g3], axis=-1) @ w2
        x1 = x + hs
        h2 = _gelu(_layernorm(x1, axis=-1) @ w3) @ w4
        return x1 + h2

    x = A_x
    xn = _layernorm(x, axis=-1)
    return x + _A_ref(xn, A_wqkv, A_wo) + _B_ref(xn, B_w1, B_w2, B_w3, B_w4)
```

```asm
; @launch grid=(256,1,1) block=(256,1,1) lds=163840
.amdgcn_target "amdgcn-amd-amdhsa--gfx950"
.text
.globl parallel_sum__linear_attn_block__mixer_s_mlp__prompt_kernel
.p2align 8
.type parallel_sum__linear_attn_block__mixer_s_mlp__prompt_kernel,@function
parallel_sum__linear_attn_block__mixer_s_mlp__prompt_kernel:
s_cmp_ge_u32 s2, 256
s_cbranch_scc1 L_end
s_load_dwordx16 s[16:31], s[0:1], 0
s_load_dwordx4 s[32:35], s[0:1], 64
s_load_dwordx2 s[36:37], s[0:1], 80
s_memrealtime s[8:9]
s_getpc_b64 s[12:13]
L_pc:
s_lshr_b32 s6, s2, 3
s_and_b32 s7, s6, 7
s_lshl_b32 s7, s7, 13
v_lshrrev_b32 v4, 2, v0
v_lshl_add_u32 v4, v4, 7, s7
v_min_u32 v4, L_end-L_pc, v4
global_load_dword a99, v4, s[12:13]
v_lshrrev_b32 v4, 6, v0
v_and_b32 v1, 63, v0
v_readfirstlane_b32 s3, v4
s_and_b32 s4, s2, 1
s_bfe_u32 s5, s2, 0x20001
v_lshrrev_b32 v2, 5, v1
v_and_b32 v3, 31, v1
s_mov_b32 s67, 0x3f803f80
v_lshrrev_b32 v248, 3, v1
v_mul_u32_u24 v248, 1280, v248
v_lshrrev_b32 v249, 4, v1
v_and_b32 v250, 7, v1
v_xor_b32 v251, v249, v250
v_lshl_add_u32 v4, v251, 4, v248
s_cmp_ge_u32 s6, 20
s_cbranch_scc1 L_kv
s_mul_i32 s11, s6, 52
s_lshr_b32 s11, s11, 8
s_mul_i32 s12, s11, 5
s_sub_u32 s12, s6, s12
s_lshl_b32 s60, s5, 2
s_add_u32 s60, s60, s11
s_mul_i32 s61, s4, 5
s_add_u32 s61, s61, s12
s_add_u32 s63, s61, s4
s_lshl_b32 s64, s12, 1
s_mul_i32 s11, s11, 3
s_add_u32 s64, s64, s11
s_lshl_b32 s62, s60, 2
s_add_u32 s62, s62, s3
s_cmp_ge_u32 s64, 10
s_cselect_b32 s11, 10, 0
s_sub_u32 s64, s64, s11
s_mul_i32 s68, s62, 40960
s_lshl_b32 s69, s61, 7
v_add_u32 v4, s68, v4
v_xor_b32 v5, 64, v4
v_add_u32 v6, 18432, v4
v_add_u32 v7, 27648, v5
v_add_u32 v5, 9216, v5
v_and_b32 v249, 1, v249
v_lshlrev_b32 v249, 2, v249
v_xor_b32 v249, v249, v250
v_lshl_add_u32 v20, v249, 4, v248
s_mul_i32 s12, s3, 20480
s_add_u32 s65, s12, 81920
s_add_u32 s12, s12, s69
v_add_u32 v20, s12, v20
v_add_u32 v21, 9216, v20
s_lshl_b32 s7, s3, 11
s_lshl_b32 s71, s64, 7
s_mov_b32 s70, s71
s_mov_b32 s83, s69
s_add_u32 s71, s71, 128
s_cmp_eq_u32 s71, 1280
s_cselect_b32 s71, 0, s71
s_cmp_eq_u32 s71, s69
s_cselect_b32 s84, s70, s71
s_add_u32 s71, s71, 128
s_cmp_eq_u32 s71, 1280
s_cselect_b32 s71, 0, s71
s_cmp_eq_u32 s71, s69
s_cselect_b32 s85, s70, s71
s_waitcnt lgkmcnt(0)
s_mov_b32 s40, s16
s_mov_b32 s41, s17
s_mov_b32 s42, 2621440
s_mov_b32 s43, 0x20000
s_mov_b32 s44, s24
s_mov_b32 s45, s25
s_mov_b32 s46, 819200
s_mov_b32 s47, 0x20000
s_add_u32 m0, s65, 0
s_mul_i32 s15, s83, 640
buffer_load_dwordx4 v4, s[40:43], s83 offen offset:0 lds
buffer_load_dwordx4 v5, s[40:43], s83 offen offset:1024 lds
buffer_load_dwordx4 v6, s[40:43], s83 offen offset:2048 lds
buffer_load_dwordx4 v7, s[40:43], s83 offen offset:3072 lds
s_add_u32 m0, s7, 0
s_nop 0
buffer_load_dwordx4 v20, s[44:47], s15 offen offset:0 lds
buffer_load_dwordx4 v21, s[44:47], s15 offen offset:1024 lds
s_add_u32 m0, s65, 4096
s_mul_i32 s15, s84, 640
buffer_load_dwordx4 v4, s[40:43], s84 offen offset:0 lds
buffer_load_dwordx4 v5, s[40:43], s84 offen offset:1024 lds
buffer_load_dwordx4 v6, s[40:43], s84 offen offset:2048 lds
buffer_load_dwordx4 v7, s[40:43], s84 offen offset:3072 lds
s_add_u32 m0, s7, 8192
s_nop 0
buffer_load_dwordx4 v20, s[44:47], s15 offen offset:0 lds
buffer_load_dwordx4 v21, s[44:47], s15 offen offset:1024 lds
s_mov_b32 s48, s36
s_mov_b32 s49, s37
s_mov_b32 s50, 23068672
s_mov_b32 s51, 0x20000
s_mov_b32 s56, s34
s_mov_b32 s57, s35
s_mov_b32 s58, 256
s_mov_b32 s59, 0x20000
s_or_b32 s11, s2, s3
s_cmp_lg_u32 s11, 0
s_cbranch_scc1 L_nononce
s_or_b32 s8, s8, 1
v_mov_b32 v248, s8
v_mov_b32 v249, s9
v_mov_b32 v250, 0
s_mov_b64 exec, 1
buffer_store_dwordx2 v[248:249], v250, s[56:59], 0 offen sc1
s_mov_b64 exec, -1
L_nononce:
s_add_u32 s71, s71, 128
s_cmp_eq_u32 s71, 1280
s_cselect_b32 s71, 0, s71
s_cmp_eq_u32 s71, s69
s_cselect_b32 s86, s70, s71
s_add_u32 s71, s71, 128
s_cmp_eq_u32 s71, 1280
s_cselect_b32 s71, 0, s71
s_cmp_eq_u32 s71, s69
s_cselect_b32 s87, s70, s71
s_add_u32 s71, s71, 128
s_cmp_eq_u32 s71, 1280
s_cselect_b32 s71, 0, s71
s_cmp_eq_u32 s71, s69
s_cselect_b32 s88, s70, s71
s_add_u32 s71, s71, 128
s_cmp_eq_u32 s71, 1280
s_cselect_b32 s71, 0, s71
s_cmp_eq_u32 s71, s69
s_cselect_b32 s89, s70, s71
s_add_u32 s71, s71, 128
s_cmp_eq_u32 s71, 1280
s_cselect_b32 s71, 0, s71
s_cmp_eq_u32 s71, s69
s_cselect_b32 s90, s70, s71
s_add_u32 s71, s71, 128
s_cmp_eq_u32 s71, 1280
s_cselect_b32 s71, 0, s71
s_cmp_eq_u32 s71, s69
s_cselect_b32 s91, s70, s71
s_add_u32 s71, s71, 128
s_cmp_eq_u32 s71, 1280
s_cselect_b32 s71, 0, s71
s_cmp_eq_u32 s71, s69
s_cselect_b32 s92, s70, s71
v_lshrrev_b32 v248, 1, v3
v_and_b32 v248, 7, v248
v_xor_b32 v249, v248, v2
v_lshlrev_b32 v249, 4, v249
v_lshl_add_u32 v249, v3, 7, v249
v_add_u32 v8, s65, v249
v_xor_b32 v9, 32, v8
v_xor_b32 v10, 64, v8
v_xor_b32 v11, 96, v8
v_lshlrev_b32 v248, 4, v248
v_lshl_add_u32 v248, v3, 7, v248
v_lshl_add_u32 v248, v2, 3, v248
v_add_u32 v32, s65, v248
v_xor_b32 v33, 16, v32
v_xor_b32 v34, 32, v32
v_xor_b32 v35, 48, v32
v_xor_b32 v36, 64, v32
v_xor_b32 v37, 80, v32
v_xor_b32 v38, 96, v32
v_xor_b32 v39, 112, v32
v_and_b32 v248, 15, v1
v_lshrrev_b32 v249, 2, v248
v_and_b32 v248, 3, v248
v_lshlrev_b32 v248, 3, v248
v_and_b32 v250, 16, v1
v_lshl_add_u32 v248, v250, 1, v248
v_mad_u32_u24 v250, v2, 8, v249
v_lshl_add_u32 v248, v250, 7, v248
v_lshrrev_b32 v249, 1, v249
v_lshl_add_u32 v248, v249, 6, v248
v_add_u32 v16, 0, v248
v_xor_b32 v17, 64, v16
v_add_u32 v18, 65536, v16
v_add_u32 v19, 65536, v17
v_add_u32 v28, s7, v16
v_add_u32 v29, s7, v17
v_add_u32 v30, s7, v18
v_add_u32 v31, s7, v19
v_lshrrev_b32 v248, 2, v1
v_lshrrev_b32 v249, 4, v1
v_xor_b32 v248, v248, v249
v_and_b32 v248, 1, v248
v_add_u32 v248, -1, v248
v_and_b32 v248, 0x3f803f80, v248
v_accvgpr_write_b32 a128, v248
v_accvgpr_write_b32 a129, v248
v_accvgpr_write_b32 a130, v248
v_accvgpr_write_b32 a131, v248
s_mov_b32 s52, s18
s_mov_b32 s53, s19
s_mov_b32 s54, 2457600
s_mov_b32 s55, 0x20000
v_lshrrev_b32 v248, 3, v1
v_mul_u32_u24 v248, 3840, v248
v_lshrrev_b32 v249, 2, v1
v_and_b32 v249, 4, v249
v_and_b32 v250, 7, v1
v_xor_b32 v249, v249, v250
v_lshl_add_u32 v12, v249, 4, v248
v_add_u32 v13, 29696, v12
v_add_u32 v14, 59392, v12
v_add_u32 v15, 89088, v12
s_mul_i32 s11, s3, 160
s_lshl_b32 s66, s11, 7
s_lshl_b32 s12, s64, 6
s_add_u32 s12, s12, s11
s_add_u32 s73, s12, 0
s_cmp_ge_u32 s73, 640
s_cselect_b32 s13, 640, 0
s_sub_u32 s73, s73, s13
s_add_u32 s74, s12, 32
s_cmp_ge_u32 s74, 640
s_cselect_b32 s13, 640, 0
s_sub_u32 s74, s74, s13
s_add_u32 s75, s12, 64
s_cmp_ge_u32 s75, 640
s_cselect_b32 s13, 640, 0
s_sub_u32 s75, s75, s13
s_add_u32 s76, s12, 96
s_cmp_ge_u32 s76, 640
s_cselect_b32 s13, 640, 0
s_sub_u32 s76, s76, s13
s_add_u32 s77, s12, 128
s_cmp_ge_u32 s77, 640
s_cselect_b32 s13, 640, 0
s_sub_u32 s77, s77, s13
s_lshr_b32 s11, s73, 6
s_and_b32 s12, s73, 63
s_cmp_eq_u32 s11, s61
s_cselect_b32 s13, s64, s11
s_cmp_eq_u32 s11, s64
s_cselect_b32 s13, s61, s13
s_lshl_b32 s13, s13, 6
s_add_u32 s13, s13, s12
s_mul_i32 s78, s13, 3840
s_add_u32 s78, s78, s69
s_mov_b32 s73, s13
s_lshr_b32 s11, s74, 6
s_and_b32 s12, s74, 63
s_cmp_eq_u32 s11, s61
s_cselect_b32 s13, s64, s11
s_cmp_eq_u32 s11, s64
s_cselect_b32 s13, s61, s13
s_lshl_b32 s13, s13, 6
s_add_u32 s13, s13, s12
s_mul_i32 s79, s13, 3840
s_add_u32 s79, s79, s69
s_mov_b32 s74, s13
s_lshr_b32 s11, s75, 6
s_and_b32 s12, s75, 63
s_cmp_eq_u32 s11, s61
s_cselect_b32 s13, s64, s11
s_cmp_eq_u32 s11, s64
s_cselect_b32 s13, s61, s13
s_lshl_b32 s13, s13, 6
s_add_u32 s13, s13, s12
s_mul_i32 s80, s13, 3840
s_add_u32 s80, s80, s69
s_mov_b32 s75, s13
s_lshr_b32 s11, s76, 6
s_and_b32 s12, s76, 63
s_cmp_eq_u32 s11, s61
s_cselect_b32 s13, s64, s11
s_cmp_eq_u32 s11, s64
s_cselect_b32 s13, s61, s13
s_lshl_b32 s13, s13, 6
s_add_u32 s13, s13, s12
s_mul_i32 s81, s13, 3840
s_add_u32 s81, s81, s69
s_mov_b32 s76, s13
s_lshr_b32 s11, s77, 6
s_and_b32 s12, s77, 63
s_cmp_eq_u32 s11, s61
s_cselect_b32 s13, s64, s11
s_cmp_eq_u32 s11, s64
s_cselect_b32 s13, s61, s13
s_lshl_b32 s13, s13, 6
s_add_u32 s13, s13, s12
s_mul_i32 s82, s13, 3840
s_add_u32 s82, s82, s69
s_mov_b32 s77, s13
s_mul_i32 s73, s73, 1280
s_add_u32 s73, s73, s69
s_mul_i32 s74, s74, 1280
s_add_u32 s74, s74, s69
s_mul_i32 s75, s75, 1280
s_add_u32 s75, s75, s69
s_mul_i32 s76, s76, 1280
s_add_u32 s76, s76, s69
s_mul_i32 s77, s77, 1280
s_add_u32 s77, s77, s69
s_lshl_b32 s14, s63, 8
s_lshl_b32 s11, s3, 5
s_lshl_b32 s12, s64, 6
s_add_u32 s12, s12, s11
s_add_u32 s11, s12, 0
s_cmp_ge_u32 s11, 640
s_cselect_b32 s13, 640, 0
s_sub_u32 s11, s11, s13
s_lshr_b32 s13, s11, 6
s_and_b32 s11, s11, 63
s_cmp_eq_u32 s13, s61
s_cselect_b32 s36, s64, s13
s_cmp_eq_u32 s13, s64
s_cselect_b32 s13, s61, s36
s_lshl_b32 s13, s13, 6
s_add_u32 s11, s11, s13
s_mul_i32 s11, s11, 3072
s_add_u32 s36, s11, s14
s_add_u32 s11, s12, 128
s_cmp_ge_u32 s11, 640
s_cselect_b32 s13, 640, 0
s_sub_u32 s11, s11, s13
s_lshr_b32 s13, s11, 6
s_and_b32 s11, s11, 63
s_cmp_eq_u32 s13, s61
s_cselect_b32 s37, s64, s13
s_cmp_eq_u32 s13, s64
s_cselect_b32 s13, s61, s37
s_lshl_b32 s13, s13, 6
s_add_u32 s11, s11, s13
s_mul_i32 s11, s11, 3072
s_add_u32 s37, s11, s14
s_add_u32 s11, s12, 256
s_cmp_ge_u32 s11, 640
s_cselect_b32 s13, 640, 0
s_sub_u32 s11, s11, s13
s_lshr_b32 s13, s11, 6
s_and_b32 s11, s11, 63
s_cmp_eq_u32 s13, s61
s_cselect_b32 s38, s64, s13
s_cmp_eq_u32 s13, s64
s_cselect_b32 s13, s61, s38
s_lshl_b32 s13, s13, 6
s_add_u32 s11, s11, s13
s_mul_i32 s11, s11, 3072
s_add_u32 s38, s11, s14
s_add_u32 s11, s12, 384
s_cmp_ge_u32 s11, 640
s_cselect_b32 s13, 640, 0
s_sub_u32 s11, s11, s13
s_lshr_b32 s13, s11, 6
s_and_b32 s11, s11, 63
s_cmp_eq_u32 s13, s61
s_cselect_b32 s39, s64, s13
s_cmp_eq_u32 s13, s64
s_cselect_b32 s13, s61, s39
s_lshl_b32 s13, s13, 6
s_add_u32 s11, s11, s13
s_mul_i32 s11, s11, 3072
s_add_u32 s39, s11, s14
s_add_u32 s11, s12, 512
s_cmp_ge_u32 s11, 640
s_cselect_b32 s13, 640, 0
s_sub_u32 s11, s11, s13
s_lshr_b32 s13, s11, 6
s_and_b32 s11, s11, 63
s_cmp_eq_u32 s13, s61
s_cselect_b32 s93, s64, s13
s_cmp_eq_u32 s13, s64
s_cselect_b32 s13, s61, s93
s_lshl_b32 s13, s13, 6
s_add_u32 s11, s11, s13
s_mul_i32 s11, s11, 3072
s_add_u32 s93, s11, s14
s_lshr_b32 s13, s6, 2
s_lshl_b32 s25, s5, 3
s_add_u32 s25, s25, s13
s_and_b32 s11, s6, 3
s_lshl_b32 s24, s4, 2
s_add_u32 s24, s24, s11
s_mul_i32 s22, s3, 491520
s_add_u32 s22, s22, 16777216
s_mul_i32 s31, s3, 204800
s_add_u32 s31, s31, 18743296
s_mul_i32 s65, s3, 20480
s_add_u32 s65, s65, 81920
s_mul_i32 s11, s11, 3
s_add_u32 s11, s11, 1
s_lshr_b32 s11, s11, 1
s_add_u32 s11, s11, s13
s_mul_i32 s12, s11, 52
s_lshr_b32 s12, s12, 8
s_mul_i32 s12, s12, 5
s_sub_u32 s30, s11, s12
s_mul_i32 s12, s11, 43
s_lshr_b32 s12, s12, 8
s_mul_i32 s12, s12, 6
s_sub_u32 s11, s11, s12
s_and_b32 s12, s11, 6
s_add_u32 s12, s12, s11
s_lshl_b32 s0, s12, 11
s_add_u32 s11, s11, 1
s_cmp_eq_u32 s11, 6
s_cselect_b32 s11, 0, s11
s_and_b32 s12, s11, 6
s_add_u32 s12, s12, s11
s_lshl_b32 s1, s12, 11
s_add_u32 s11, s11, 1
s_cmp_eq_u32 s11, 6
s_cselect_b32 s11, 0, s11
s_and_b32 s12, s11, 6
s_add_u32 s12, s12, s11
s_lshl_b32 s18, s12, 11
s_add_u32 s11, s11, 1
s_cmp_eq_u32 s11, 6
s_cselect_b32 s11, 0, s11
s_and_b32 s12, s11, 6
s_add_u32 s12, s12, s11
s_lshl_b32 s19, s12, 11
s_add_u32 s11, s11, 1
s_cmp_eq_u32 s11, 6
s_cselect_b32 s11, 0, s11
s_and_b32 s12, s11, 6
s_add_u32 s12, s12, s11
s_lshl_b32 s20, s12, 11
s_add_u32 s11, s11, 1
s_cmp_eq_u32 s11, 6
s_cselect_b32 s11, 0, s11
s_and_b32 s12, s11, 6
s_add_u32 s12, s12, s11
s_lshl_b32 s21, s12, 11
s_lshl_b32 s11, s61, 1
s_add_u32 s11, s11, 0
s_mul_i32 s12, s11, 52
s_lshr_b32 s12, s12, 8
s_lshr_b32 s13, s12, 1
s_add_u32 s13, s13, 1
s_sub_u32 s14, 0, s13
s_bitcmp1_b32 s12, 0
s_cselect_b32 s13, s14, s13
s_lshl_b32 s12, s62, 5
s_add_u32 s12, s12, s13
v_add_u32 v248, s12, v3
v_cmp_gt_u32 vcc, 2048, v248
v_and_b32 v248, 2047, v248
v_lshrrev_b32 v249, 5, v248
s_mov_b64 s[94:95], vcc
v_and_b32 v248, 31, v248
v_mul_u32_u24 v249, 40960, v249
v_lshl_add_u32 v248, v2, 5, v248
v_lshl_add_u32 v22, v248, 4, v249
s_lshl_b32 s98, s11, 11
s_lshl_b32 s11, s61, 1
s_add_u32 s11, s11, 1
s_mul_i32 s12, s11, 52
s_lshr_b32 s12, s12, 8
s_lshr_b32 s13, s12, 1
s_add_u32 s13, s13, 1
s_sub_u32 s14, 0, s13
s_bitcmp1_b32 s12, 0
s_cselect_b32 s13, s14, s13
s_lshl_b32 s12, s62, 5
s_add_u32 s12, s12, s13
v_add_u32 v248, s12, v3
v_cmp_gt_u32 vcc, 2048, v248
v_and_b32 v248, 2047, v248
v_lshrrev_b32 v249, 5, v248
s_mov_b64 s[96:97], vcc
v_and_b32 v248, 31, v248
v_mul_u32_u24 v249, 40960, v249
v_lshl_add_u32 v248, v2, 5, v248
v_lshl_add_u32 v23, v248, 4, v249
s_lshl_b32 s99, s11, 11
s_lshl_b32 s11, s3, 2
v_lshl_add_u32 v24, v1, 4, s11
v_lshlrev_b32 v25, 4, v1
s_add_u32 m0, s65, 8192
s_mul_i32 s15, s85, 640
buffer_load_dwordx4 v4, s[40:43], s85 offen offset:0 lds
buffer_load_dwordx4 v5, s[40:43], s85 offen offset:1024 lds
buffer_load_dwordx4 v6, s[40:43], s85 offen offset:2048 lds
buffer_load_dwordx4 v7, s[40:43], s85 offen offset:3072 lds
s_add_u32 m0, s7, 16384
s_nop 0
buffer_load_dwordx4 v20, s[44:47], s15 offen offset:0 lds
buffer_load_dwordx4 v21, s[44:47], s15 offen offset:1024 lds
s_lshl_b32 s11, s62, 12
s_lshl_b32 s12, s61, 8
s_add_u32 s72, s11, s12
s_add_u32 s72, s72, 22151168
s_lshl_b32 s12, s63, 8
s_add_u32 s11, s11, s12
s_add_u32 s11, s11, 22413312
v_and_b32 v248, 31, v1
v_lshlrev_b32 v248, 3, v248
s_sub_u32 s14, s11, s72
v_mul_lo_u32 v249, v2, s14
v_mov_b64 v[250:251], 0
v_add_u32 v248, v248, v249
s_waitcnt vmcnt(12)
s_barrier
ds_read_b64 a[100:101], v32
ds_read_b64 a[102:103], v33
ds_read_b64 a[104:105], v34
ds_read_b64 a[106:107], v35
ds_read_b64 a[108:109], v36
ds_read_b64 a[110:111], v37
ds_read_b64 a[112:113], v38
ds_read_b64 a[114:115], v39
ds_read_b128 v[64:67], v8 offset:0
ds_read_b64_tr_b16 v[224:225], v16 offset:0
ds_read_b64_tr_b16 v[226:227], v16 offset:512
ds_read_b64_tr_b16 v[228:229], v17 offset:0
ds_read_b64_tr_b16 v[230:231], v17 offset:512
ds_read_b128 v[68:71], v9 offset:0
ds_read_b64_tr_b16 v[232:233], v16 offset:2048
ds_read_b64_tr_b16 v[234:235], v16 offset:2560
ds_read_b64_tr_b16 v[236:237], v17 offset:2048
ds_read_b64_tr_b16 v[238:239], v17 offset:2560
s_waitcnt lgkmcnt(5)
v_mfma_f32_16x16x32_bf16 a[124:127], a[128:131], v[64:67], 0
v_mfma_f32_32x32x16_bf16 v[32:47], v[224:227], v[64:67], 0
ds_read_b64_tr_b16 a[132:133], v28 offset:0
ds_read_b64_tr_b16 a[134:135], v28 offset:512
ds_read_b128 v[72:75], v10 offset:0
ds_read_b64_tr_b16 v[240:241], v16 offset:4096
ds_read_b64_tr_b16 v[242:243], v16 offset:4608
s_add_u32 m0, s65, 12288
s_mul_i32 s15, s86, 640
buffer_load_dwordx4 v4, s[40:43], s86 offen offset:0 lds
v_mfma_f32_32x32x16_bf16 v[48:63], v[228:231], v[64:67], 0
ds_read_b64_tr_b16 a[136:137], v29 offset:0
ds_read_b64_tr_b16 a[138:139], v29 offset:512
ds_read_b64_tr_b16 v[244:245], v17 offset:4096
ds_read_b64_tr_b16 v[246:247], v17 offset:4608
buffer_load_dwordx4 v5, s[40:43], s86 offen offset:1024 lds
s_waitcnt lgkmcnt(9)
v_mfma_f32_16x16x32_bf16 a[124:127], a[128:131], v[68:71], a[124:127]
v_mfma_f32_32x32x16_bf16 v[32:47], v[232:235], v[68:71], v[32:47]
ds_read_b128 v[76:79], v11 offset:0
ds_read_b64_tr_b16 v[224:225], v16 offset:6144
ds_read_b64_tr_b16 v[226:227], v16 offset:6656
v_mfma_f32_32x32x16_bf16 v[48:63], v[236:239], v[68:71], v[48:63]
ds_read_b64_tr_b16 v[228:229], v17 offset:6144
ds_read_b64_tr_b16 v[230:231], v17 offset:6656
buffer_load_dwordx4 v6, s[40:43], s86 offen offset:2048 lds
s_waitcnt vmcnt(9) lgkmcnt(5)
s_barrier
v_mfma_f32_16x16x32_bf16 a[124:127], a[128:131], v[72:75], a[124:127]
v_mfma_f32_16x16x32_bf16 a[116:119], a[128:131], a[132:135], 0
v_mfma_f32_16x16x32_bf16 a[120:123], a[128:131], a[136:139], 0
v_mfma_f32_32x32x16_bf16 v[32:47], v[240:243], v[72:75], v[32:47]
ds_read_b128 v[80:83], v8 offset:4096
ds_read_b64_tr_b16 v[232:233], v16 offset:8192
ds_read_b64_tr_b16 v[234:235], v16 offset:8704
buffer_load_dwordx4 v7, s[40:43], s86 offen offset:3072 lds
s_add_u32 m0, s7, 24576
v_mfma_f32_32x32x16_bf16 v[48:63], v[244:247], v[72:75], v[48:63]
ds_read_b64_tr_b16 v[236:237], v17 offset:8192
ds_read_b64_tr_b16 v[238:239], v17 offset:8704
s_waitcnt lgkmcnt(5)
v_mfma_f32_16x16x32_bf16 a[124:127], a[128:131], v[76:79], a[124:127]
v_mfma_f32_32x32x16_bf16 v[32:47], v[224:227], v[76:79], v[32:47]
ds_read_b128 v[84:87], v9 offset:4096
ds_read_b64_tr_b16 v[240:241], v16 offset:10240
ds_read_b64_tr_b16 v[242:243], v16 offset:10752
buffer_load_dwordx4 v20, s[44:47], s15 offen offset:0 lds
v_mfma_f32_32x32x16_bf16 v[48:63], v[228:231], v[76:79], v[48:63]
ds_read_b64_tr_b16 v[244:245], v17 offset:10240
ds_read_b64_tr_b16 v[246:247], v17 offset:10752
s_waitcnt lgkmcnt(5)
v_mfma_f32_4x4x4_16b_bf16 a[140:143], v[64:65], v[64:65], 0
buffer_load_dwordx4 v21, s[44:47], s15 offen offset:1024 lds
v_mfma_f32_4x4x4_16b_bf16 a[144:147], v[66:67], v[66:67], 0
v_mfma_f32_4x4x4_16b_bf16 a[148:151], v[68:69], v[68:69], 0
v_mfma_f32_4x4x4_16b_bf16 a[152:155], v[70:71], v[70:71], 0
v_mfma_f32_4x4x4_16b_bf16 a[140:143], v[72:73], v[72:73], a[140:143]
v_mfma_f32_4x4x4_16b_bf16 a[144:147], v[74:75], v[74:75], a[144:147]
v_mfma_f32_4x4x4_16b_bf16 a[148:151], v[76:77], v[76:77], a[148:151]
v_mfma_f32_4x4x4_16b_bf16 a[152:155], v[78:79], v[78:79], a[152:155]
v_mfma_f32_16x16x32_bf16 a[124:127], a[128:131], v[80:83], a[124:127]
v_mfma_f32_32x32x16_bf16 v[32:47], v[232:235], v[80:83], v[32:47]
ds_read_b64_tr_b16 a[132:133], v28 offset:8192
ds_read_b64_tr_b16 a[134:135], v28 offset:8704
ds_read_b128 v[88:91], v10 offset:4096
ds_read_b64_tr_b16 v[224:225], v16 offset:12288
ds_read_b64_tr_b16 v[226:227], v16 offset:12800
s_add_u32 m0, s65, 0
s_mul_i32 s15, s87, 640
buffer_load_dwordx4 v4, s[40:43], s87 offen offset:0 lds
v_mfma_f32_32x32x16_bf16 v[48:63], v[236:239], v[80:83], v[48:63]
ds_read_b64_tr_b16 a[136:137], v29 offset:8192
ds_read_b64_tr_b16 a[138:139], v29 offset:8704
ds_read_b64_tr_b16 v[228:229], v17 offset:12288
ds_read_b64_tr_b16 v[230:231], v17 offset:12800
buffer_load_dwordx4 v5, s[40:43], s87 offen offset:1024 lds
s_waitcnt lgkmcnt(9)
v_mfma_f32_16x16x32_bf16 a[124:127], a[128:131], v[84:87], a[124:127]
v_mfma_f32_32x32x16_bf16 v[32:47], v[240:243], v[84:87], v[32:47]
ds_read_b128 v[92:95], v11 offset:4096
ds_read_b64_tr_b16 v[232:233], v16 offset:14336
ds_read_b64_tr_b16 v[234:235], v16 offset:14848
v_mfma_f32_32x32x16_bf16 v[48:63], v[244:247], v[84:87], v[48:63]
ds_read_b64_tr_b16 v[236:237], v17 offset:14336
ds_read_b64_tr_b16 v[238:239], v17 offset:14848
buffer_load_dwordx4 v6, s[40:43], s87 offen offset:2048 lds
s_waitcnt vmcnt(9) lgkmcnt(5)
s_barrier
v_mfma_f32_16x16x32_bf16 a[124:127], a[128:131], v[88:91], a[124:127]
v_mfma_f32_16x16x32_bf16 a[116:119], a[128:131], a[132:135], a[116:119]
v_mfma_f32_16x16x32_bf16 a[120:123], a[128:131], a[136:139], a[120:123]
v_mfma_f32_32x32x16_bf16 v[32:47], v[224:227], v[88:91], v[32:47]
ds_read_b128 v[96:99], v8 offset:8192
ds_read_b64_tr_b16 v[240:241], v16 offset:16384
ds_read_b64_tr_b16 v[242:243], v16 offset:16896
buffer_load_dwordx4 v7, s[40:43], s87 offen offset:3072 lds
s_add_u32 m0, s7, 32768
v_mfma_f32_32x32x16_bf16 v[48:63], v[228:231], v[88:91], v[48:63]
ds_read_b64_tr_b16 v[244:245], v17 offset:16384
ds_read_b64_tr_b16 v[246:247], v17 offset:16896
s_waitcnt lgkmcnt(5)
v_mfma_f32_16x16x32_bf16 a[124:127], a[128:131], v[92:95], a[124:127]
v_mfma_f32_32x32x16_bf16 v[32:47], v[232:235], v[92:95], v[32:47]
ds_read_b128 v[100:103], v9 offset:8192
ds_read_b64_tr_b16 v[224:225], v16 offset:18432
ds_read_b64_tr_b16 v[226:227], v16 offset:18944
buffer_load_dwordx4 v20, s[44:47], s15 offen offset:0 lds
v_mfma_f32_32x32x16_bf16 v[48:63], v[236:239], v[92:95], v[48:63]
ds_read_b64_tr_b16 v[228:229], v17 offset:18432
ds_read_b64_tr_b16 v[230:231], v17 offset:18944
s_waitcnt lgkmcnt(5)
v_mfma_f32_4x4x4_16b_bf16 a[140:143], v[80:81], v[80:81], a[140:143]
buffer_load_dwordx4 v21, s[44:47], s15 offen offset:1024 lds
v_mfma_f32_4x4x4_16b_bf16 a[144:147], v[82:83], v[82:83], a[144:147]
v_mfma_f32_4x4x4_16b_bf16 a[148:151], v[84:85], v[84:85], a[148:151]
v_mfma_f32_4x4x4_16b_bf16 a[152:155], v[86:87], v[86:87], a[152:155]
v_mfma_f32_4x4x4_16b_bf16 a[140:143], v[88:89], v[88:89], a[140:143]
v_mfma_f32_4x4x4_16b_bf16 a[144:147], v[90:91], v[90:91], a[144:147]
v_mfma_f32_4x4x4_16b_bf16 a[148:151], v[92:93], v[92:93], a[148:151]
v_mfma_f32_4x4x4_16b_bf16 a[152:155], v[94:95], v[94:95], a[152:155]
v_mfma_f32_16x16x32_bf16 a[124:127], a[128:131], v[96:99], a[124:127]
v_mfma_f32_32x32x16_bf16 v[32:47], v[240:243], v[96:99], v[32:47]
ds_read_b64_tr_b16 a[132:133], v28 offset:16384
ds_read_b64_tr_b16 a[134:135], v28 offset:16896
ds_read_b128 v[104:107], v10 offset:8192
ds_read_b64_tr_b16 v[232:233], v16 offset:20480
ds_read_b64_tr_b16 v[234:235], v16 offset:20992
s_add_u32 m0, s65, 4096
s_mul_i32 s15, s88, 640
buffer_load_dwordx4 v4, s[40:43], s88 offen offset:0 lds
v_mfma_f32_32x32x16_bf16 v[48:63], v[244:247], v[96:99], v[48:63]
ds_read_b64_tr_b16 a[136:137], v29 offset:16384
ds_read_b64_tr_b16 a[138:139], v29 offset:16896
ds_read_b64_tr_b16 v[236:237], v17 offset:20480
ds_read_b64_tr_b16 v[238:239], v17 offset:20992
buffer_load_dwordx4 v5, s[40:43], s88 offen offset:1024 lds
s_waitcnt lgkmcnt(9)
v_mfma_f32_16x16x32_bf16 a[124:127], a[128:131], v[100:103], a[124:127]
v_mfma_f32_32x32x16_bf16 v[32:47], v[224:227], v[100:103], v[32:47]
ds_read_b128 v[108:111], v11 offset:8192
ds_read_b64_tr_b16 v[240:241], v16 offset:22528
ds_read_b64_tr_b16 v[242:243], v16 offset:23040
v_mfma_f32_32x32x16_bf16 v[48:63], v[228:231], v[100:103], v[48:63]
ds_read_b64_tr_b16 v[244:245], v17 offset:22528
ds_read_b64_tr_b16 v[246:247], v17 offset:23040
buffer_load_dwordx4 v6, s[40:43], s88 offen offset:2048 lds
s_waitcnt vmcnt(9) lgkmcnt(5)
s_barrier
v_mfma_f32_16x16x32_bf16 a[124:127], a[128:131], v[104:107], a[124:127]
v_mfma_f32_16x16x32_bf16 a[116:119], a[128:131], a[132:135], a[116:119]
v_mfma_f32_16x16x32_bf16 a[120:123], a[128:131], a[136:139], a[120:123]
v_mfma_f32_32x32x16_bf16 v[32:47], v[232:235], v[104:107], v[32:47]
ds_read_b128 v[112:115], v8 offset:12288
ds_read_b64_tr_b16 v[224:225], v16 offset:24576
ds_read_b64_tr_b16 v[226:227], v16 offset:25088
buffer_load_dwordx4 v7, s[40:43], s88 offen offset:3072 lds
s_add_u32 m0, s7, 40960
v_mfma_f32_32x32x16_bf16 v[48:63], v[236:239], v[104:107], v[48:63]
ds_read_b64_tr_b16 v[228:229], v17 offset:24576
ds_read_b64_tr_b16 v[230:231], v17 offset:25088
s_waitcnt lgkmcnt(5)
v_mfma_f32_16x16x32_bf16 a[124:127], a[128:131], v[108:111], a[124:127]
v_mfma_f32_32x32x16_bf16 v[32:47], v[240:243], v[108:111], v[32:47]
ds_read_b128 v[116:119], v9 offset:12288
ds_read_b64_tr_b16 v[232:233], v16 offset:26624
ds_read_b64_tr_b16 v[234:235], v16 offset:27136
buffer_load_dwordx4 v20, s[44:47], s15 offen offset:0 lds
v_mfma_f32_32x32x16_bf16 v[48:63], v[244:247], v[108:111], v[48:63]
ds_read_b64_tr_b16 v[236:237], v17 offset:26624
ds_read_b64_tr_b16 v[238:239], v17 offset:27136
s_waitcnt lgkmcnt(5)
v_mfma_f32_4x4x4_16b_bf16 a[140:143], v[96:97], v[96:97], a[140:143]
buffer_load_dwordx4 v21, s[44:47], s15 offen offset:1024 lds
v_mfma_f32_4x4x4_16b_bf16 a[144:147], v[98:99], v[98:99], a[144:147]
v_mfma_f32_4x4x4_16b_bf16 a[148:151], v[100:101], v[100:101], a[148:151]
v_mfma_f32_4x4x4_16b_bf16 a[152:155], v[102:103], v[102:103], a[152:155]
v_mfma_f32_4x4x4_16b_bf16 a[140:143], v[104:105], v[104:105], a[140:143]
v_mfma_f32_4x4x4_16b_bf16 a[144:147], v[106:107], v[106:107], a[144:147]
v_mfma_f32_4x4x4_16b_bf16 a[148:151], v[108:109], v[108:109], a[148:151]
v_mfma_f32_4x4x4_16b_bf16 a[152:155], v[110:111], v[110:111], a[152:155]
v_mfma_f32_16x16x32_bf16 a[124:127], a[128:131], v[112:115], a[124:127]
v_mfma_f32_32x32x16_bf16 v[32:47], v[224:227], v[112:115], v[32:47]
ds_read_b64_tr_b16 a[132:133], v28 offset:24576
ds_read_b64_tr_b16 a[134:135], v28 offset:25088
ds_read_b128 v[120:123], v10 offset:12288
ds_read_b64_tr_b16 v[240:241], v16 offset:28672
ds_read_b64_tr_b16 v[242:243], v16 offset:29184
s_add_u32 m0, s65, 8192
s_mul_i32 s15, s89, 640
buffer_load_dwordx4 v4, s[40:43], s89 offen offset:0 lds
v_mfma_f32_32x32x16_bf16 v[48:63], v[228:231], v[112:115], v[48:63]
ds_read_b64_tr_b16 a[136:137], v29 offset:24576
ds_read_b64_tr_b16 a[138:139], v29 offset:25088
ds_read_b64_tr_b16 v[244:245], v17 offset:28672
ds_read_b64_tr_b16 v[246:247], v17 offset:29184
buffer_load_dwordx4 v5, s[40:43], s89 offen offset:1024 lds
s_waitcnt lgkmcnt(9)
v_mfma_f32_16x16x32_bf16 a[124:127], a[128:131], v[116:119], a[124:127]
v_mfma_f32_32x32x16_bf16 v[32:47], v[232:235], v[116:119], v[32:47]
ds_read_b128 v[124:127], v11 offset:12288
ds_read_b64_tr_b16 v[224:225], v16 offset:30720
ds_read_b64_tr_b16 v[226:227], v16 offset:31232
v_mfma_f32_32x32x16_bf16 v[48:63], v[236:239], v[116:119], v[48:63]
ds_read_b64_tr_b16 v[228:229], v17 offset:30720
ds_read_b64_tr_b16 v[230:231], v17 offset:31232
buffer_load_dwordx4 v6, s[40:43], s89 offen offset:2048 lds
s_waitcnt vmcnt(9) lgkmcnt(5)
s_barrier
v_mfma_f32_16x16x32_bf16 a[124:127], a[128:131], v[120:123], a[124:127]
v_mfma_f32_16x16x32_bf16 a[116:119], a[128:131], a[132:135], a[116:119]
v_mfma_f32_16x16x32_bf16 a[120:123], a[128:131], a[136:139], a[120:123]
v_mfma_f32_32x32x16_bf16 v[32:47], v[240:243], v[120:123], v[32:47]
ds_read_b128 v[128:131], v8 offset:0
ds_read_b64_tr_b16 v[232:233], v16 offset:32768
ds_read_b64_tr_b16 v[234:235], v16 offset:33280
buffer_load_dwordx4 v7, s[40:43], s89 offen offset:3072 lds
s_add_u32 m0, s7, 49152
v_mfma_f32_32x32x16_bf16 v[48:63], v[244:247], v[120:123], v[48:63]
ds_read_b64_tr_b16 v[236:237], v17 offset:32768
ds_read_b64_tr_b16 v[238:239], v17 offset:33280
s_waitcnt lgkmcnt(5)
v_mfma_f32_16x16x32_bf16 a[124:127], a[128:131], v[124:127], a[124:127]
v_mfma_f32_32x32x16_bf16 v[32:47], v[224:227], v[124:127], v[32:47]
ds_read_b128 v[132:135], v9 offset:0
ds_read_b64_tr_b16 v[240:241], v16 offset:34816
ds_read_b64_tr_b16 v[242:243], v16 offset:35328
buffer_load_dwordx4 v20, s[44:47], s15 offen offset:0 lds
v_mfma_f32_32x32x16_bf16 v[48:63], v[228:231], v[124:127], v[48:63]
ds_read_b64_tr_b16 v[244:245], v17 offset:34816
ds_read_b64_tr_b16 v[246:247], v17 offset:35328
s_waitcnt lgkmcnt(5)
v_mfma_f32_4x4x4_16b_bf16 a[140:143], v[112:113], v[112:113], a[140:143]
buffer_load_dwordx4 v21, s[44:47], s15 offen offset:1024 lds
v_mfma_f32_4x4x4_16b_bf16 a[144:147], v[114:115], v[114:115], a[144:147]
v_mfma_f32_4x4x4_16b_bf16 a[148:151], v[116:117], v[116:117], a[148:151]
v_mfma_f32_4x4x4_16b_bf16 a[152:155], v[118:119], v[118:119], a[152:155]
v_mfma_f32_4x4x4_16b_bf16 a[140:143], v[120:121], v[120:121], a[140:143]
v_mfma_f32_4x4x4_16b_bf16 a[144:147], v[122:123], v[122:123], a[144:147]
v_mfma_f32_4x4x4_16b_bf16 a[148:151], v[124:125], v[124:125], a[148:151]
v_mfma_f32_4x4x4_16b_bf16 a[152:155], v[126:127], v[126:127], a[152:155]
v_mfma_f32_16x16x32_bf16 a[124:127], a[128:131], v[128:131], a[124:127]
v_mfma_f32_32x32x16_bf16 v[32:47], v[232:235], v[128:131], v[32:47]
ds_read_b64_tr_b16 a[132:133], v28 offset:32768
ds_read_b64_tr_b16 a[134:135], v28 offset:33280
ds_read_b128 v[136:139], v10 offset:0
ds_read_b64_tr_b16 v[224:225], v16 offset:36864
ds_read_b64_tr_b16 v[226:227], v16 offset:37376
s_add_u32 m0, s65, 12288
s_mul_i32 s15, s90, 640
buffer_load_dwordx4 v4, s[40:43], s90 offen offset:0 lds
v_mfma_f32_32x32x16_bf16 v[48:63], v[236:239], v[128:131], v[48:63]
ds_read_b64_tr_b16 a[136:137], v29 offset:32768
ds_read_b64_tr_b16 a[138:139], v29 offset:33280
ds_read_b64_tr_b16 v[228:229], v17 offset:36864
ds_read_b64_tr_b16 v[230:231], v17 offset:37376
buffer_load_dwordx4 v5, s[40:43], s90 offen offset:1024 lds
s_waitcnt lgkmcnt(9)
v_mfma_f32_16x16x32_bf16 a[124:127], a[128:131], v[132:135], a[124:127]
v_mfma_f32_32x32x16_bf16 v[32:47], v[240:243], v[132:135], v[32:47]
ds_read_b128 v[140:143], v11 offset:0
ds_read_b64_tr_b16 v[232:233], v16 offset:38912
ds_read_b64_tr_b16 v[234:235], v16 offset:39424
v_mfma_f32_32x32x16_bf16 v[48:63], v[244:247], v[132:135], v[48:63]
ds_read_b64_tr_b16 v[236:237], v17 offset:38912
ds_read_b64_tr_b16 v[238:239], v17 offset:39424
buffer_load_dwordx4 v6, s[40:43], s90 offen offset:2048 lds
s_waitcnt vmcnt(9) lgkmcnt(5)
s_barrier
v_mfma_f32_16x16x32_bf16 a[124:127], a[128:131], v[136:139], a[124:127]
v_mfma_f32_16x16x32_bf16 a[116:119], a[128:131], a[132:135], a[116:119]
v_mfma_f32_16x16x32_bf16 a[120:123], a[128:131], a[136:139], a[120:123]
v_mfma_f32_32x32x16_bf16 v[32:47], v[224:227], v[136:139], v[32:47]
ds_read_b128 v[144:147], v8 offset:4096
ds_read_b64_tr_b16 v[240:241], v16 offset:40960
ds_read_b64_tr_b16 v[242:243], v16 offset:41472
buffer_load_dwordx4 v7, s[40:43], s90 offen offset:3072 lds
s_add_u32 m0, s7, 57344
v_mfma_f32_32x32x16_bf16 v[48:63], v[228:231], v[136:139], v[48:63]
ds_read_b64_tr_b16 v[244:245], v17 offset:40960
ds_read_b64_tr_b16 v[246:247], v17 offset:41472
s_waitcnt lgkmcnt(5)
v_mfma_f32_16x16x32_bf16 a[124:127], a[128:131], v[140:143], a[124:127]
v_mfma_f32_32x32x16_bf16 v[32:47], v[232:235], v[140:143], v[32:47]
ds_read_b128 v[148:151], v9 offset:4096
ds_read_b64_tr_b16 v[224:225], v16 offset:43008
ds_read_b64_tr_b16 v[226:227], v16 offset:43520
buffer_load_dwordx4 v20, s[44:47], s15 offen offset:0 lds
v_mfma_f32_32x32x16_bf16 v[48:63], v[236:239], v[140:143], v[48:63]
ds_read_b64_tr_b16 v[228:229], v17 offset:43008
ds_read_b64_tr_b16 v[230:231], v17 offset:43520
s_waitcnt lgkmcnt(5)
v_mfma_f32_4x4x4_16b_bf16 a[140:143], v[128:129], v[128:129], a[140:143]
buffer_load_dwordx4 v21, s[44:47], s15 offen offset:1024 lds
v_mfma_f32_4x4x4_16b_bf16 a[144:147], v[130:131], v[130:131], a[144:147]
v_mfma_f32_4x4x4_16b_bf16 a[148:151], v[132:133], v[132:133], a[148:151]
v_mfma_f32_4x4x4_16b_bf16 a[152:155], v[134:135], v[134:135], a[152:155]
v_mfma_f32_4x4x4_16b_bf16 a[140:143], v[136:137], v[136:137], a[140:143]
v_mfma_f32_4x4x4_16b_bf16 a[144:147], v[138:139], v[138:139], a[144:147]
v_mfma_f32_4x4x4_16b_bf16 a[148:151], v[140:141], v[140:141], a[148:151]
v_mfma_f32_4x4x4_16b_bf16 a[152:155], v[142:143], v[142:143], a[152:155]
v_mfma_f32_16x16x32_bf16 a[124:127], a[128:131], v[144:147], a[124:127]
v_mfma_f32_32x32x16_bf16 v[32:47], v[240:243], v[144:147], v[32:47]
ds_read_b64_tr_b16 a[132:133], v28 offset:40960
ds_read_b64_tr_b16 a[134:135], v28 offset:41472
ds_read_b128 v[152:155], v10 offset:4096
ds_read_b64_tr_b16 v[232:233], v16 offset:45056
ds_read_b64_tr_b16 v[234:235], v16 offset:45568
s_add_u32 m0, s65, 0
s_mul_i32 s15, s91, 640
buffer_load_dwordx4 v4, s[40:43], s91 offen offset:0 lds
v_mfma_f32_32x32x16_bf16 v[48:63], v[244:247], v[144:147], v[48:63]
ds_read_b64_tr_b16 a[136:137], v29 offset:40960
ds_read_b64_tr_b16 a[138:139], v29 offset:41472
ds_read_b64_tr_b16 v[236:237], v17 offset:45056
ds_read_b64_tr_b16 v[238:239], v17 offset:45568
buffer_load_dwordx4 v5, s[40:43], s91 offen offset:1024 lds
s_waitcnt lgkmcnt(9)
v_mfma_f32_16x16x32_bf16 a[124:127], a[128:131], v[148:151], a[124:127]
v_mfma_f32_32x32x16_bf16 v[32:47], v[224:227], v[148:151], v[32:47]
ds_read_b128 v[156:159], v11 offset:4096
ds_read_b64_tr_b16 v[240:241], v16 offset:47104
ds_read_b64_tr_b16 v[242:243], v16 offset:47616
v_mfma_f32_32x32x16_bf16 v[48:63], v[228:231], v[148:151], v[48:63]
ds_read_b64_tr_b16 v[244:245], v17 offset:47104
ds_read_b64_tr_b16 v[246:247], v17 offset:47616
buffer_load_dwordx4 v6, s[40:43], s91 offen offset:2048 lds
s_waitcnt vmcnt(9) lgkmcnt(5)
s_barrier
v_mfma_f32_16x16x32_bf16 a[124:127], a[128:131], v[152:155], a[124:127]
v_mfma_f32_16x16x32_bf16 a[116:119], a[128:131], a[132:135], a[116:119]
v_mfma_f32_16x16x32_bf16 a[120:123], a[128:131], a[136:139], a[120:123]
v_mfma_f32_32x32x16_bf16 v[32:47], v[232:235], v[152:155], v[32:47]
ds_read_b128 v[160:163], v8 offset:8192
ds_read_b64_tr_b16 v[224:225], v16 offset:49152
ds_read_b64_tr_b16 v[226:227], v16 offset:49664
buffer_load_dwordx4 v7, s[40:43], s91 offen offset:3072 lds
s_add_u32 m0, s7, 65536
v_mfma_f32_32x32x16_bf16 v[48:63], v[236:239], v[152:155], v[48:63]
ds_read_b64_tr_b16 v[228:229], v17 offset:49152
ds_read_b64_tr_b16 v[230:231], v17 offset:49664
s_waitcnt lgkmcnt(5)
v_mfma_f32_16x16x32_bf16 a[124:127], a[128:131], v[156:159], a[124:127]
v_mfma_f32_32x32x16_bf16 v[32:47], v[240:243], v[156:159], v[32:47]
ds_read_b128 v[164:167], v9 offset:8192
ds_read_b64_tr_b16 v[232:233], v16 offset:51200
ds_read_b64_tr_b16 v[234:235], v16 offset:51712
buffer_load_dwordx4 v20, s[44:47], s15 offen offset:0 lds
v_mfma_f32_32x32x16_bf16 v[48:63], v[244:247], v[156:159], v[48:63]
ds_read_b64_tr_b16 v[236:237], v17 offset:51200
ds_read_b64_tr_b16 v[238:239], v17 offset:51712
s_waitcnt lgkmcnt(5)
v_mfma_f32_4x4x4_16b_bf16 a[140:143], v[144:145], v[144:145], a[140:143]
buffer_load_dwordx4 v21, s[44:47], s15 offen offset:1024 lds
v_mfma_f32_4x4x4_16b_bf16 a[144:147], v[146:147], v[146:147], a[144:147]
v_mfma_f32_4x4x4_16b_bf16 a[148:151], v[148:149], v[148:149], a[148:151]
v_mfma_f32_4x4x4_16b_bf16 a[152:155], v[150:151], v[150:151], a[152:155]
v_mfma_f32_4x4x4_16b_bf16 a[140:143], v[152:153], v[152:153], a[140:143]
v_mfma_f32_4x4x4_16b_bf16 a[144:147], v[154:155], v[154:155], a[144:147]
v_mfma_f32_4x4x4_16b_bf16 a[148:151], v[156:157], v[156:157], a[148:151]
v_mfma_f32_4x4x4_16b_bf16 a[152:155], v[158:159], v[158:159], a[152:155]
v_mfma_f32_16x16x32_bf16 a[124:127], a[128:131], v[160:163], a[124:127]
v_mfma_f32_32x32x16_bf16 v[32:47], v[224:227], v[160:163], v[32:47]
ds_read_b64_tr_b16 a[132:133], v28 offset:49152
ds_read_b64_tr_b16 a[134:135], v28 offset:49664
ds_read_b128 v[168:171], v10 offset:8192
ds_read_b64_tr_b16 v[240:241], v16 offset:53248
ds_read_b64_tr_b16 v[242:243], v16 offset:53760
s_add_u32 m0, s65, 4096
s_mul_i32 s15, s92, 640
buffer_load_dwordx4 v4, s[40:43], s92 offen offset:0 lds
v_mfma_f32_32x32x16_bf16 v[48:63], v[228:231], v[160:163], v[48:63]
ds_read_b64_tr_b16 a[136:137], v29 offset:49152
ds_read_b64_tr_b16 a[138:139], v29 offset:49664
ds_read_b64_tr_b16 v[244:245], v17 offset:53248
ds_read_b64_tr_b16 v[246:247], v17 offset:53760
buffer_load_dwordx4 v5, s[40:43], s92 offen offset:1024 lds
s_waitcnt lgkmcnt(9)
v_mfma_f32_16x16x32_bf16 a[124:127], a[128:131], v[164:167], a[124:127]
v_mfma_f32_32x32x16_bf16 v[32:47], v[232:235], v[164:167], v[32:47]
ds_read_b128 v[172:175], v11 offset:8192
ds_read_b64_tr_b16 v[224:225], v16 offset:55296
ds_read_b64_tr_b16 v[226:227], v16 offset:55808
v_mfma_f32_32x32x16_bf16 v[48:63], v[236:239], v[164:167], v[48:63]
ds_read_b64_tr_b16 v[228:229], v17 offset:55296
ds_read_b64_tr_b16 v[230:231], v17 offset:55808
buffer_load_dwordx4 v6, s[40:43], s92 offen offset:2048 lds
s_waitcnt vmcnt(9) lgkmcnt(5)
s_barrier
v_mfma_f32_16x16x32_bf16 a[124:127], a[128:131], v[168:171], a[124:127]
v_mfma_f32_16x16x32_bf16 a[116:119], a[128:131], a[132:135], a[116:119]
v_mfma_f32_16x16x32_bf16 a[120:123], a[128:131], a[136:139], a[120:123]
v_mfma_f32_32x32x16_bf16 v[32:47], v[240:243], v[168:171], v[32:47]
ds_read_b128 v[176:179], v8 offset:12288
ds_read_b64_tr_b16 v[232:233], v16 offset:57344
ds_read_b64_tr_b16 v[234:235], v16 offset:57856
buffer_load_dwordx4 v7, s[40:43], s92 offen offset:3072 lds
s_add_u32 m0, s7, 73728
v_mfma_f32_32x32x16_bf16 v[48:63], v[244:247], v[168:171], v[48:63]
ds_read_b64_tr_b16 v[236:237], v17 offset:57344
ds_read_b64_tr_b16 v[238:239], v17 offset:57856
s_waitcnt lgkmcnt(5)
v_mfma_f32_16x16x32_bf16 a[124:127], a[128:131], v[172:175], a[124:127]
v_mfma_f32_32x32x16_bf16 v[32:47], v[224:227], v[172:175], v[32:47]
ds_read_b128 v[180:183], v9 offset:12288
ds_read_b64_tr_b16 v[240:241], v16 offset:59392
ds_read_b64_tr_b16 v[242:243], v16 offset:59904
buffer_load_dwordx4 v20, s[44:47], s15 offen offset:0 lds
v_mfma_f32_32x32x16_bf16 v[48:63], v[228:231], v[172:175], v[48:63]
ds_read_b64_tr_b16 v[244:245], v17 offset:59392
ds_read_b64_tr_b16 v[246:247], v17 offset:59904
s_waitcnt lgkmcnt(5)
v_mfma_f32_4x4x4_16b_bf16 a[140:143], v[160:161], v[160:161], a[140:143]
buffer_load_dwordx4 v21, s[44:47], s15 offen offset:1024 lds
v_mfma_f32_4x4x4_16b_bf16 a[144:147], v[162:163], v[162:163], a[144:147]
v_mfma_f32_4x4x4_16b_bf16 a[148:151], v[164:165], v[164:165], a[148:151]
v_mfma_f32_4x4x4_16b_bf16 a[152:155], v[166:167], v[166:167], a[152:155]
v_mfma_f32_4x4x4_16b_bf16 a[140:143], v[168:169], v[168:169], a[140:143]
v_mfma_f32_4x4x4_16b_bf16 a[144:147], v[170:171], v[170:171], a[144:147]
v_mfma_f32_4x4x4_16b_bf16 a[148:151], v[172:173], v[172:173], a[148:151]
v_mfma_f32_4x4x4_16b_bf16 a[152:155], v[174:175], v[174:175], a[152:155]
v_mfma_f32_16x16x32_bf16 a[124:127], a[128:131], v[176:179], a[124:127]
v_mfma_f32_32x32x16_bf16 v[32:47], v[232:235], v[176:179], v[32:47]
ds_read_b64_tr_b16 a[132:133], v28 offset:57344
ds_read_b64_tr_b16 a[134:135], v28 offset:57856
ds_read_b128 v[184:187], v10 offset:12288
ds_read_b64_tr_b16 v[224:225], v16 offset:61440
ds_read_b64_tr_b16 v[226:227], v16 offset:61952
s_add_u32 m0, s66, 98304
s_nop 0
buffer_load_dwordx4 v12, s[52:55], s82 offen offset:0 lds
v_mfma_f32_32x32x16_bf16 v[48:63], v[236:239], v[176:179], v[48:63]
ds_read_b64_tr_b16 a[136:137], v29 offset:57344
ds_read_b64_tr_b16 a[138:139], v29 offset:57856
ds_read_b64_tr_b16 v[228:229], v17 offset:61440
ds_read_b64_tr_b16 v[230:231], v17 offset:61952
buffer_load_dwordx4 v13, s[52:55], s82 offen offset:1024 lds
s_waitcnt lgkmcnt(9)
v_mfma_f32_16x16x32_bf16 a[124:127], a[128:131], v[180:183], a[124:127]
v_mfma_f32_32x32x16_bf16 v[32:47], v[240:243], v[180:183], v[32:47]
ds_read_b128 v[188:191], v11 offset:12288
ds_read_b64_tr_b16 v[232:233], v16 offset:63488
ds_read_b64_tr_b16 v[234:235], v16 offset:64000
buffer_store_dwordx2 v[250:251], v248, s[48:51], s72 offen sc1
v_mfma_f32_32x32x16_bf16 v[48:63], v[244:247], v[180:183], v[48:63]
ds_read_b64_tr_b16 v[236:237], v17 offset:63488
ds_read_b64_tr_b16 v[238:239], v17 offset:64000
buffer_load_dwordx4 v14, s[52:55], s82 offen offset:2048 lds
s_waitcnt vmcnt(10) lgkmcnt(5)
s_barrier
v_mfma_f32_16x16x32_bf16 a[124:127], a[128:131], v[184:187], a[124:127]
v_mfma_f32_16x16x32_bf16 a[116:119], a[128:131], a[132:135], a[116:119]
v_mfma_f32_16x16x32_bf16 a[120:123], a[128:131], a[136:139], a[120:123]
v_mfma_f32_32x32x16_bf16 v[32:47], v[224:227], v[184:187], v[32:47]
ds_read_b128 v[192:195], v8 offset:0
ds_read_b64_tr_b16 v[240:241], v18 offset:0
ds_read_b64_tr_b16 v[242:243], v18 offset:512
buffer_load_dwordx4 v15, s[52:55], s82 offen offset:3072 lds
v_mfma_f32_32x32x16_bf16 v[48:63], v[228:231], v[184:187], v[48:63]
ds_read_b64_tr_b16 v[244:245], v19 offset:0
ds_read_b64_tr_b16 v[246:247], v19 offset:512
s_add_u32 s11, s72, 655360
s_mov_b64 exec, 0xffff
buffer_store_dwordx2 v[250:251], v248, s[48:51], s11 offen sc1
s_mov_b64 exec, -1
s_waitcnt lgkmcnt(5)
v_mfma_f32_16x16x32_bf16 a[124:127], a[128:131], v[188:191], a[124:127]
v_mfma_f32_32x32x16_bf16 v[32:47], v[232:235], v[188:191], v[32:47]
ds_read_b128 v[196:199], v9 offset:0
ds_read_b64_tr_b16 v[224:225], v18 offset:2048
ds_read_b64_tr_b16 v[226:227], v18 offset:2560
s_add_u32 m0, s66, 90112
s_nop 0
buffer_load_dwordx4 v12, s[52:55], s80 offen offset:0 lds
v_mfma_f32_32x32x16_bf16 v[48:63], v[236:239], v[188:191], v[48:63]
ds_read_b64_tr_b16 v[228:229], v19 offset:2048
ds_read_b64_tr_b16 v[230:231], v19 offset:2560
s_waitcnt lgkmcnt(5)
v_mfma_f32_4x4x4_16b_bf16 a[140:143], v[176:177], v[176:177], a[140:143]
buffer_load_dwordx4 v13, s[52:55], s80 offen offset:1024 lds
v_mfma_f32_4x4x4_16b_bf16 a[144:147], v[178:179], v[178:179], a[144:147]
v_mfma_f32_4x4x4_16b_bf16 a[148:151], v[180:181], v[180:181], a[148:151]
v_mfma_f32_4x4x4_16b_bf16 a[152:155], v[182:183], v[182:183], a[152:155]
v_mfma_f32_4x4x4_16b_bf16 a[140:143], v[184:185], v[184:185], a[140:143]
v_mfma_f32_4x4x4_16b_bf16 a[144:147], v[186:187], v[186:187], a[144:147]
v_mfma_f32_4x4x4_16b_bf16 a[148:151], v[188:189], v[188:189], a[148:151]
v_mfma_f32_4x4x4_16b_bf16 a[152:155], v[190:191], v[190:191], a[152:155]
v_mfma_f32_16x16x32_bf16 a[124:127], a[128:131], v[192:195], a[124:127]
v_mfma_f32_32x32x16_bf16 v[32:47], v[240:243], v[192:195], v[32:47]
ds_read_b64_tr_b16 a[132:133], v30 offset:0
ds_read_b64_tr_b16 a[134:135], v30 offset:512
ds_read_b128 v[200:203], v10 offset:0
ds_read_b64_tr_b16 v[232:233], v18 offset:4096
ds_read_b64_tr_b16 v[234:235], v18 offset:4608
buffer_load_dwordx4 v14, s[52:55], s80 offen offset:2048 lds
v_mfma_f32_32x32x16_bf16 v[48:63], v[244:247], v[192:195], v[48:63]
ds_read_b64_tr_b16 a[136:137], v31 offset:0
ds_read_b64_tr_b16 a[138:139], v31 offset:512
ds_read_b64_tr_b16 v[236:237], v19 offset:4096
ds_read_b64_tr_b16 v[238:239], v19 offset:4608
buffer_load_dwordx4 v15, s[52:55], s80 offen offset:3072 lds
s_waitcnt lgkmcnt(9)
v_mfma_f32_16x16x32_bf16 a[124:127], a[128:131], v[196:199], a[124:127]
v_mfma_f32_32x32x16_bf16 v[32:47], v[224:227], v[196:199], v[32:47]
ds_read_b128 v[204:207], v11 offset:0
ds_read_b64_tr_b16 v[240:241], v18 offset:6144
ds_read_b64_tr_b16 v[242:243], v18 offset:6656
v_mfma_f32_32x32x16_bf16 v[48:63], v[228:231], v[196:199], v[48:63]
ds_read_b64_tr_b16 v[244:245], v19 offset:6144
ds_read_b64_tr_b16 v[246:247], v19 offset:6656
s_add_u32 m0, s66, 94208
s_nop 0
buffer_load_dwordx4 v12, s[52:55], s81 offen offset:0 lds
s_waitcnt vmcnt(11) lgkmcnt(5)
s_barrier
v_mfma_f32_16x16x32_bf16 a[124:127], a[128:131], v[200:203], a[124:127]
v_mfma_f32_16x16x32_bf16 a[116:119], a[128:131], a[132:135], a[116:119]
v_mfma_f32_16x16x32_bf16 a[120:123], a[128:131], a[136:139], a[120:123]
v_mfma_f32_32x32x16_bf16 v[32:47], v[232:235], v[200:203], v[32:47]
ds_read_b128 v[208:211], v8 offset:4096
ds_read_b64_tr_b16 v[224:225], v18 offset:8192
ds_read_b64_tr_b16 v[226:227], v18 offset:8704
buffer_load_dwordx4 v13, s[52:55], s81 offen offset:1024 lds
v_mfma_f32_32x32x16_bf16 v[48:63], v[236:239], v[200:203], v[48:63]
ds_read_b64_tr_b16 v[228:229], v19 offset:8192
ds_read_b64_tr_b16 v[230:231], v19 offset:8704
s_waitcnt lgkmcnt(5)
v_mfma_f32_16x16x32_bf16 a[124:127], a[128:131], v[204:207], a[124:127]
v_mfma_f32_32x32x16_bf16 v[32:47], v[240:243], v[204:207], v[32:47]
ds_read_b128 v[212:215], v9 offset:4096
ds_read_b64_tr_b16 v[232:233], v18 offset:10240
ds_read_b64_tr_b16 v[234:235], v18 offset:10752
buffer_load_dwordx4 v14, s[52:55], s81 offen offset:2048 lds
v_mfma_f32_32x32x16_bf16 v[48:63], v[244:247], v[204:207], v[48:63]
ds_read_b64_tr_b16 v[236:237], v19 offset:10240
ds_read_b64_tr_b16 v[238:239], v19 offset:10752
v_lshlrev_b32 v254, 3, v1
buffer_load_dwordx2 v[252:253], off, s[56:59], 0 sc1
s_waitcnt lgkmcnt(5)
v_mfma_f32_4x4x4_16b_bf16 a[140:143], v[192:193], v[192:193], a[140:143]
buffer_load_dwordx4 v15, s[52:55], s81 offen offset:3072 lds
v_mfma_f32_4x4x4_16b_bf16 a[144:147], v[194:195], v[194:195], a[144:147]
v_mfma_f32_4x4x4_16b_bf16 a[148:151], v[196:197], v[196:197], a[148:151]
v_mfma_f32_4x4x4_16b_bf16 a[152:155], v[198:199], v[198:199], a[152:155]
v_mfma_f32_4x4x4_16b_bf16 a[140:143], v[200:201], v[200:201], a[140:143]
v_mfma_f32_4x4x4_16b_bf16 a[144:147], v[202:203], v[202:203], a[144:147]
v_mfma_f32_4x4x4_16b_bf16 a[148:151], v[204:205], v[204:205], a[148:151]
v_mfma_f32_4x4x4_16b_bf16 a[152:155], v[206:207], v[206:207], a[152:155]
v_mfma_f32_16x16x32_bf16 a[124:127], a[128:131], v[208:211], a[124:127]
v_mfma_f32_32x32x16_bf16 v[32:47], v[224:227], v[208:211], v[32:47]
ds_read_b64_tr_b16 a[132:133], v30 offset:8192
ds_read_b64_tr_b16 a[134:135], v30 offset:8704
ds_read_b128 v[216:219], v10 offset:4096
ds_read_b64_tr_b16 v[240:241], v18 offset:12288
ds_read_b64_tr_b16 v[242:243], v18 offset:12800
s_add_u32 m0, s66, 81920
s_nop 0
buffer_load_dwordx4 v12, s[52:55], s78 offen offset:0 lds
v_mfma_f32_32x32x16_bf16 v[48:63], v[228:231], v[208:211], v[48:63]
ds_read_b64_tr_b16 a[136:137], v31 offset:8192
ds_read_b64_tr_b16 a[138:139], v31 offset:8704
ds_read_b64_tr_b16 v[244:245], v19 offset:12288
ds_read_b64_tr_b16 v[246:247], v19 offset:12800
buffer_load_dwordx4 v13, s[52:55], s78 offen offset:1024 lds
s_waitcnt lgkmcnt(9)
v_mfma_f32_16x16x32_bf16 a[124:127], a[128:131], v[212:215], a[124:127]
v_mfma_f32_32x32x16_bf16 v[32:47], v[232:235], v[212:215], v[32:47]
ds_read_b128 v[220:223], v11 offset:4096
ds_read_b64_tr_b16 v[224:225], v18 offset:14336
ds_read_b64_tr_b16 v[226:227], v18 offset:14848
v_mfma_f32_32x32x16_bf16 v[48:63], v[236:239], v[212:215], v[48:63]
ds_read_b64_tr_b16 v[228:229], v19 offset:14336
ds_read_b64_tr_b16 v[230:231], v19 offset:14848
buffer_load_dwordx4 v14, s[52:55], s78 offen offset:2048 lds
s_waitcnt lgkmcnt(5)
v_mfma_f32_16x16x32_bf16 a[124:127], a[128:131], v[216:219], a[124:127]
v_mfma_f32_16x16x32_bf16 a[116:119], a[128:131], a[132:135], a[116:119]
v_mfma_f32_16x16x32_bf16 a[120:123], a[128:131], a[136:139], a[120:123]
v_mfma_f32_32x32x16_bf16 v[32:47], v[240:243], v[216:219], v[32:47]
buffer_load_dwordx4 v15, s[52:55], s78 offen offset:3072 lds
v_mfma_f32_32x32x16_bf16 v[48:63], v[244:247], v[216:219], v[48:63]
s_waitcnt lgkmcnt(0)
v_mfma_f32_16x16x32_bf16 a[124:127], a[128:131], v[220:223], a[124:127]
v_mfma_f32_32x32x16_bf16 v[32:47], v[224:227], v[220:223], v[32:47]
s_add_u32 m0, s66, 86016
s_nop 0
buffer_load_dwordx4 v12, s[52:55], s79 offen offset:0 lds
buffer_load_dwordx4 v13, s[52:55], s79 offen offset:1024 lds
v_accvgpr_read_b32 v248, a116
v_accvgpr_read_b32 v249, a120
ds_write_b32 v24, v248 offset:0
ds_write_b32 v24, v249 offset:1024
v_mfma_f32_32x32x16_bf16 v[48:63], v[228:231], v[220:223], v[48:63]
v_mfma_f32_4x4x4_16b_bf16 a[140:143], v[208:209], v[208:209], a[140:143]
buffer_load_dwordx4 v14, s[52:55], s79 offen offset:2048 lds
buffer_load_dwordx4 v15, s[52:55], s79 offen offset:3072 lds
v_mfma_f32_4x4x4_16b_bf16 a[144:147], v[210:211], v[210:211], a[144:147]
v_mfma_f32_4x4x4_16b_bf16 a[148:151], v[212:213], v[212:213], a[148:151]
v_mfma_f32_4x4x4_16b_bf16 a[152:155], v[214:215], v[214:215], a[152:155]
v_mfma_f32_4x4x4_16b_bf16 a[140:143], v[216:217], v[216:217], a[140:143]
v_mfma_f32_4x4x4_16b_bf16 a[144:147], v[218:219], v[218:219], a[144:147]
v_mfma_f32_4x4x4_16b_bf16 a[148:151], v[220:221], v[220:221], a[148:151]
v_mfma_f32_4x4x4_16b_bf16 a[152:155], v[222:223], v[222:223], a[152:155]
s_waitcnt lgkmcnt(0)
s_barrier
ds_read_b128 v[240:243], v25 offset:0
ds_read_b128 v[244:247], v25 offset:1024
v_accvgpr_read_b32 v20, a124
v_mul_f32 v20, 0x3acccccd, v20
v_mul_f32 v249, 0.5, v20
v_cvt_pk_bf16_f32 v26, -v249, -v249
v_and_b32 v248, 0xffff0000, v26
v_sub_f32_e64 v248, -v249, v248
v_cvt_pk_bf16_f32 v27, v248, v248
s_waitcnt lgkmcnt(0)
v_pk_add_f32 v[240:241], v[240:241], v[242:243]
v_add_f32 v240, v240, v241
v_cvt_pk_bf16_f32 v8, v240, v240
v_and_b32 v248, 0xffff0000, v8
v_sub_f32 v248, v240, v248
v_cvt_pk_bf16_f32 v8, v240, v248
v_mov_b32 v9, v8
v_pk_add_f32 v[244:245], v[244:245], v[246:247]
v_add_f32 v244, v244, v245
v_cvt_pk_bf16_f32 v10, v244, v244
v_and_b32 v248, 0xffff0000, v10
v_sub_f32 v248, v244, v248
v_cvt_pk_bf16_f32 v10, v244, v248
v_mov_b32 v11, v10
v_mfma_f32_32x32x8_bf16 v[32:47], v[8:9], v[26:27], v[32:47]
s_nop 0
v_mfma_f32_32x32x8_bf16 v[48:63], v[10:11], v[26:27], v[48:63]
v_lshrrev_b32 v248, 3, v1
v_mul_u32_u24 v248, 2560, v248
v_sub_u32 v12, v12, v248
s_mov_b32 s44, s26
s_mov_b32 s45, s27
v_add_u32 v13, 9216, v12
v_add_u32 v14, 18432, v12
v_add_u32 v15, 27648, v12
v_accvgpr_read_b32 v224, a140
v_accvgpr_read_b32 v225, a141
v_accvgpr_read_b32 v226, a142
v_accvgpr_read_b32 v227, a143
v_accvgpr_read_b32 v228, a144
v_accvgpr_read_b32 v229, a145
v_accvgpr_read_b32 v230, a146
v_accvgpr_read_b32 v231, a147
v_accvgpr_read_b32 v232, a148
v_accvgpr_read_b32 v233, a149
v_accvgpr_read_b32 v234, a150
v_accvgpr_read_b32 v235, a151
v_accvgpr_read_b32 v236, a152
v_accvgpr_read_b32 v237, a153
v_accvgpr_read_b32 v238, a154
v_accvgpr_read_b32 v239, a155
v_add_f32 v224, v224, v232
v_add_f32 v225, v225, v233
v_add_f32 v226, v226, v234
v_add_f32 v227, v227, v235
v_add_f32 v228, v228, v236
v_add_f32 v229, v229, v237
v_add_f32 v230, v230, v238
v_add_f32 v231, v231, v239
s_mov_b32 vcc_lo, 0xaaaaaaaa
s_mov_b32 vcc_hi, 0xaaaaaaaa
v_add_f32 v224, v224, v228
v_add_f32 v225, v225, v229
v_add_f32 v226, v226, v230
v_add_f32 v227, v227, v231
v_cndmask_b32 v224, v224, v225, vcc
v_cndmask_b32 v226, v226, v227, vcc
s_mov_b32 vcc_lo, 0xcccccccc
s_mov_b32 vcc_hi, 0xcccccccc
v_cndmask_b32 v21, v224, v226, vcc
v_mov_b32 v248, v21
s_nop 1
v_permlane32_swap_b32 v21, v248
v_add_f32 v21, v21, v248
v_mul_f32 v21, 0x3acccccd, v21
v_fma_f32 v21, -v20, v20, v21
v_max_f32 v21, 0, v21
v_add_f32 v248, 0x3727c5ac, v21
v_rsq_f32 v4, v248
s_nop 0
v_mul_f32 v248, v4, v4
v_mul_f32 v248, v248, v21
v_add_f32 v248, 0x3727c5ac, v248
v_rsq_f32 v248, v248
v_mul_f32 v6, v20, v4
v_mul_f32 v7, v248, v4
v_cndmask_b32 v248, 0, v7, s[94:95]
v_mul_f32 v24, 0xc0135761, v248
v_mul_f32 v28, v248, v248
v_rcp_f32 v30, v248
v_mul_f32 v28, v28, v248
v_mul_f32 v28, 0xbdd2d3e8, v28
v_pk_mul_f32 v[224:225], v[32:33], v[32:33]
v_pk_mul_f32 v[226:227], v[34:35], v[34:35]
v_pk_mul_f32 v[228:229], v[36:37], v[36:37]
v_pk_mul_f32 v[230:231], v[38:39], v[38:39]
v_pk_fma_f32 v[224:225], v[224:225], v[28:29], v[24:25] op_sel_hi:[1,0,0]
v_pk_fma_f32 v[226:227], v[226:227], v[28:29], v[24:25] op_sel_hi:[1,0,0]
v_pk_fma_f32 v[228:229], v[228:229], v[28:29], v[24:25] op_sel_hi:[1,0,0]
v_pk_fma_f32 v[230:231], v[230:231], v[28:29], v[24:25] op_sel_hi:[1,0,0]
v_pk_mul_f32 v[224:225], v[224:225], v[32:33]
v_pk_mul_f32 v[226:227], v[226:227], v[34:35]
v_pk_mul_f32 v[228:229], v[228:229], v[36:37]
v_pk_mul_f32 v[230:231], v[230:231], v[38:39]
v_exp_f32 v224, v224
v_exp_f32 v225, v225
v_exp_f32 v226, v226
v_exp_f32 v227, v227
v_exp_f32 v228, v228
v_exp_f32 v229, v229
v_exp_f32 v230, v230
v_exp_f32 v231, v231
v_pk_fma_f32 v[224:225], v[224:225], v[30:31], v[30:31] op_sel_hi:[1,0,0]
v_pk_fma_f32 v[226:227], v[226:227], v[30:31], v[30:31] op_sel_hi:[1,0,0]
v_pk_fma_f32 v[228:229], v[228:229], v[30:31], v[30:31] op_sel_hi:[1,0,0]
v_pk_fma_f32 v[230:231], v[230:231], v[30:31], v[30:31] op_sel_hi:[1,0,0]
v_rcp_f32 v224, v224
v_rcp_f32 v225, v225
v_rcp_f32 v226, v226
v_rcp_f32 v227, v227
v_rcp_f32 v228, v228
v_rcp_f32 v229, v229
v_rcp_f32 v230, v230
v_rcp_f32 v231, v231
v_pk_mul_f32 v[32:33], v[32:33], v[224:225]
v_pk_mul_f32 v[34:35], v[34:35], v[226:227]
v_pk_mul_f32 v[36:37], v[36:37], v[228:229]
v_pk_mul_f32 v[38:39], v[38:39], v[230:231]
v_cvt_pk_bf16_f32 v232, v32, v33
v_cvt_pk_bf16_f32 v233, v34, v35
v_cvt_pk_bf16_f32 v234, v36, v37
v_cvt_pk_bf16_f32 v235, v38, v39
buffer_store_dwordx4 v[232:235], v22, s[48:51], s98 offen offset:0 sc1
v_pk_mul_f32 v[224:225], v[40:41], v[40:41]
v_pk_mul_f32 v[226:227], v[42:43], v[42:43]
v_pk_mul_f32 v[228:229], v[44:45], v[44:45]
v_pk_mul_f32 v[230:231], v[46:47], v[46:47]
v_pk_fma_f32 v[224:225], v[224:225], v[28:29], v[24:25] op_sel_hi:[1,0,0]
v_pk_fma_f32 v[226:227], v[226:227], v[28:29], v[24:25] op_sel_hi:[1,0,0]
v_pk_fma_f32 v[228:229], v[228:229], v[28:29], v[24:25] op_sel_hi:[1,0,0]
v_pk_fma_f32 v[230:231], v[230:231], v[28:29], v[24:25] op_sel_hi:[1,0,0]
v_pk_mul_f32 v[224:225], v[224:225], v[40:41]
v_pk_mul_f32 v[226:227], v[226:227], v[42:43]
v_pk_mul_f32 v[228:229], v[228:229], v[44:45]
v_pk_mul_f32 v[230:231], v[230:231], v[46:47]
v_exp_f32 v224, v224
v_exp_f32 v225, v225
v_exp_f32 v226, v226
v_exp_f32 v227, v227
v_exp_f32 v228, v228
v_exp_f32 v229, v229
v_exp_f32 v230, v230
v_exp_f32 v231, v231
v_pk_fma_f32 v[224:225], v[224:225], v[30:31], v[30:31] op_sel_hi:[1,0,0]
v_pk_fma_f32 v[226:227], v[226:227], v[30:31], v[30:31] op_sel_hi:[1,0,0]
v_pk_fma_f32 v[228:229], v[228:229], v[30:31], v[30:31] op_sel_hi:[1,0,0]
v_pk_fma_f32 v[230:231], v[230:231], v[30:31], v[30:31] op_sel_hi:[1,0,0]
v_rcp_f32 v224, v224
v_rcp_f32 v225, v225
v_rcp_f32 v226, v226
v_rcp_f32 v227, v227
v_rcp_f32 v228, v228
v_rcp_f32 v229, v229
v_rcp_f32 v230, v230
v_rcp_f32 v231, v231
v_pk_mul_f32 v[40:41], v[40:41], v[224:225]
v_pk_mul_f32 v[42:43], v[42:43], v[226:227]
v_pk_mul_f32 v[44:45], v[44:45], v[228:229]
v_pk_mul_f32 v[46:47], v[46:47], v[230:231]
v_cvt_pk_bf16_f32 v236, v40, v41
v_cvt_pk_bf16_f32 v237, v42, v43
v_cvt_pk_bf16_f32 v238, v44, v45
v_cvt_pk_bf16_f32 v239, v46, v47
buffer_store_dwordx4 v[236:239], v22, s[48:51], s98 offen offset:1024 sc1
v_cndmask_b32 v248, 0, v7, s[96:97]
v_mul_f32 v24, 0xc0135761, v248
v_mul_f32 v28, v248, v248
v_rcp_f32 v30, v248
v_mul_f32 v28, v28, v248
v_mul_f32 v28, 0xbdd2d3e8, v28
v_pk_mul_f32 v[224:225], v[48:49], v[48:49]
v_pk_mul_f32 v[226:227], v[50:51], v[50:51]
v_pk_mul_f32 v[228:229], v[52:53], v[52:53]
v_pk_mul_f32 v[230:231], v[54:55], v[54:55]
v_pk_fma_f32 v[224:225], v[224:225], v[28:29], v[24:25] op_sel_hi:[1,0,0]
v_pk_fma_f32 v[226:227], v[226:227], v[28:29], v[24:25] op_sel_hi:[1,0,0]
v_pk_fma_f32 v[228:229], v[228:229], v[28:29], v[24:25] op_sel_hi:[1,0,0]
v_pk_fma_f32 v[230:231], v[230:231], v[28:29], v[24:25] op_sel_hi:[1,0,0]
v_pk_mul_f32 v[224:225], v[224:225], v[48:49]
v_pk_mul_f32 v[226:227], v[226:227], v[50:51]
v_pk_mul_f32 v[228:229], v[228:229], v[52:53]
v_pk_mul_f32 v[230:231], v[230:231], v[54:55]
v_exp_f32 v224, v224
v_exp_f32 v225, v225
v_exp_f32 v226, v226
v_exp_f32 v227, v227
v_exp_f32 v228, v228
v_exp_f32 v229, v229
v_exp_f32 v230, v230
v_exp_f32 v231, v231
v_pk_fma_f32 v[224:225], v[224:225], v[30:31], v[30:31] op_sel_hi:[1,0,0]
v_pk_fma_f32 v[226:227], v[226:227], v[30:31], v[30:31] op_sel_hi:[1,0,0]
v_pk_fma_f32 v[228:229], v[228:229], v[30:31], v[30:31] op_sel_hi:[1,0,0]
v_pk_fma_f32 v[230:231], v[230:231], v[30:31], v[30:31] op_sel_hi:[1,0,0]
v_rcp_f32 v224, v224
v_rcp_f32 v225, v225
v_rcp_f32 v226, v226
v_rcp_f32 v227, v227
v_rcp_f32 v228, v228
v_rcp_f32 v229, v229
v_rcp_f32 v230, v230
v_rcp_f32 v231, v231
v_pk_mul_f32 v[48:49], v[48:49], v[224:225]
v_pk_mul_f32 v[50:51], v[50:51], v[226:227]
v_pk_mul_f32 v[52:53], v[52:53], v[228:229]
v_pk_mul_f32 v[54:55], v[54:55], v[230:231]
v_cvt_pk_bf16_f32 v240, v48, v49
v_cvt_pk_bf16_f32 v241, v50, v51
v_cvt_pk_bf16_f32 v242, v52, v53
v_cvt_pk_bf16_f32 v243, v54, v55
buffer_store_dwordx4 v[240:243], v23, s[48:51], s99 offen offset:0 sc1
v_pk_mul_f32 v[224:225], v[56:57], v[56:57]
v_pk_mul_f32 v[226:227], v[58:59], v[58:59]
v_pk_mul_f32 v[228:229], v[60:61], v[60:61]
v_pk_mul_f32 v[230:231], v[62:63], v[62:63]
v_pk_fma_f32 v[224:225], v[224:225], v[28:29], v[24:25] op_sel_hi:[1,0,0]
v_pk_fma_f32 v[226:227], v[226:227], v[28:29], v[24:25] op_sel_hi:[1,0,0]
v_pk_fma_f32 v[228:229], v[228:229], v[28:29], v[24:25] op_sel_hi:[1,0,0]
v_pk_fma_f32 v[230:231], v[230:231], v[28:29], v[24:25] op_sel_hi:[1,0,0]
v_pk_mul_f32 v[224:225], v[224:225], v[56:57]
v_pk_mul_f32 v[226:227], v[226:227], v[58:59]
v_pk_mul_f32 v[228:229], v[228:229], v[60:61]
v_pk_mul_f32 v[230:231], v[230:231], v[62:63]
v_exp_f32 v224, v224
v_exp_f32 v225, v225
v_exp_f32 v226, v226
v_exp_f32 v227, v227
v_exp_f32 v228, v228
v_exp_f32 v229, v229
v_exp_f32 v230, v230
v_exp_f32 v231, v231
v_pk_fma_f32 v[224:225], v[224:225], v[30:31], v[30:31] op_sel_hi:[1,0,0]
v_pk_fma_f32 v[226:227], v[226:227], v[30:31], v[30:31] op_sel_hi:[1,0,0]
v_pk_fma_f32 v[228:229], v[228:229], v[30:31], v[30:31] op_sel_hi:[1,0,0]
v_pk_fma_f32 v[230:231], v[230:231], v[30:31], v[30:31] op_sel_hi:[1,0,0]
v_rcp_f32 v224, v224
v_rcp_f32 v225, v225
v_rcp_f32 v226, v226
v_rcp_f32 v227, v227
v_rcp_f32 v228, v228
v_rcp_f32 v229, v229
v_rcp_f32 v230, v230
v_rcp_f32 v231, v231
v_pk_mul_f32 v[56:57], v[56:57], v[224:225]
v_pk_mul_f32 v[58:59], v[58:59], v[226:227]
v_pk_mul_f32 v[60:61], v[60:61], v[228:229]
v_pk_mul_f32 v[62:63], v[62:63], v[230:231]
v_cvt_pk_bf16_f32 v244, v56, v57
v_cvt_pk_bf16_f32 v245, v58, v59
v_cvt_pk_bf16_f32 v246, v60, v61
v_cvt_pk_bf16_f32 v247, v62, v63
buffer_store_dwordx4 v[244:247], v23, s[48:51], s99 offen offset:1024 sc1
v_lshlrev_b32 v248, 2, v3
v_lshl_add_u32 v248, v2, 13, v248
s_mov_b32 vcc_lo, -1
s_mov_b32 vcc_hi, 0
s_lshl_b32 s11, s62, 7
s_add_u32 s11, s11, 21299200
s_cmp_eq_u32 s61, 0
s_cselect_b32 s11, s11, 0x7f000000
v_cndmask_b32 v249, v4, v20, vcc
buffer_store_dword v249, v248, s[48:51], s11 offen sc1
v_add_u32 v16, 81920, v16
v_add_u32 v17, 81920, v17
v_add_u32 v18, 81920, v18
v_add_u32 v19, 81920, v19
v_add_u32 v28, s7, v16
v_add_u32 v29, s7, v17
v_add_u32 v30, s7, v18
v_add_u32 v31, s7, v19
s_waitcnt vmcnt(5)
s_mov_b32 s10, 0x20000
L_nonce1:
v_readfirstlane_b32 s8, v252
v_readfirstlane_b32 s9, v253
s_nop 0
s_cmp_lg_u32 s8, 0
s_cbranch_scc1 L_nonce1x
buffer_load_dwordx2 v[252:253], off, s[56:59], 0 sc1
s_sub_u32 s10, s10, 1
s_waitcnt vmcnt(0)
s_cbranch_scc0 L_nonce1
L_nonce1x:
s_barrier
ds_read_b64_tr_b16 v[224:225], v16 offset:0
ds_read_b64_tr_b16 v[226:227], v16 offset:512
ds_read_b64_tr_b16 v[228:229], v17 offset:0
ds_read_b64_tr_b16 v[230:231], v17 offset:512
ds_read_b64_tr_b16 v[232:233], v16 offset:2048
ds_read_b64_tr_b16 v[234:235], v16 offset:2560
ds_read_b64_tr_b16 v[236:237], v17 offset:2048
ds_read_b64_tr_b16 v[238:239], v17 offset:2560
s_waitcnt lgkmcnt(4)
v_mfma_f32_32x32x16_bf16 v[32:47], v[224:227], v[64:67], 0
ds_read_b64_tr_b16 v[240:241], v16 offset:4096
ds_read_b64_tr_b16 v[242:243], v16 offset:4608
ds_read_b64_tr_b16 a[132:133], v28 offset:0
ds_read_b64_tr_b16 a[134:135], v28 offset:512
v_min_u32 v248, 19, v3
v_mfma_f32_32x32x16_bf16 v[48:63], v[228:231], v[64:67], 0
ds_read_b64_tr_b16 v[244:245], v17 offset:4096
ds_read_b64_tr_b16 v[246:247], v17 offset:4608
ds_read_b64_tr_b16 a[136:137], v29 offset:0
ds_read_b64_tr_b16 a[138:139], v29 offset:512
v_lshrrev_b32 v249, 1, v248
s_waitcnt lgkmcnt(8)
v_mfma_f32_32x32x16_bf16 v[32:47], v[232:235], v[68:71], v[32:47]
ds_read_b64_tr_b16 v[224:225], v16 offset:6144
ds_read_b64_tr_b16 v[226:227], v16 offset:6656
v_and_b32 v248, 1, v248
v_mul_u32_u24 v249, 3072, v249
v_lshl_add_u32 v248, v248, 7, v249
v_mfma_f32_32x32x16_bf16 v[48:63], v[236:239], v[68:71], v[48:63]
ds_read_b64_tr_b16 v[228:229], v17 offset:6144
ds_read_b64_tr_b16 v[230:231], v17 offset:6656
s_mul_i32 s11, s62, 30720
s_lshl_b32 s12, s63, 8
s_add_u32 s11, s11, s12
s_waitcnt lgkmcnt(6)
v_mfma_f32_32x32x16_bf16 v[32:47], v[240:243], v[72:75], v[32:47]
ds_read_b64_tr_b16 v[232:233], v16 offset:8192
ds_read_b64_tr_b16 v[234:235], v16 offset:8704
v_add_u32 v248, s11, v248
v_lshl_add_u32 v248, v2, 8, v248
global_load_dword a99, v248, s[28:29]
v_mfma_f32_32x32x16_bf16 v[48:63], v[244:247], v[72:75], v[48:63]
ds_read_b64_tr_b16 v[236:237], v17 offset:8192
ds_read_b64_tr_b16 v[238:239], v17 offset:8704
v_lshlrev_b32 v11, 7, v3
s_mov_b32 s15, 22740992
s_mul_i32 s23, s24, 5120
s_waitcnt lgkmcnt(4)
v_mfma_f32_32x32x16_bf16 v[32:47], v[224:227], v[76:79], v[32:47]
ds_read_b64_tr_b16 v[240:241], v16 offset:10240
ds_read_b64_tr_b16 v[242:243], v16 offset:10752
v_lshl_add_u32 v22, v1, 4, s23
v_add_u32 v23, 4096, v22
v_mfma_f32_32x32x16_bf16 v[48:63], v[228:231], v[76:79], v[48:63]
ds_read_b64_tr_b16 v[244:245], v17 offset:10240
ds_read_b64_tr_b16 v[246:247], v17 offset:10752
v_lshl_add_u32 v8, v1, 4, s68
v_lshrrev_b32 v248, 4, v1
v_min_u32 v248, 2, v248
v_mfma_f32_16x16x32_bf16 a[116:119], a[128:131], a[132:135], 0
v_mfma_f32_16x16x32_bf16 a[120:123], a[128:131], a[136:139], 0
s_waitcnt lgkmcnt(4)
v_mfma_f32_32x32x16_bf16 v[32:47], v[232:235], v[80:83], v[32:47]
ds_read_b64_tr_b16 v[224:225], v16 offset:12288
ds_read_b64_tr_b16 v[226:227], v16 offset:12800
ds_read_b64_tr_b16 a[132:133], v28 offset:8192
ds_read_b64_tr_b16 a[134:135], v28 offset:8704
s_sub_u32 s11, s62, 1
v_mfma_f32_32x32x16_bf16 v[48:63], v[236:239], v[80:83], v[48:63]
ds_read_b64_tr_b16 v[228:229], v17 offset:12288
ds_read_b64_tr_b16 v[230:231], v17 offset:12800
ds_read_b64_tr_b16 a[136:137], v29 offset:8192
ds_read_b64_tr_b16 a[138:139], v29 offset:8704
v_add_u32 v248, s11, v248
s_waitcnt lgkmcnt(8)
v_mfma_f32_32x32x16_bf16 v[32:47], v[240:243], v[84:87], v[32:47]
ds_read_b64_tr_b16 v[232:233], v16 offset:14336
ds_read_b64_tr_b16 v[234:235], v16 offset:14848
v_and_b32 v248, 63, v248
v_and_b32 v249, 15, v1
v_min_u32 v249, 9, v249
v_mfma_f32_32x32x16_bf16 v[48:63], v[244:247], v[84:87], v[48:63]
ds_read_b64_tr_b16 v[236:237], v17 offset:14336
ds_read_b64_tr_b16 v[238:239], v17 offset:14848
s_add_u32 m0, s66, 0
s_nop 0
buffer_load_dwordx4 v12, s[44:47], s73 offen offset:0 lds
v_lshlrev_b32 v249, 8, v249
s_waitcnt lgkmcnt(6)
v_mfma_f32_32x32x16_bf16 v[32:47], v[224:227], v[88:91], v[32:47]
ds_read_b64_tr_b16 v[240:241], v16 offset:16384
ds_read_b64_tr_b16 v[242:243], v16 offset:16896
v_lshl_add_u32 v9, v248, 12, v249
s_mov_b32 s70, 22151168
v_lshlrev_b32 v10, 9, v2
v_mfma_f32_32x32x16_bf16 v[48:63], v[228:231], v[88:91], v[48:63]
ds_read_b64_tr_b16 v[244:245], v17 offset:16384
ds_read_b64_tr_b16 v[246:247], v17 offset:16896
buffer_load_dwordx4 v13, s[44:47], s73 offen offset:1024 lds
v_add_u32 v10, 81920, v10
s_waitcnt lgkmcnt(4)
v_mfma_f32_32x32x16_bf16 v[32:47], v[232:235], v[92:95], v[32:47]
ds_read_b64_tr_b16 v[224:225], v16 offset:18432
ds_read_b64_tr_b16 v[226:227], v16 offset:18944
s_lshl_b32 s83, s83, 5
s_lshl_b32 s84, s84, 5
s_lshl_b32 s85, s85, 5
v_mfma_f32_32x32x16_bf16 v[48:63], v[236:239], v[92:95], v[48:63]
ds_read_b64_tr_b16 v[228:229], v17 offset:18432
ds_read_b64_tr_b16 v[230:231], v17 offset:18944
buffer_load_dwordx4 v14, s[44:47], s73 offen offset:2048 lds
s_lshl_b32 s86, s86, 5
v_mfma_f32_16x16x32_bf16 a[116:119], a[128:131], a[132:135], a[116:119]
v_mfma_f32_16x16x32_bf16 a[120:123], a[128:131], a[136:139], a[120:123]
s_waitcnt lgkmcnt(4)
v_mfma_f32_32x32x16_bf16 v[32:47], v[240:243], v[96:99], v[32:47]
ds_read_b64_tr_b16 v[232:233], v16 offset:20480
ds_read_b64_tr_b16 v[234:235], v16 offset:20992
ds_read_b64_tr_b16 a[132:133], v28 offset:16384
ds_read_b64_tr_b16 a[134:135], v28 offset:16896
s_lshl_b32 s87, s87, 5
v_mfma_f32_32x32x16_bf16 v[48:63], v[244:247], v[96:99], v[48:63]
ds_read_b64_tr_b16 v[236:237], v17 offset:20480
ds_read_b64_tr_b16 v[238:239], v17 offset:20992
ds_read_b64_tr_b16 a[136:137], v29 offset:16384
ds_read_b64_tr_b16 a[138:139], v29 offset:16896
buffer_load_dwordx4 v15, s[44:47], s73 offen offset:3072 lds
s_waitcnt lgkmcnt(8)
v_mfma_f32_32x32x16_bf16 v[32:47], v[224:227], v[100:103], v[32:47]
ds_read_b64_tr_b16 v[240:241], v16 offset:22528
ds_read_b64_tr_b16 v[242:243], v16 offset:23040
s_lshl_b32 s88, s88, 5
s_lshl_b32 s89, s89, 5
s_lshl_b32 s90, s90, 5
v_mfma_f32_32x32x16_bf16 v[48:63], v[228:231], v[100:103], v[48:63]
ds_read_b64_tr_b16 v[244:245], v17 offset:22528
ds_read_b64_tr_b16 v[246:247], v17 offset:23040
s_waitcnt vmcnt(5)
s_mov_b64 exec, 0xffff
buffer_store_dwordx2 v[252:253], v254, s[48:51], s72 offen sc1
s_mov_b64 exec, -1
s_waitcnt lgkmcnt(6)
v_mfma_f32_32x32x16_bf16 v[32:47], v[232:235], v[104:107], v[32:47]
ds_read_b64_tr_b16 v[224:225], v16 offset:24576
ds_read_b64_tr_b16 v[226:227], v16 offset:25088
s_lshl_b32 s91, s91, 5
s_lshl_b32 s92, s92, 5
v_mfma_f32_32x32x16_bf16 v[48:63], v[236:239], v[104:107], v[48:63]
ds_read_b64_tr_b16 v[228:229], v17 offset:24576
ds_read_b64_tr_b16 v[230:231], v17 offset:25088
s_add_u32 m0, s66, 4096
s_nop 0
buffer_load_dwordx4 v12, s[44:47], s74 offen offset:0 lds
v_accvgpr_read_b32 v65, a100
s_waitcnt lgkmcnt(4)
v_mfma_f32_32x32x16_bf16 v[32:47], v[240:243], v[108:111], v[32:47]
ds_read_b64_tr_b16 v[232:233], v16 offset:26624
ds_read_b64_tr_b16 v[234:235], v16 offset:27136
v_lshlrev_b32 v64, 16, v65
v_and_b32 v65, 0xffff0000, v65
v_fma_f32 v64, v64, v4, -v6
v_mfma_f32_32x32x16_bf16 v[48:63], v[244:247], v[108:111], v[48:63]
ds_read_b64_tr_b16 v[236:237], v17 offset:26624
ds_read_b64_tr_b16 v[238:239], v17 offset:27136
buffer_load_dwordx4 v13, s[44:47], s74 offen offset:1024 lds
v_fma_f32 v65, v65, v4, -v6
v_mfma_f32_16x16x32_bf16 a[116:119], a[128:131], a[132:135], a[116:119]
v_mfma_f32_16x16x32_bf16 a[120:123], a[128:131], a[136:139], a[120:123]
s_waitcnt lgkmcnt(4)
v_mfma_f32_32x32x16_bf16 v[32:47], v[224:227], v[112:115], v[32:47]
ds_read_b64_tr_b16 v[240:241], v16 offset:28672
ds_read_b64_tr_b16 v[242:243], v16 offset:29184
ds_read_b64_tr_b16 a[132:133], v28 offset:24576
ds_read_b64_tr_b16 a[134:135], v28 offset:25088
v_accvgpr_read_b32 v67, a101
v_mfma_f32_32x32x16_bf16 v[48:63], v[228:231], v[112:115], v[48:63]
ds_read_b64_tr_b16 v[244:245], v17 offset:28672
ds_read_b64_tr_b16 v[246:247], v17 offset:29184
ds_read_b64_tr_b16 a[136:137], v29 offset:24576
ds_read_b64_tr_b16 a[138:139], v29 offset:25088
buffer_load_dwordx4 v14, s[44:47], s74 offen offset:2048 lds
s_waitcnt lgkmcnt(8)
v_mfma_f32_32x32x16_bf16 v[32:47], v[232:235], v[116:119], v[32:47]
ds_read_b64_tr_b16 v[224:225], v16 offset:30720
ds_read_b64_tr_b16 v[226:227], v16 offset:31232
v_lshlrev_b32 v66, 16, v67
v_and_b32 v67, 0xffff0000, v67
v_fma_f32 v66, v66, v4, -v6
v_mfma_f32_32x32x16_bf16 v[48:63], v[236:239], v[116:119], v[48:63]
ds_read_b64_tr_b16 v[228:229], v17 offset:30720
ds_read_b64_tr_b16 v[230:231], v17 offset:31232
buffer_load_dwordx4 v15, s[44:47], s74 offen offset:3072 lds
v_fma_f32 v67, v67, v4, -v6
s_waitcnt lgkmcnt(6)
v_mfma_f32_32x32x16_bf16 v[32:47], v[240:243], v[120:123], v[32:47]
ds_read_b64_tr_b16 v[232:233], v16 offset:32768
ds_read_b64_tr_b16 v[234:235], v16 offset:33280
v_accvgpr_read_b32 v69, a102
v_lshlrev_b32 v68, 16, v69
v_and_b32 v69, 0xffff0000, v69
v_mfma_f32_32x32x16_bf16 v[48:63], v[244:247], v[120:123], v[48:63]
ds_read_b64_tr_b16 v[236:237], v17 offset:32768
ds_read_b64_tr_b16 v[238:239], v17 offset:33280
s_add_u32 m0, s66, 8192
s_nop 0
buffer_load_dwordx4 v12, s[44:47], s75 offen offset:0 lds
v_fma_f32 v68, v68, v4, -v6
s_waitcnt lgkmcnt(4)
v_mfma_f32_32x32x16_bf16 v[32:47], v[224:227], v[124:127], v[32:47]
ds_read_b64_tr_b16 v[240:241], v16 offset:34816
ds_read_b64_tr_b16 v[242:243], v16 offset:35328
s_mov_b32 s97, s93
s_mov_b32 s93, s36
s_mov_b32 s94, s37
v_mfma_f32_32x32x16_bf16 v[48:63], v[228:231], v[124:127], v[48:63]
ds_read_b64_tr_b16 v[244:245], v17 offset:34816
ds_read_b64_tr_b16 v[246:247], v17 offset:35328
buffer_load_dwordx4 v13, s[44:47], s75 offen offset:1024 lds
s_mov_b32 s95, s38
v_mfma_f32_16x16x32_bf16 a[116:119], a[128:131], a[132:135], a[116:119]
v_mfma_f32_16x16x32_bf16 a[120:123], a[128:131], a[136:139], a[120:123]
s_waitcnt lgkmcnt(4)
v_mfma_f32_32x32x16_bf16 v[32:47], v[232:235], v[128:131], v[32:47]
ds_read_b64_tr_b16 v[224:225], v16 offset:36864
ds_read_b64_tr_b16 v[226:227], v16 offset:37376
ds_read_b64_tr_b16 a[132:133], v28 offset:32768
ds_read_b64_tr_b16 a[134:135], v28 offset:33280
s_mov_b32 s96, s39
v_mfma_f32_32x32x16_bf16 v[48:63], v[236:239], v[128:131], v[48:63]
ds_read_b64_tr_b16 v[228:229], v17 offset:36864
ds_read_b64_tr_b16 v[230:231], v17 offset:37376
ds_read_b64_tr_b16 a[136:137], v29 offset:32768
ds_read_b64_tr_b16 a[138:139], v29 offset:33280
buffer_load_dwordx4 v14, s[44:47], s75 offen offset:2048 lds
s_waitcnt lgkmcnt(8)
v_mfma_f32_32x32x16_bf16 v[32:47], v[240:243], v[132:135], v[32:47]
ds_read_b64_tr_b16 v[232:233], v16 offset:38912
ds_read_b64_tr_b16 v[234:235], v16 offset:39424
s_mov_b32 s52, s28
s_mov_b32 s53, s29
s_mov_b32 s54, 1966080
v_mfma_f32_32x32x16_bf16 v[48:63], v[244:247], v[132:135], v[48:63]
ds_read_b64_tr_b16 v[236:237], v17 offset:38912
ds_read_b64_tr_b16 v[238:239], v17 offset:39424
buffer_load_dwordx4 v15, s[44:47], s75 offen offset:3072 lds
s_lshl_b32 s99, s3, 12
s_waitcnt lgkmcnt(6)
v_mfma_f32_32x32x16_bf16 v[32:47], v[224:227], v[136:139], v[32:47]
ds_read_b64_tr_b16 v[240:241], v16 offset:40960
ds_read_b64_tr_b16 v[242:243], v16 offset:41472
v_lshrrev_b32 v248, 3, v1
v_mul_u32_u24 v248, 3072, v248
v_lshrrev_b32 v249, 2, v1
v_mfma_f32_32x32x16_bf16 v[48:63], v[228:231], v[136:139], v[48:63]
ds_read_b64_tr_b16 v[244:245], v17 offset:40960
ds_read_b64_tr_b16 v[246:247], v17 offset:41472
s_add_u32 m0, s66, 12288
s_nop 0
buffer_load_dwordx4 v12, s[44:47], s76 offen offset:0 lds
v_and_b32 v249, 4, v249
s_waitcnt lgkmcnt(4)
v_mfma_f32_32x32x16_bf16 v[32:47], v[232:235], v[140:143], v[32:47]
ds_read_b64_tr_b16 v[224:225], v16 offset:43008
ds_read_b64_tr_b16 v[226:227], v16 offset:43520
v_and_b32 v250, 7, v1
v_xor_b32 v249, v249, v250
v_lshl_add_u32 v120, v249, 4, v248
v_mfma_f32_32x32x16_bf16 v[48:63], v[236:239], v[140:143], v[48:63]
ds_read_b64_tr_b16 v[228:229], v17 offset:43008
ds_read_b64_tr_b16 v[230:231], v17 offset:43520
buffer_load_dwordx4 v13, s[44:47], s76 offen offset:1024 lds
v_add_u32 v121, 23552, v120
v_mfma_f32_16x16x32_bf16 a[116:119], a[128:131], a[132:135], a[116:119]
v_mfma_f32_16x16x32_bf16 a[120:123], a[128:131], a[136:139], a[120:123]
s_waitcnt lgkmcnt(4)
v_mfma_f32_32x32x16_bf16 v[32:47], v[240:243], v[144:147], v[32:47]
ds_read_b64_tr_b16 v[232:233], v16 offset:45056
ds_read_b64_tr_b16 v[234:235], v16 offset:45568
ds_read_b64_tr_b16 a[132:133], v28 offset:40960
ds_read_b64_tr_b16 a[134:135], v28 offset:41472
v_add_u32 v122, 47104, v120
v_mfma_f32_32x32x16_bf16 v[48:63], v[244:247], v[144:147], v[48:63]
ds_read_b64_tr_b16 v[236:237], v17 offset:45056
ds_read_b64_tr_b16 v[238:239], v17 offset:45568
ds_read_b64_tr_b16 a[136:137], v29 offset:40960
ds_read_b64_tr_b16 a[138:139], v29 offset:41472
buffer_load_dwordx4 v14, s[44:47], s76 offen offset:2048 lds
s_waitcnt lgkmcnt(8)
v_mfma_f32_32x32x16_bf16 v[32:47], v[224:227], v[148:151], v[32:47]
ds_read_b64_tr_b16 v[240:241], v16 offset:47104
ds_read_b64_tr_b16 v[242:243], v16 offset:47616
v_add_u32 v123, 70656, v120
v_mfma_f32_32x32x16_bf16 v[48:63], v[228:231], v[148:151], v[48:63]
ds_read_b64_tr_b16 v[244:245], v17 offset:47104
ds_read_b64_tr_b16 v[246:247], v17 offset:47616
buffer_load_dwordx4 v15, s[44:47], s76 offen offset:3072 lds
v_fma_f32 v69, v69, v4, -v6
s_waitcnt lgkmcnt(6)
v_mfma_f32_32x32x16_bf16 v[32:47], v[232:235], v[152:155], v[32:47]
ds_read_b64_tr_b16 v[224:225], v16 offset:49152
ds_read_b64_tr_b16 v[226:227], v16 offset:49664
v_accvgpr_read_b32 v71, a103
v_lshlrev_b32 v70, 16, v71
v_and_b32 v71, 0xffff0000, v71
v_mfma_f32_32x32x16_bf16 v[48:63], v[236:239], v[152:155], v[48:63]
ds_read_b64_tr_b16 v[228:229], v17 offset:49152
ds_read_b64_tr_b16 v[230:231], v17 offset:49664
s_add_u32 m0, s66, 16384
s_nop 0
buffer_load_dwordx4 v12, s[44:47], s77 offen offset:0 lds
v_fma_f32 v70, v70, v4, -v6
s_waitcnt lgkmcnt(4)
v_mfma_f32_32x32x16_bf16 v[32:47], v[240:243], v[156:159], v[32:47]
ds_read_b64_tr_b16 v[232:233], v16 offset:51200
ds_read_b64_tr_b16 v[234:235], v16 offset:51712
v_fma_f32 v71, v71, v4, -v6
v_accvgpr_read_b32 v73, a104
v_lshlrev_b32 v72, 16, v73
v_mfma_f32_32x32x16_bf16 v[48:63], v[244:247], v[156:159], v[48:63]
ds_read_b64_tr_b16 v[236:237], v17 offset:51200
ds_read_b64_tr_b16 v[238:239], v17 offset:51712
buffer_load_dwordx4 v13, s[44:47], s77 offen offset:1024 lds
v_and_b32 v73, 0xffff0000, v73
v_mfma_f32_16x16x32_bf16 a[116:119], a[128:131], a[132:135], a[116:119]
v_mfma_f32_16x16x32_bf16 a[120:123], a[128:131], a[136:139], a[120:123]
s_waitcnt lgkmcnt(4)
v_mfma_f32_32x32x16_bf16 v[32:47], v[224:227], v[160:163], v[32:47]
ds_read_b64_tr_b16 v[240:241], v16 offset:53248
ds_read_b64_tr_b16 v[242:243], v16 offset:53760
ds_read_b64_tr_b16 a[132:133], v28 offset:49152
ds_read_b64_tr_b16 a[134:135], v28 offset:49664
v_fma_f32 v72, v72, v4, -v6
v_mfma_f32_32x32x16_bf16 v[48:63], v[228:231], v[160:163], v[48:63]
ds_read_b64_tr_b16 v[244:245], v17 offset:53248
ds_read_b64_tr_b16 v[246:247], v17 offset:53760
ds_read_b64_tr_b16 a[136:137], v29 offset:49152
ds_read_b64_tr_b16 a[138:139], v29 offset:49664
buffer_load_dwordx4 v14, s[44:47], s77 offen offset:2048 lds
s_waitcnt lgkmcnt(8)
v_mfma_f32_32x32x16_bf16 v[32:47], v[232:235], v[164:167], v[32:47]
ds_read_b64_tr_b16 v[224:225], v16 offset:55296
ds_read_b64_tr_b16 v[226:227], v16 offset:55808
s_barrier
v_fma_f32 v73, v73, v4, -v6
v_accvgpr_read_b32 v75, a105
v_mfma_f32_32x32x16_bf16 v[48:63], v[236:239], v[164:167], v[48:63]
ds_read_b64_tr_b16 v[228:229], v17 offset:55296
ds_read_b64_tr_b16 v[230:231], v17 offset:55808
buffer_load_dwordx4 v15, s[44:47], s77 offen offset:3072 lds
v_lshlrev_b32 v74, 16, v75
s_waitcnt lgkmcnt(6)
v_mfma_f32_32x32x16_bf16 v[32:47], v[240:243], v[168:171], v[32:47]
ds_read_b64_tr_b16 v[232:233], v16 offset:57344
ds_read_b64_tr_b16 v[234:235], v16 offset:57856
v_and_b32 v75, 0xffff0000, v75
v_fma_f32 v74, v74, v4, -v6
v_fma_f32 v75, v75, v4, -v6
v_mfma_f32_32x32x16_bf16 v[48:63], v[244:247], v[168:171], v[48:63]
ds_read_b64_tr_b16 v[236:237], v17 offset:57344
ds_read_b64_tr_b16 v[238:239], v17 offset:57856
s_add_u32 m0, s99, 81920
s_nop 0
buffer_load_dwordx4 v120, s[52:55], s93 offen offset:0 lds
v_accvgpr_read_b32 v77, a106
s_waitcnt lgkmcnt(4)
v_mfma_f32_32x32x16_bf16 v[32:47], v[224:227], v[172:175], v[32:47]
ds_read_b64_tr_b16 v[240:241], v16 offset:59392
ds_read_b64_tr_b16 v[242:243], v16 offset:59904
v_lshlrev_b32 v76, 16, v77
v_and_b32 v77, 0xffff0000, v77
v_fma_f32 v76, v76, v4, -v6
v_mfma_f32_32x32x16_bf16 v[48:63], v[228:231], v[172:175], v[48:63]
ds_read_b64_tr_b16 v[244:245], v17 offset:59392
ds_read_b64_tr_b16 v[246:247], v17 offset:59904
buffer_load_dwordx4 v121, s[52:55], s93 offen offset:1024 lds
v_fma_f32 v77, v77, v4, -v6
v_mfma_f32_16x16x32_bf16 a[116:119], a[128:131], a[132:135], a[116:119]
v_mfma_f32_16x16x32_bf16 a[120:123], a[128:131], a[136:139], a[120:123]
s_waitcnt lgkmcnt(4)
v_mfma_f32_32x32x16_bf16 v[32:47], v[232:235], v[176:179], v[32:47]
ds_read_b64_tr_b16 v[224:225], v16 offset:61440
ds_read_b64_tr_b16 v[226:227], v16 offset:61952
ds_read_b64_tr_b16 a[132:133], v28 offset:57344
ds_read_b64_tr_b16 a[134:135], v28 offset:57856
v_accvgpr_read_b32 v79, a107
v_mfma_f32_32x32x16_bf16 v[48:63], v[236:239], v[176:179], v[48:63]
ds_read_b64_tr_b16 v[228:229], v17 offset:61440
ds_read_b64_tr_b16 v[230:231], v17 offset:61952
ds_read_b64_tr_b16 a[136:137], v29 offset:57344
ds_read_b64_tr_b16 a[138:139], v29 offset:57856
buffer_load_dwordx4 v122, s[52:55], s93 offen offset:2048 lds
s_waitcnt lgkmcnt(8)
v_mfma_f32_32x32x16_bf16 v[32:47], v[240:243], v[180:183], v[32:47]
ds_read_b64_tr_b16 v[232:233], v16 offset:63488
ds_read_b64_tr_b16 v[234:235], v16 offset:64000
buffer_load_dwordx2 v[20:21], v9, s[48:51], s70 offen sc1
v_lshlrev_b32 v78, 16, v79
v_mfma_f32_32x32x16_bf16 v[48:63], v[244:247], v[180:183], v[48:63]
ds_read_b64_tr_b16 v[236:237], v17 offset:63488
ds_read_b64_tr_b16 v[238:239], v17 offset:64000
buffer_load_dwordx4 v123, s[52:55], s93 offen offset:3072 lds
v_and_b32 v79, 0xffff0000, v79
s_waitcnt lgkmcnt(6)
v_mfma_f32_32x32x16_bf16 v[32:47], v[224:227], v[184:187], v[32:47]
ds_read_b64_tr_b16 v[240:241], v18 offset:0
ds_read_b64_tr_b16 v[242:243], v18 offset:512
v_fma_f32 v78, v78, v4, -v6
v_fma_f32 v79, v79, v4, -v6
v_accvgpr_read_b32 v81, a108
v_mfma_f32_32x32x16_bf16 v[48:63], v[228:231], v[184:187], v[48:63]
ds_read_b64_tr_b16 v[244:245], v19 offset:0
ds_read_b64_tr_b16 v[246:247], v19 offset:512
s_add_u32 m0, s99, 98304
s_nop 0
buffer_load_dwordx4 v120, s[52:55], s94 offen offset:0 lds
v_lshlrev_b32 v80, 16, v81
s_waitcnt lgkmcnt(4)
v_mfma_f32_32x32x16_bf16 v[32:47], v[232:235], v[188:191], v[32:47]
ds_read_b64_tr_b16 v[224:225], v18 offset:2048
ds_read_b64_tr_b16 v[226:227], v18 offset:2560
v_and_b32 v81, 0xffff0000, v81
v_fma_f32 v80, v80, v4, -v6
v_fma_f32 v81, v81, v4, -v6
v_mfma_f32_32x32x16_bf16 v[48:63], v[236:239], v[188:191], v[48:63]
ds_read_b64_tr_b16 v[228:229], v19 offset:2048
ds_read_b64_tr_b16 v[230:231], v19 offset:2560
buffer_load_dwordx4 v121, s[52:55], s94 offen offset:1024 lds
v_accvgpr_read_b32 v83, a109
v_mfma_f32_16x16x32_bf16 a[116:119], a[128:131], a[132:135], a[116:119]
v_mfma_f32_16x16x32_bf16 a[120:123], a[128:131], a[136:139], a[120:123]
s_waitcnt lgkmcnt(4)
v_mfma_f32_32x32x16_bf16 v[32:47], v[240:243], v[192:195], v[32:47]
ds_read_b64_tr_b16 v[232:233], v18 offset:4096
ds_read_b64_tr_b16 v[234:235], v18 offset:4608
ds_read_b64_tr_b16 a[132:133], v30 offset:0
ds_read_b64_tr_b16 a[134:135], v30 offset:512
v_lshlrev_b32 v82, 16, v83
v_mfma_f32_32x32x16_bf16 v[48:63], v[244:247], v[192:195], v[48:63]
ds_read_b64_tr_b16 v[236:237], v19 offset:4096
ds_read_b64_tr_b16 v[238:239], v19 offset:4608
ds_read_b64_tr_b16 a[136:137], v31 offset:0
ds_read_b64_tr_b16 a[138:139], v31 offset:512
buffer_load_dwordx4 v122, s[52:55], s94 offen offset:2048 lds
s_waitcnt lgkmcnt(8)
v_mfma_f32_32x32x16_bf16 v[32:47], v[224:227], v[196:199], v[32:47]
ds_read_b64_tr_b16 v[240:241], v18 offset:6144
ds_read_b64_tr_b16 v[242:243], v18 offset:6656
v_and_b32 v83, 0xffff0000, v83
v_fma_f32 v82, v82, v4, -v6
v_fma_f32 v83, v83, v4, -v6
v_mfma_f32_32x32x16_bf16 v[48:63], v[228:231], v[196:199], v[48:63]
ds_read_b64_tr_b16 v[244:245], v19 offset:6144
ds_read_b64_tr_b16 v[246:247], v19 offset:6656
buffer_load_dwordx4 v123, s[52:55], s94 offen offset:3072 lds
v_accvgpr_read_b32 v85, a110
s_waitcnt lgkmcnt(6)
v_mfma_f32_32x32x16_bf16 v[32:47], v[232:235], v[200:203], v[32:47]
ds_read_b64_tr_b16 v[224:225], v18 offset:8192
ds_read_b64_tr_b16 v[226:227], v18 offset:8704
s_waitcnt vmcnt(5)
v_cmp_ne_u64 vcc, s[8:9], v[20:21]
s_cbranch_vccz L_chk2x
s_mov_b32 s10, 0x20000
L_chk2:
buffer_load_dwordx2 v[20:21], v9, s[48:51], s70 offen sc1
s_sub_u32 s10, s10, 1
s_waitcnt vmcnt(0)
s_cbranch_scc1 L_chk2x
v_cmp_ne_u64 vcc, s[8:9], v[20:21]
s_cbranch_vccnz L_chk2
L_chk2x:
v_mfma_f32_32x32x16_bf16 v[48:63], v[236:239], v[200:203], v[48:63]
ds_read_b64_tr_b16 v[228:229], v19 offset:8192
ds_read_b64_tr_b16 v[230:231], v19 offset:8704
buffer_load_dwordx4 a[0:3], v8, s[48:51], s83 offen offset:0 sc1
v_lshlrev_b32 v84, 16, v85
s_waitcnt lgkmcnt(4)
v_mfma_f32_32x32x16_bf16 v[32:47], v[240:243], v[204:207], v[32:47]
ds_read_b64_tr_b16 v[232:233], v18 offset:10240
ds_read_b64_tr_b16 v[234:235], v18 offset:10752
buffer_load_dwordx4 a[4:7], v8, s[48:51], s83 offen offset:1024 sc1
v_and_b32 v85, 0xffff0000, v85
v_mfma_f32_32x32x16_bf16 v[48:63], v[244:247], v[204:207], v[48:63]
ds_read_b64_tr_b16 v[236:237], v19 offset:10240
ds_read_b64_tr_b16 v[238:239], v19 offset:10752
buffer_load_dwordx4 a[8:11], v8, s[48:51], s83 offen offset:2048 sc1
v_fma_f32 v84, v84, v4, -v6
v_mfma_f32_16x16x32_bf16 a[116:119], a[128:131], a[132:135], a[116:119]
v_mfma_f32_16x16x32_bf16 a[120:123], a[128:131], a[136:139], a[120:123]
s_waitcnt lgkmcnt(4)
v_mfma_f32_32x32x16_bf16 v[32:47], v[224:227], v[208:211], v[32:47]
ds_read_b64_tr_b16 v[240:241], v18 offset:12288
ds_read_b64_tr_b16 v[242:243], v18 offset:12800
ds_read_b64_tr_b16 a[132:133], v30 offset:8192
ds_read_b64_tr_b16 a[134:135], v30 offset:8704
buffer_load_dwordx4 a[12:15], v8, s[48:51], s83 offen offset:3072 sc1
v_mfma_f32_32x32x16_bf16 v[48:63], v[228:231], v[208:211], v[48:63]
ds_read_b64_tr_b16 v[244:245], v19 offset:12288
ds_read_b64_tr_b16 v[246:247], v19 offset:12800
ds_read_b64_tr_b16 a[136:137], v31 offset:8192
ds_read_b64_tr_b16 a[138:139], v31 offset:8704
buffer_load_dwordx4 a[16:19], v8, s[48:51], s84 offen offset:0 sc1
s_waitcnt lgkmcnt(8)
v_mfma_f32_32x32x16_bf16 v[32:47], v[232:235], v[212:215], v[32:47]
ds_read_b64_tr_b16 v[224:225], v18 offset:14336
ds_read_b64_tr_b16 v[226:227], v18 offset:14848
buffer_load_dwordx4 a[20:23], v8, s[48:51], s84 offen offset:1024 sc1
v_fma_f32 v85, v85, v4, -v6
v_mfma_f32_32x32x16_bf16 v[48:63], v[236:239], v[212:215], v[48:63]
ds_read_b64_tr_b16 v[228:229], v19 offset:14336
ds_read_b64_tr_b16 v[230:231], v19 offset:14848
buffer_load_dwordx4 a[24:27], v8, s[48:51], s84 offen offset:2048 sc1
v_accvgpr_read_b32 v87, a111
s_waitcnt lgkmcnt(6)
v_mfma_f32_32x32x16_bf16 v[32:47], v[240:243], v[216:219], v[32:47]
buffer_load_dwordx4 a[28:31], v8, s[48:51], s84 offen offset:3072 sc1
v_lshlrev_b32 v86, 16, v87
v_mfma_f32_32x32x16_bf16 v[48:63], v[244:247], v[216:219], v[48:63]
buffer_load_dwordx4 a[32:35], v8, s[48:51], s85 offen offset:0 sc1
v_and_b32 v87, 0xffff0000, v87
s_waitcnt lgkmcnt(0)
v_mfma_f32_32x32x16_bf16 v[32:47], v[224:227], v[220:223], v[32:47]
buffer_load_dwordx4 a[36:39], v8, s[48:51], s85 offen offset:1024 sc1
v_fma_f32 v86, v86, v4, -v6
v_mfma_f32_32x32x16_bf16 v[48:63], v[228:231], v[220:223], v[48:63]
buffer_load_dwordx4 a[40:43], v8, s[48:51], s85 offen offset:2048 sc1
v_fma_f32 v87, v87, v4, -v6
v_mfma_f32_16x16x32_bf16 a[116:119], a[128:131], a[132:135], a[116:119]
v_mfma_f32_16x16x32_bf16 a[120:123], a[128:131], a[136:139], a[120:123]
buffer_load_dwordx4 a[44:47], v8, s[48:51], s85 offen offset:3072 sc1
v_sub_u32 v16, v16, v10
v_sub_u32 v17, v17, v10
v_sub_u32 v18, v18, v10
v_sub_u32 v19, v19, v10
s_lshl_b32 s11, s3, 2
v_lshlrev_b32 v7, 4, v1
v_add_u32 v7, 114688, v7
v_add_u32 v250, s11, v7
ds_write_b32 v250, a116 offset:0
ds_write_b32 v250, a120 offset:1024
s_waitcnt lgkmcnt(0)
s_barrier
ds_read_b128 v[96:99], v7 offset:0
ds_read_b128 v[100:103], v7 offset:1024
ds_read_b64_tr_b16 v[224:225], v16 offset:0
ds_read_b64_tr_b16 v[226:227], v16 offset:1024
ds_read_b64_tr_b16 v[228:229], v17 offset:0
ds_read_b64_tr_b16 v[230:231], v17 offset:1024
ds_read_b64_tr_b16 v[232:233], v16 offset:2048
ds_read_b64_tr_b16 v[234:235], v16 offset:3072
ds_read_b64_tr_b16 v[236:237], v17 offset:2048
ds_read_b64_tr_b16 v[238:239], v17 offset:3072
s_waitcnt vmcnt(11) lgkmcnt(4)
v_mfma_f32_32x32x16_bf16 v[144:159], v[224:227], a[0:3], 0
ds_read_b64_tr_b16 v[240:241], v16 offset:4096
ds_read_b64_tr_b16 v[242:243], v16 offset:5120
v_accvgpr_read_b32 v89, a112
v_lshlrev_b32 v88, 16, v89
v_and_b32 v89, 0xffff0000, v89
v_fma_f32 v88, v88, v4, -v6
v_mfma_f32_32x32x16_bf16 v[160:175], v[228:231], a[0:3], 0
ds_read_b64_tr_b16 v[244:245], v17 offset:4096
ds_read_b64_tr_b16 v[246:247], v17 offset:5120
buffer_load_dwordx4 a[48:51], v8, s[48:51], s86 offen offset:0 sc1
v_fma_f32 v89, v89, v4, -v6
v_accvgpr_read_b32 v91, a113
v_lshlrev_b32 v90, 16, v91
s_waitcnt vmcnt(11) lgkmcnt(4)
v_mfma_f32_32x32x16_bf16 v[144:159], v[232:235], a[4:7], v[144:159]
ds_read_b64_tr_b16 v[224:225], v16 offset:6144
ds_read_b64_tr_b16 v[226:227], v16 offset:7168
v_and_b32 v91, 0xffff0000, v91
v_fma_f32 v90, v90, v4, -v6
v_fma_f32 v91, v91, v4, -v6
v_accvgpr_read_b32 v93, a114
v_mfma_f32_32x32x16_bf16 v[160:175], v[236:239], a[4:7], v[160:175]
ds_read_b64_tr_b16 v[228:229], v17 offset:6144
ds_read_b64_tr_b16 v[230:231], v17 offset:7168
buffer_load_dwordx4 a[52:55], v8, s[48:51], s86 offen offset:1024 sc1
v_lshlrev_b32 v92, 16, v93
v_and_b32 v93, 0xffff0000, v93
v_fma_f32 v92, v92, v4, -v6
s_waitcnt vmcnt(11) lgkmcnt(4)
v_mfma_f32_32x32x16_bf16 v[144:159], v[240:243], a[8:11], v[144:159]
ds_read_b64_tr_b16 v[232:233], v16 offset:8192
ds_read_b64_tr_b16 v[234:235], v16 offset:9216
v_fma_f32 v93, v93, v4, -v6
v_accvgpr_read_b32 v95, a115
v_lshlrev_b32 v94, 16, v95
v_and_b32 v95, 0xffff0000, v95
v_mfma_f32_32x32x16_bf16 v[160:175], v[244:247], a[8:11], v[160:175]
ds_read_b64_tr_b16 v[236:237], v17 offset:8192
ds_read_b64_tr_b16 v[238:239], v17 offset:9216
buffer_load_dwordx4 a[56:59], v8, s[48:51], s86 offen offset:2048 sc1
v_fma_f32 v94, v94, v4, -v6
v_fma_f32 v95, v95, v4, -v6
s_waitcnt vmcnt(11) lgkmcnt(4)
v_mfma_f32_32x32x16_bf16 v[144:159], v[224:227], a[12:15], v[144:159]
ds_read_b64_tr_b16 v[240:241], v16 offset:10240
ds_read_b64_tr_b16 v[242:243], v16 offset:11264
v_add_f32 v96, v96, v98
v_add_f32 v97, v97, v99
v_add_f32 v96, v96, v97
v_mfma_f32_32x32x16_bf16 v[160:175], v[228:231], a[12:15], v[160:175]
ds_read_b64_tr_b16 v[244:245], v17 offset:10240
ds_read_b64_tr_b16 v[246:247], v17 offset:11264
buffer_load_dwordx4 a[60:63], v8, s[48:51], s86 offen offset:3072 sc1
v_cvt_pk_bf16_f32 v104, v96, v96
v_and_b32 v248, 0xffff0000, v104
s_waitcnt vmcnt(11) lgkmcnt(4)
v_mfma_f32_32x32x16_bf16 v[144:159], v[232:235], a[16:19], v[144:159]
ds_read_b64_tr_b16 v[224:225], v16 offset:12288
ds_read_b64_tr_b16 v[226:227], v16 offset:13312
v_sub_f32 v248, v96, v248
v_cvt_pk_bf16_f32 v104, v96, v248
v_mov_b32 v105, v104
v_mfma_f32_32x32x16_bf16 v[160:175], v[236:239], a[16:19], v[160:175]
ds_read_b64_tr_b16 v[228:229], v17 offset:12288
ds_read_b64_tr_b16 v[230:231], v17 offset:13312
buffer_load_dwordx4 a[64:67], v8, s[48:51], s87 offen offset:0 sc1
v_add_f32 v100, v100, v102
v_add_f32 v101, v101, v103
s_waitcnt vmcnt(11) lgkmcnt(4)
v_mfma_f32_32x32x16_bf16 v[144:159], v[240:243], a[20:23], v[144:159]
ds_read_b64_tr_b16 v[232:233], v16 offset:14336
ds_read_b64_tr_b16 v[234:235], v16 offset:15360
v_add_f32 v100, v100, v101
v_cvt_pk_bf16_f32 v106, v100, v100
v_and_b32 v248, 0xffff0000, v106
v_mfma_f32_32x32x16_bf16 v[160:175], v[244:247], a[20:23], v[160:175]
ds_read_b64_tr_b16 v[236:237], v17 offset:14336
ds_read_b64_tr_b16 v[238:239], v17 offset:15360
buffer_load_dwordx4 a[68:71], v8, s[48:51], s87 offen offset:1024 sc1
v_sub_f32 v248, v100, v248
v_cvt_pk_bf16_f32 v106, v100, v248
s_waitcnt vmcnt(11) lgkmcnt(4)
v_mfma_f32_32x32x16_bf16 v[144:159], v[224:227], a[24:27], v[144:159]
ds_read_b64_tr_b16 v[240:241], v16 offset:16384
ds_read_b64_tr_b16 v[242:243], v16 offset:17408
v_mov_b32 v107, v106
s_mov_b32 s15, 0x358637bd
v_mul_f32 v24, 0x3fb8aa3b, v4
v_mfma_f32_32x32x16_bf16 v[160:175], v[228:231], a[24:27], v[160:175]
ds_read_b64_tr_b16 v[244:245], v17 offset:16384
ds_read_b64_tr_b16 v[246:247], v17 offset:17408
buffer_load_dwordx4 a[72:75], v8, s[48:51], s87 offen offset:2048 sc1
v_mfma_f32_32x32x8_bf16 v[32:47], v[104:105], v[26:27], v[32:47]
v_mfma_f32_32x32x8_bf16 v[48:63], v[106:107], v[26:27], v[48:63]
s_waitcnt vmcnt(11) lgkmcnt(4)
v_mfma_f32_32x32x16_bf16 v[144:159], v[232:235], a[28:31], v[144:159]
ds_read_b64_tr_b16 v[224:225], v16 offset:18432
ds_read_b64_tr_b16 v[226:227], v16 offset:19456
s_lshl_b32 s70, s61, 12
s_add_u32 s98, s70, 2621440
s_add_u32 s70, s70, 5242880
v_mfma_f32_32x32x16_bf16 v[160:175], v[236:239], a[28:31], v[160:175]
ds_read_b64_tr_b16 v[228:229], v17 offset:18432
ds_read_b64_tr_b16 v[230:231], v17 offset:19456
buffer_load_dwordx4 a[76:79], v8, s[48:51], s87 offen offset:3072 sc1
s_mul_i32 s71, s62, 2560
s_lshl_b32 s12, s61, 8
s_waitcnt vmcnt(11) lgkmcnt(4)
v_mfma_f32_32x32x16_bf16 v[144:159], v[240:243], a[32:35], v[144:159]
ds_read_b64_tr_b16 v[232:233], v16 offset:20480
ds_read_b64_tr_b16 v[234:235], v16 offset:21504
s_add_u32 s71, s71, s12
s_add_u32 s71, s71, 21757952
s_add_u32 s72, s72, 128
v_mfma_f32_32x32x16_bf16 v[160:175], v[244:247], a[32:35], v[160:175]
ds_read_b64_tr_b16 v[236:237], v17 offset:20480
ds_read_b64_tr_b16 v[238:239], v17 offset:21504
buffer_load_dwordx4 a[80:83], v8, s[48:51], s88 offen offset:0 sc1
v_lshlrev_b32 v11, 2, v3
v_lshlrev_b32 v10, 3, v3
s_waitcnt vmcnt(11) lgkmcnt(4)
v_mfma_f32_32x32x16_bf16 v[144:159], v[224:227], a[36:39], v[144:159]
ds_read_b64_tr_b16 v[240:241], v16 offset:22528
ds_read_b64_tr_b16 v[242:243], v16 offset:23552
s_add_u32 s78, s93, 128
s_add_u32 s79, s94, 128
s_add_u32 s80, s95, 128
v_mfma_f32_32x32x16_bf16 v[160:175], v[228:231], a[36:39], v[160:175]
ds_read_b64_tr_b16 v[244:245], v17 offset:22528
ds_read_b64_tr_b16 v[246:247], v17 offset:23552
buffer_load_dwordx4 a[84:87], v8, s[48:51], s88 offen offset:1024 sc1
s_add_u32 s81, s96, 128
s_add_u32 s82, s97, 128
s_waitcnt vmcnt(11) lgkmcnt(4)
v_mfma_f32_32x32x16_bf16 v[144:159], v[232:235], a[40:43], v[144:159]
ds_read_b64_tr_b16 v[224:225], v16 offset:24576
ds_read_b64_tr_b16 v[226:227], v16 offset:25600
v_mov_b32 v108, s15
v_mov_b32 v109, s15
s_add_u32 s69, s72, 655232
v_mfma_f32_32x32x16_bf16 v[160:175], v[236:239], a[40:43], v[160:175]
ds_read_b64_tr_b16 v[228:229], v17 offset:24576
ds_read_b64_tr_b16 v[230:231], v17 offset:25600
buffer_load_dwordx4 a[88:91], v8, s[48:51], s88 offen offset:2048 sc1
v_mul_f32 v112, v32, v24
v_mul_f32 v113, v33, v24
s_waitcnt vmcnt(11) lgkmcnt(4)
v_mfma_f32_32x32x16_bf16 v[144:159], v[240:243], a[44:47], v[144:159]
ds_read_b64_tr_b16 v[232:233], v16 offset:26624
ds_read_b64_tr_b16 v[234:235], v16 offset:27648
v_mul_f32 v114, v34, v24
v_mul_f32 v115, v35, v24
v_mfma_f32_32x32x16_bf16 v[160:175], v[244:247], a[44:47], v[160:175]
ds_read_b64_tr_b16 v[236:237], v17 offset:26624
ds_read_b64_tr_b16 v[238:239], v17 offset:27648
buffer_load_dwordx4 a[92:95], v8, s[48:51], s88 offen offset:3072 sc1
v_exp_f32_e64 v112, v112 clamp
s_waitcnt vmcnt(11) lgkmcnt(4)
v_mfma_f32_32x32x16_bf16 v[144:159], v[224:227], a[48:51], v[144:159]
ds_read_b64_tr_b16 v[240:241], v16 offset:28672
ds_read_b64_tr_b16 v[242:243], v16 offset:29696
v_fma_f32 v32, v32, v4, s15
v_exp_f32_e64 v113, v113 clamp
v_mfma_f32_32x32x16_bf16 v[160:175], v[228:231], a[48:51], v[160:175]
ds_read_b64_tr_b16 v[244:245], v17 offset:28672
ds_read_b64_tr_b16 v[246:247], v17 offset:29696
buffer_load_dwordx4 a[96:99], v8, s[48:51], s89 offen offset:0 sc1
v_fma_f32 v33, v33, v4, s15
s_waitcnt vmcnt(11) lgkmcnt(4)
v_mfma_f32_32x32x16_bf16 v[144:159], v[232:235], a[52:55], v[144:159]
ds_read_b64_tr_b16 v[224:225], v16 offset:30720
ds_read_b64_tr_b16 v[226:227], v16 offset:31744
v_exp_f32_e64 v114, v114 clamp
v_fma_f32 v34, v34, v4, s15
v_mfma_f32_32x32x16_bf16 v[160:175], v[236:239], a[52:55], v[160:175]
ds_read_b64_tr_b16 v[228:229], v17 offset:30720
ds_read_b64_tr_b16 v[230:231], v17 offset:31744
buffer_load_dwordx4 a[100:103], v8, s[48:51], s89 offen offset:1024 sc1
v_exp_f32_e64 v115, v115 clamp
s_waitcnt vmcnt(11) lgkmcnt(4)
v_mfma_f32_32x32x16_bf16 v[144:159], v[240:243], a[56:59], v[144:159]
ds_read_b64_tr_b16 v[232:233], v16 offset:32768
ds_read_b64_tr_b16 v[234:235], v16 offset:33792
v_fma_f32 v35, v35, v4, s15
v_max_f32 v32, s15, v32
v_max_f32 v33, s15, v33
v_mfma_f32_32x32x16_bf16 v[160:175], v[244:247], a[56:59], v[160:175]
ds_read_b64_tr_b16 v[236:237], v17 offset:32768
ds_read_b64_tr_b16 v[238:239], v17 offset:33792
buffer_load_dwordx4 a[104:107], v8, s[48:51], s89 offen offset:2048 sc1
v_max_f32 v34, s15, v34
v_max_f32 v35, s15, v35
s_waitcnt vmcnt(11) lgkmcnt(4)
v_mfma_f32_32x32x16_bf16 v[144:159], v[224:227], a[60:63], v[144:159]
ds_read_b64_tr_b16 v[240:241], v16 offset:34816
ds_read_b64_tr_b16 v[242:243], v16 offset:35840
v_add_f32 v32, v32, v112
v_add_f32 v33, v33, v113
v_add_f32 v34, v34, v114
v_mfma_f32_32x32x16_bf16 v[160:175], v[228:231], a[60:63], v[160:175]
ds_read_b64_tr_b16 v[244:245], v17 offset:34816
ds_read_b64_tr_b16 v[246:247], v17 offset:35840
buffer_load_dwordx4 a[108:111], v8, s[48:51], s89 offen offset:3072 sc1
v_add_f32 v35, v35, v115
v_cvt_pk_bf16_f32 v128, v32, v33
s_waitcnt vmcnt(11) lgkmcnt(4)
v_mfma_f32_32x32x16_bf16 v[144:159], v[232:235], a[64:67], v[144:159]
ds_read_b64_tr_b16 v[224:225], v16 offset:36864
ds_read_b64_tr_b16 v[226:227], v16 offset:37888
v_cvt_pk_bf16_f32 v129, v34, v35
v_mul_f32 v116, v36, v24
v_mul_f32 v117, v37, v24
v_mfma_f32_32x32x16_bf16 v[160:175], v[236:239], a[64:67], v[160:175]
ds_read_b64_tr_b16 v[228:229], v17 offset:36864
ds_read_b64_tr_b16 v[230:231], v17 offset:37888
buffer_load_dwordx4 a[112:115], v8, s[48:51], s90 offen offset:0 sc1
v_mul_f32 v118, v38, v24
v_mul_f32 v119, v39, v24
s_waitcnt vmcnt(11) lgkmcnt(4)
v_mfma_f32_32x32x16_bf16 v[144:159], v[240:243], a[68:71], v[144:159]
ds_read_b64_tr_b16 v[232:233], v16 offset:38912
ds_read_b64_tr_b16 v[234:235], v16 offset:39936
v_exp_f32_e64 v116, v116 clamp
v_fma_f32 v36, v36, v4, s15
v_mfma_f32_32x32x16_bf16 v[160:175], v[244:247], a[68:71], v[160:175]
ds_read_b64_tr_b16 v[236:237], v17 offset:38912
ds_read_b64_tr_b16 v[238:239], v17 offset:39936
buffer_load_dwordx4 a[116:119], v8, s[48:51], s90 offen offset:1024 sc1
v_exp_f32_e64 v117, v117 clamp
s_waitcnt vmcnt(11) lgkmcnt(4)
v_mfma_f32_32x32x16_bf16 v[144:159], v[224:227], a[72:75], v[144:159]
ds_read_b64_tr_b16 v[240:241], v16 offset:40960
ds_read_b64_tr_b16 v[242:243], v16 offset:41984
v_fma_f32 v37, v37, v4, s15
v_exp_f32_e64 v118, v118 clamp
v_mfma_f32_32x32x16_bf16 v[160:175], v[228:231], a[72:75], v[160:175]
ds_read_b64_tr_b16 v[244:245], v17 offset:40960
ds_read_b64_tr_b16 v[246:247], v17 offset:41984
buffer_load_dwordx4 a[120:123], v8, s[48:51], s90 offen offset:2048 sc1
v_fma_f32 v38, v38, v4, s15
s_waitcnt vmcnt(11) lgkmcnt(4)
v_mfma_f32_32x32x16_bf16 v[144:159], v[232:235], a[76:79], v[144:159]
ds_read_b64_tr_b16 v[224:225], v16 offset:43008
ds_read_b64_tr_b16 v[226:227], v16 offset:44032
v_exp_f32_e64 v119, v119 clamp
v_fma_f32 v39, v39, v4, s15
v_mfma_f32_32x32x16_bf16 v[160:175], v[236:239], a[76:79], v[160:175]
ds_read_b64_tr_b16 v[228:229], v17 offset:43008
ds_read_b64_tr_b16 v[230:231], v17 offset:44032
buffer_load_dwordx4 a[124:127], v8, s[48:51], s90 offen offset:3072 sc1
v_max_f32 v36, s15, v36
v_max_f32 v37, s15, v37
s_waitcnt vmcnt(11) lgkmcnt(4)
v_mfma_f32_32x32x16_bf16 v[144:159], v[240:243], a[80:83], v[144:159]
ds_read_b64_tr_b16 v[232:233], v16 offset:45056
ds_read_b64_tr_b16 v[234:235], v16 offset:46080
v_max_f32 v38, s15, v38
v_max_f32 v39, s15, v39
v_add_f32 v36, v36, v116
s_barrier
v_mfma_f32_32x32x16_bf16 v[160:175], v[244:247], a[80:83], v[160:175]
ds_read_b64_tr_b16 v[236:237], v17 offset:45056
ds_read_b64_tr_b16 v[238:239], v17 offset:46080
buffer_load_dwordx4 a[128:131], v8, s[48:51], s91 offen offset:0 sc1
v_add_f32 v37, v37, v117
v_add_f32 v38, v38, v118
s_waitcnt vmcnt(11) lgkmcnt(4)
v_mfma_f32_32x32x16_bf16 v[144:159], v[224:227], a[84:87], v[144:159]
ds_read_b64_tr_b16 v[240:241], v16 offset:47104
ds_read_b64_tr_b16 v[242:243], v16 offset:48128
v_add_f32 v39, v39, v119
v_cvt_pk_bf16_f32 v130, v36, v37
v_cvt_pk_bf16_f32 v131, v38, v39
v_mfma_f32_32x32x16_bf16 v[160:175], v[228:231], a[84:87], v[160:175]
ds_read_b64_tr_b16 v[244:245], v17 offset:47104
ds_read_b64_tr_b16 v[246:247], v17 offset:48128
buffer_load_dwordx4 a[132:135], v8, s[48:51], s91 offen offset:1024 sc1
v_mul_f32 v112, v40, v24
v_mul_f32 v113, v41, v24
s_waitcnt vmcnt(11) lgkmcnt(4)
v_mfma_f32_32x32x16_bf16 v[144:159], v[232:235], a[88:91], v[144:159]
ds_read_b64_tr_b16 v[224:225], v16 offset:49152
ds_read_b64_tr_b16 v[226:227], v16 offset:50176
v_mul_f32 v114, v42, v24
v_mul_f32 v115, v43, v24
v_mfma_f32_32x32x16_bf16 v[160:175], v[236:239], a[88:91], v[160:175]
ds_read_b64_tr_b16 v[228:229], v17 offset:49152
ds_read_b64_tr_b16 v[230:231], v17 offset:50176
buffer_load_dwordx4 a[136:139], v8, s[48:51], s91 offen offset:2048 sc1
v_exp_f32_e64 v112, v112 clamp
s_waitcnt vmcnt(11) lgkmcnt(4)
v_mfma_f32_32x32x16_bf16 v[144:159], v[240:243], a[92:95], v[144:159]
ds_read_b64_tr_b16 v[232:233], v16 offset:51200
ds_read_b64_tr_b16 v[234:235], v16 offset:52224
v_fma_f32 v40, v40, v4, s15
v_exp_f32_e64 v113, v113 clamp
v_mfma_f32_32x32x16_bf16 v[160:175], v[244:247], a[92:95], v[160:175]
ds_read_b64_tr_b16 v[236:237], v17 offset:51200
ds_read_b64_tr_b16 v[238:239], v17 offset:52224
buffer_load_dwordx4 a[140:143], v8, s[48:51], s91 offen offset:3072 sc1
v_fma_f32 v41, v41, v4, s15
s_waitcnt vmcnt(11) lgkmcnt(4)
v_mfma_f32_32x32x16_bf16 v[144:159], v[224:227], a[96:99], v[144:159]
ds_read_b64_tr_b16 v[240:241], v16 offset:53248
ds_read_b64_tr_b16 v[242:243], v16 offset:54272
v_exp_f32_e64 v114, v114 clamp
v_fma_f32 v42, v42, v4, s15
v_mfma_f32_32x32x16_bf16 v[160:175], v[228:231], a[96:99], v[160:175]
ds_read_b64_tr_b16 v[244:245], v17 offset:53248
ds_read_b64_tr_b16 v[246:247], v17 offset:54272
buffer_load_dwordx4 a[144:147], v8, s[48:51], s92 offen offset:0 sc1
v_exp_f32_e64 v115, v115 clamp
s_waitcnt vmcnt(11) lgkmcnt(4)
v_mfma_f32_32x32x16_bf16 v[144:159], v[232:235], a[100:103], v[144:159]
ds_read_b64_tr_b16 v[224:225], v16 offset:55296
ds_read_b64_tr_b16 v[226:227], v16 offset:56320
v_fma_f32 v43, v43, v4, s15
v_max_f32 v40, s15, v40
v_max_f32 v41, s15, v41
v_mfma_f32_32x32x16_bf16 v[160:175], v[236:239], a[100:103], v[160:175]
ds_read_b64_tr_b16 v[228:229], v17 offset:55296
ds_read_b64_tr_b16 v[230:231], v17 offset:56320
buffer_load_dwordx4 a[148:151], v8, s[48:51], s92 offen offset:1024 sc1
v_max_f32 v42, s15, v42
v_max_f32 v43, s15, v43
s_waitcnt vmcnt(11) lgkmcnt(4)
v_mfma_f32_32x32x16_bf16 v[144:159], v[240:243], a[104:107], v[144:159]
ds_read_b64_tr_b16 v[232:233], v16 offset:57344
ds_read_b64_tr_b16 v[234:235], v16 offset:58368
v_add_f32 v40, v40, v112
v_add_f32 v41, v41, v113
v_add_f32 v42, v42, v114
v_mfma_f32_32x32x16_bf16 v[160:175], v[244:247], a[104:107], v[160:175]
ds_read_b64_tr_b16 v[236:237], v17 offset:57344
ds_read_b64_tr_b16 v[238:239], v17 offset:58368
buffer_load_dwordx4 a[152:155], v8, s[48:51], s92 offen offset:2048 sc1
v_add_f32 v43, v43, v115
v_cvt_pk_bf16_f32 v132, v40, v41
s_waitcnt vmcnt(11) lgkmcnt(4)
v_mfma_f32_32x32x16_bf16 v[144:159], v[224:227], a[108:111], v[144:159]
ds_read_b64_tr_b16 v[240:241], v16 offset:59392
ds_read_b64_tr_b16 v[242:243], v16 offset:60416
v_cvt_pk_bf16_f32 v133, v42, v43
v_mul_f32 v116, v44, v24
v_mul_f32 v117, v45, v24
v_mfma_f32_32x32x16_bf16 v[160:175], v[228:231], a[108:111], v[160:175]
ds_read_b64_tr_b16 v[244:245], v17 offset:59392
ds_read_b64_tr_b16 v[246:247], v17 offset:60416
buffer_load_dwordx4 a[156:159], v8, s[48:51], s92 offen offset:3072 sc1
v_mul_f32 v118, v46, v24
v_mul_f32 v119, v47, v24
s_waitcnt vmcnt(11) lgkmcnt(4)
v_mfma_f32_32x32x16_bf16 v[144:159], v[232:235], a[112:115], v[144:159]
ds_read_b64_tr_b16 v[224:225], v16 offset:61440
ds_read_b64_tr_b16 v[226:227], v16 offset:62464
v_exp_f32_e64 v116, v116 clamp
v_fma_f32 v44, v44, v4, s15
v_mfma_f32_32x32x16_bf16 v[160:175], v[236:239], a[112:115], v[160:175]
ds_read_b64_tr_b16 v[228:229], v17 offset:61440
ds_read_b64_tr_b16 v[230:231], v17 offset:62464
s_add_u32 m0, s99, 114688
s_nop 0
buffer_load_dwordx4 v120, s[52:55], s95 offen offset:0 lds
v_exp_f32_e64 v117, v117 clamp
s_waitcnt vmcnt(11) lgkmcnt(4)
v_mfma_f32_32x32x16_bf16 v[144:159], v[240:243], a[116:119], v[144:159]
ds_read_b64_tr_b16 v[232:233], v16 offset:63488
ds_read_b64_tr_b16 v[234:235], v16 offset:64512
v_fma_f32 v45, v45, v4, s15
v_exp_f32_e64 v118, v118 clamp
v_mfma_f32_32x32x16_bf16 v[160:175], v[244:247], a[116:119], v[160:175]
ds_read_b64_tr_b16 v[236:237], v17 offset:63488
ds_read_b64_tr_b16 v[238:239], v17 offset:64512
buffer_load_dwordx4 v121, s[52:55], s95 offen offset:1024 lds
v_fma_f32 v46, v46, v4, s15
s_waitcnt vmcnt(11) lgkmcnt(4)
v_mfma_f32_32x32x16_bf16 v[144:159], v[224:227], a[120:123], v[144:159]
ds_read_b64_tr_b16 v[240:241], v18 offset:0
ds_read_b64_tr_b16 v[242:243], v18 offset:1024
v_exp_f32_e64 v119, v119 clamp
v_fma_f32 v47, v47, v4, s15
v_lshlrev_b32 v9, 7, v3
s_mov_b32 s7, 22740992
buffer_load_dwordx2 v[20:21], v9, s[48:51], s7 offen sc1
v_mfma_f32_32x32x16_bf16 v[160:175], v[228:231], a[120:123], v[160:175]
ds_read_b64_tr_b16 v[244:245], v19 offset:0
ds_read_b64_tr_b16 v[246:247], v19 offset:1024
buffer_load_dwordx4 v122, s[52:55], s95 offen offset:2048 lds
v_max_f32 v44, s15, v44
v_max_f32 v45, s15, v45
s_waitcnt vmcnt(12) lgkmcnt(4)
v_mfma_f32_32x32x16_bf16 v[144:159], v[232:235], a[124:127], v[144:159]
ds_read_b64_tr_b16 v[224:225], v18 offset:2048
ds_read_b64_tr_b16 v[226:227], v18 offset:3072
v_max_f32 v46, s15, v46
v_max_f32 v47, s15, v47
v_add_f32 v44, v44, v116
v_mfma_f32_32x32x16_bf16 v[160:175], v[236:239], a[124:127], v[160:175]
ds_read_b64_tr_b16 v[228:229], v19 offset:2048
ds_read_b64_tr_b16 v[230:231], v19 offset:3072
buffer_load_dwordx4 v123, s[52:55], s95 offen offset:3072 lds
v_add_f32 v45, v45, v117
v_add_f32 v46, v46, v118
s_waitcnt vmcnt(12) lgkmcnt(4)
v_mfma_f32_32x32x16_bf16 v[144:159], v[240:243], a[128:131], v[144:159]
ds_read_b64_tr_b16 v[232:233], v18 offset:4096
ds_read_b64_tr_b16 v[234:235], v18 offset:5120
v_add_f32 v47, v47, v119
v_cvt_pk_bf16_f32 v134, v44, v45
v_cvt_pk_bf16_f32 v135, v46, v47
v_mfma_f32_32x32x16_bf16 v[160:175], v[244:247], a[128:131], v[160:175]
ds_read_b64_tr_b16 v[236:237], v19 offset:4096
ds_read_b64_tr_b16 v[238:239], v19 offset:5120
s_add_u32 m0, s99, 131072
s_nop 0
buffer_load_dwordx4 v120, s[52:55], s96 offen offset:0 lds
s_waitcnt vmcnt(12) lgkmcnt(4)
v_mfma_f32_32x32x16_bf16 v[144:159], v[224:227], a[132:135], v[144:159]
ds_read_b64_tr_b16 v[240:241], v18 offset:6144
ds_read_b64_tr_b16 v[242:243], v18 offset:7168
v_mfma_f32_32x32x16_bf16 v[160:175], v[228:231], a[132:135], v[160:175]
ds_read_b64_tr_b16 v[244:245], v19 offset:6144
ds_read_b64_tr_b16 v[246:247], v19 offset:7168
buffer_load_dwordx4 v121, s[52:55], s96 offen offset:1024 lds
s_waitcnt vmcnt(12) lgkmcnt(4)
v_mfma_f32_32x32x16_bf16 v[144:159], v[232:235], a[136:139], v[144:159]
ds_read_b64_tr_b16 v[224:225], v18 offset:8192
ds_read_b64_tr_b16 v[226:227], v18 offset:9216
v_mfma_f32_32x32x16_bf16 v[160:175], v[236:239], a[136:139], v[160:175]
ds_read_b64_tr_b16 v[228:229], v19 offset:8192
ds_read_b64_tr_b16 v[230:231], v19 offset:9216
buffer_load_dwordx4 v122, s[52:55], s96 offen offset:2048 lds
s_waitcnt vmcnt(12) lgkmcnt(4)
v_mfma_f32_32x32x16_bf16 v[144:159], v[240:243], a[140:143], v[144:159]
ds_read_b64_tr_b16 v[232:233], v18 offset:10240
ds_read_b64_tr_b16 v[234:235], v18 offset:11264
v_mfma_f32_32x32x16_bf16 v[160:175], v[244:247], a[140:143], v[160:175]
ds_read_b64_tr_b16 v[236:237], v19 offset:10240
ds_read_b64_tr_b16 v[238:239], v19 offset:11264
buffer_load_dwordx4 v123, s[52:55], s96 offen offset:3072 lds
s_waitcnt vmcnt(12) lgkmcnt(4)
v_mfma_f32_32x32x16_bf16 v[144:159], v[224:227], a[144:147], v[144:159]
ds_read_b64_tr_b16 v[240:241], v18 offset:12288
ds_read_b64_tr_b16 v[242:243], v18 offset:13312
v_mfma_f32_32x32x16_bf16 v[160:175], v[228:231], a[144:147], v[160:175]
ds_read_b64_tr_b16 v[244:245], v19 offset:12288
ds_read_b64_tr_b16 v[246:247], v19 offset:13312
s_waitcnt vmcnt(11) lgkmcnt(4)
v_mfma_f32_32x32x16_bf16 v[144:159], v[232:235], a[148:151], v[144:159]
ds_read_b64_tr_b16 v[224:225], v18 offset:14336
ds_read_b64_tr_b16 v[226:227], v18 offset:15360
v_mfma_f32_32x32x16_bf16 v[160:175], v[236:239], a[148:151], v[160:175]
ds_read_b64_tr_b16 v[228:229], v19 offset:14336
ds_read_b64_tr_b16 v[230:231], v19 offset:15360
s_waitcnt vmcnt(10) lgkmcnt(4)
v_mfma_f32_32x32x16_bf16 v[144:159], v[240:243], a[152:155], v[144:159]
v_mfma_f32_32x32x16_bf16 v[160:175], v[244:247], a[152:155], v[160:175]
s_waitcnt vmcnt(9) lgkmcnt(0)
v_mfma_f32_32x32x16_bf16 v[144:159], v[224:227], a[156:159], v[144:159]
v_mfma_f32_32x32x16_bf16 v[160:175], v[228:231], a[156:159], v[160:175]
s_nop 10
v_pk_add_f32 v[144:145], v[144:145], v[64:65]
v_pk_add_f32 v[146:147], v[146:147], v[66:67]
v_pk_add_f32 v[148:149], v[148:149], v[68:69]
v_pk_add_f32 v[150:151], v[150:151], v[70:71]
v_cvt_pk_bf16_f32 v232, v144, v145
v_cvt_pk_bf16_f32 v233, v146, v147
v_cvt_pk_bf16_f32 v234, v148, v149
v_cvt_pk_bf16_f32 v235, v150, v151
buffer_store_dwordx4 v[232:235], v8, s[48:51], s70 offen offset:0 sc1
v_pk_add_f32 v[152:153], v[152:153], v[72:73]
v_pk_add_f32 v[154:155], v[154:155], v[74:75]
v_pk_add_f32 v[156:157], v[156:157], v[76:77]
v_pk_add_f32 v[158:159], v[158:159], v[78:79]
v_cvt_pk_bf16_f32 v236, v152, v153
v_cvt_pk_bf16_f32 v237, v154, v155
v_cvt_pk_bf16_f32 v238, v156, v157
v_cvt_pk_bf16_f32 v239, v158, v159
buffer_store_dwordx4 v[236:239], v8, s[48:51], s70 offen offset:1024 sc1
v_pk_add_f32 v[160:161], v[160:161], v[80:81]
v_pk_add_f32 v[162:163], v[162:163], v[82:83]
v_pk_add_f32 v[164:165], v[164:165], v[84:85]
v_pk_add_f32 v[166:167], v[166:167], v[86:87]
v_cvt_pk_bf16_f32 v240, v160, v161
v_cvt_pk_bf16_f32 v241, v162, v163
v_cvt_pk_bf16_f32 v242, v164, v165
v_cvt_pk_bf16_f32 v243, v166, v167
buffer_store_dwordx4 v[240:243], v8, s[48:51], s70 offen offset:2048 sc1
v_pk_add_f32 v[168:169], v[168:169], v[88:89]
v_pk_add_f32 v[170:171], v[170:171], v[90:91]
v_pk_add_f32 v[172:173], v[172:173], v[92:93]
v_pk_add_f32 v[174:175], v[174:175], v[94:95]
v_cvt_pk_bf16_f32 v244, v168, v169
v_cvt_pk_bf16_f32 v245, v170, v171
v_cvt_pk_bf16_f32 v246, v172, v173
v_cvt_pk_bf16_f32 v247, v174, v175
buffer_store_dwordx4 v[244:247], v8, s[48:51], s70 offen offset:3072 sc1
v_mov_b32 v224, 0
v_mov_b32 v225, 0
v_dot2c_f32_bf16 v224, s67, v232
v_dot2c_f32_bf16 v225, v232, v232
v_dot2c_f32_bf16 v224, s67, v233
v_dot2c_f32_bf16 v225, v233, v233
v_dot2c_f32_bf16 v224, s67, v234
v_dot2c_f32_bf16 v225, v234, v234
v_dot2c_f32_bf16 v224, s67, v235
v_dot2c_f32_bf16 v225, v235, v235
v_dot2c_f32_bf16 v224, s67, v236
v_dot2c_f32_bf16 v225, v236, v236
v_dot2c_f32_bf16 v224, s67, v237
v_dot2c_f32_bf16 v225, v237, v237
v_dot2c_f32_bf16 v224, s67, v238
v_dot2c_f32_bf16 v225, v238, v238
v_dot2c_f32_bf16 v224, s67, v239
v_dot2c_f32_bf16 v225, v239, v239
v_dot2c_f32_bf16 v224, s67, v240
v_dot2c_f32_bf16 v225, v240, v240
v_dot2c_f32_bf16 v224, s67, v241
v_dot2c_f32_bf16 v225, v241, v241
v_dot2c_f32_bf16 v224, s67, v242
v_dot2c_f32_bf16 v225, v242, v242
v_dot2c_f32_bf16 v224, s67, v243
v_dot2c_f32_bf16 v225, v243, v243
v_dot2c_f32_bf16 v224, s67, v244
v_dot2c_f32_bf16 v225, v244, v244
v_dot2c_f32_bf16 v224, s67, v245
v_dot2c_f32_bf16 v225, v245, v245
v_dot2c_f32_bf16 v224, s67, v246
v_dot2c_f32_bf16 v225, v246, v246
v_dot2c_f32_bf16 v224, s67, v247
v_dot2c_f32_bf16 v225, v247, v247
s_nop 1
v_mov_b32 v248, v224
s_nop 1
v_permlane32_swap_b32 v224, v248
v_add_f32 v224, v224, v248
v_mov_b32 v249, v225
s_nop 1
v_permlane32_swap_b32 v225, v249
v_add_f32 v225, v225, v249
s_mov_b32 exec_hi, 0
buffer_store_dwordx2 v[224:225], v10, s[48:51], s71 offen sc1
s_mov_b32 exec_hi, -1
s_barrier
s_lshl_b32 s73, s30, 11
s_add_u32 s74, s73, 2048
s_cmp_eq_u32 s74, 10240
s_cselect_b32 s74, 0, s74
s_add_u32 s75, s74, 2048
s_cmp_eq_u32 s75, 10240
s_cselect_b32 s75, 0, s75
s_add_u32 s76, s75, 2048
s_cmp_eq_u32 s76, 10240
s_cselect_b32 s76, 0, s76
s_add_u32 m0, s99, 147456
s_nop 0
buffer_load_dwordx4 v120, s[52:55], s97 offen offset:0 lds
s_add_u32 s77, s76, 2048
s_cmp_eq_u32 s77, 10240
s_cselect_b32 s77, 0, s77
v_add_u32 v16, 81920, v16
v_add_u32 v17, 81920, v17
v_add_u32 v18, 81920, v18
v_add_u32 v19, 81920, v19
s_add_u32 s83, s83, 5242880
s_add_u32 s84, s84, 5242880
s_add_u32 s85, s85, 5242880
buffer_load_dwordx4 v121, s[52:55], s97 offen offset:1024 lds
s_add_u32 s86, s86, 5242880
s_add_u32 s87, s87, 5242880
s_add_u32 s88, s88, 5242880
s_add_u32 s89, s89, 5242880
s_add_u32 s90, s90, 5242880
s_add_u32 s91, s91, 5242880
s_add_u32 s92, s92, 5242880
v_pk_mul_f32 v[112:113], v[48:49], v[24:25] op_sel_hi:[1,0]
v_pk_mul_f32 v[114:115], v[50:51], v[24:25] op_sel_hi:[1,0]
v_pk_mul_f32 v[116:117], v[52:53], v[24:25] op_sel_hi:[1,0]
buffer_load_dwordx4 v122, s[52:55], s97 offen offset:2048 lds
v_pk_mul_f32 v[118:119], v[54:55], v[24:25] op_sel_hi:[1,0]
v_pk_fma_f32 v[48:49], v[48:49], v[4:5], v[108:109] op_sel_hi:[1,0,1]
v_pk_fma_f32 v[50:51], v[50:51], v[4:5], v[108:109] op_sel_hi:[1,0,1]
v_pk_fma_f32 v[52:53], v[52:53], v[4:5], v[108:109] op_sel_hi:[1,0,1]
v_pk_fma_f32 v[54:55], v[54:55], v[4:5], v[108:109] op_sel_hi:[1,0,1]
v_exp_f32_e64 v112, v112 clamp
v_exp_f32_e64 v113, v113 clamp
v_exp_f32_e64 v114, v114 clamp
v_exp_f32_e64 v115, v115 clamp
v_exp_f32_e64 v116, v116 clamp
buffer_load_dwordx4 v123, s[52:55], s97 offen offset:3072 lds
v_exp_f32_e64 v117, v117 clamp
v_exp_f32_e64 v118, v118 clamp
v_exp_f32_e64 v119, v119 clamp
v_max_f32 v48, v108, v48
v_max_f32 v49, v108, v49
v_max_f32 v50, v108, v50
v_max_f32 v51, v108, v51
v_max_f32 v52, v108, v52
v_max_f32 v53, v108, v53
v_max_f32 v54, v108, v54
s_add_u32 m0, s99, 0
s_nop 0
buffer_load_dwordx4 v120, s[52:55], s78 offen offset:0 lds
v_max_f32 v55, v108, v55
v_pk_add_f32 v[48:49], v[48:49], v[112:113]
v_pk_add_f32 v[50:51], v[50:51], v[114:115]
v_pk_add_f32 v[52:53], v[52:53], v[116:117]
v_pk_add_f32 v[54:55], v[54:55], v[118:119]
v_cvt_pk_bf16_f32 v136, v48, v49
v_cvt_pk_bf16_f32 v137, v50, v51
v_cvt_pk_bf16_f32 v138, v52, v53
v_cvt_pk_bf16_f32 v139, v54, v55
v_pk_mul_f32 v[112:113], v[56:57], v[24:25] op_sel_hi:[1,0]
buffer_load_dwordx4 v121, s[52:55], s78 offen offset:1024 lds
v_pk_mul_f32 v[114:115], v[58:59], v[24:25] op_sel_hi:[1,0]
v_pk_mul_f32 v[116:117], v[60:61], v[24:25] op_sel_hi:[1,0]
v_pk_mul_f32 v[118:119], v[62:63], v[24:25] op_sel_hi:[1,0]
v_pk_fma_f32 v[56:57], v[56:57], v[4:5], v[108:109] op_sel_hi:[1,0,1]
v_pk_fma_f32 v[58:59], v[58:59], v[4:5], v[108:109] op_sel_hi:[1,0,1]
v_pk_fma_f32 v[60:61], v[60:61], v[4:5], v[108:109] op_sel_hi:[1,0,1]
v_pk_fma_f32 v[62:63], v[62:63], v[4:5], v[108:109] op_sel_hi:[1,0,1]
v_exp_f32_e64 v112, v112 clamp
v_exp_f32_e64 v113, v113 clamp
v_exp_f32_e64 v114, v114 clamp
buffer_load_dwordx4 v122, s[52:55], s78 offen offset:2048 lds
v_exp_f32_e64 v115, v115 clamp
v_exp_f32_e64 v116, v116 clamp
v_exp_f32_e64 v117, v117 clamp
v_exp_f32_e64 v118, v118 clamp
v_exp_f32_e64 v119, v119 clamp
v_max_f32 v56, v108, v56
v_max_f32 v57, v108, v57
v_max_f32 v58, v108, v58
v_max_f32 v59, v108, v59
v_max_f32 v60, v108, v60
buffer_load_dwordx4 v123, s[52:55], s78 offen offset:3072 lds
v_max_f32 v61, v108, v61
v_max_f32 v62, v108, v62
v_max_f32 v63, v108, v63
v_pk_add_f32 v[56:57], v[56:57], v[112:113]
v_pk_add_f32 v[58:59], v[58:59], v[114:115]
v_pk_add_f32 v[60:61], v[60:61], v[116:117]
v_pk_add_f32 v[62:63], v[62:63], v[118:119]
v_cvt_pk_bf16_f32 v140, v56, v57
v_cvt_pk_bf16_f32 v141, v58, v59
v_cvt_pk_bf16_f32 v142, v60, v61
v_cvt_pk_bf16_f32 v143, v62, v63
s_waitcnt vmcnt(8)
s_mov_b64 exec, 0xffff
buffer_store_dwordx2 v[252:253], v254, s[48:51], s72 offen sc1
s_mov_b64 exec, -1
buffer_store_dwordx4 v[128:131], v8, s[48:51], s98 offen offset:0 sc1
buffer_store_dwordx4 v[132:135], v8, s[48:51], s98 offen offset:1024 sc1
buffer_store_dwordx4 v[136:139], v8, s[48:51], s98 offen offset:2048 sc1
buffer_store_dwordx4 v[140:143], v8, s[48:51], s98 offen offset:3072 sc1
v_cmp_ne_u64 vcc, s[8:9], v[20:21]
s_cbranch_vccz L_chk3x
s_mov_b32 s10, 0x20000
L_chk3:
buffer_load_dwordx2 v[20:21], v9, s[48:51], s7 offen sc1
s_sub_u32 s10, s10, 1
s_waitcnt vmcnt(0)
s_cbranch_scc1 L_chk3x
v_cmp_ne_u64 vcc, s[8:9], v[20:21]
s_cbranch_vccnz L_chk3
L_chk3x:
v_and_b32 v249, 15, v1
v_min_u32 v249, 9, v249
s_lshl_b32 s15, s62, 12
v_lshl_add_u32 v9, v249, 8, s15
s_mov_b32 s15, 22151296
s_add_u32 m0, s99, 16384
s_nop 0
buffer_load_dwordx4 v120, s[52:55], s79 offen offset:0 lds
buffer_load_dwordx4 v121, s[52:55], s79 offen offset:1024 lds
buffer_load_dwordx4 v122, s[52:55], s79 offen offset:2048 lds
buffer_load_dwordx4 v123, s[52:55], s79 offen offset:3072 lds
s_add_u32 m0, s99, 32768
s_nop 0
buffer_load_dwordx4 v120, s[52:55], s80 offen offset:0 lds
buffer_load_dwordx4 v121, s[52:55], s80 offen offset:1024 lds
buffer_load_dwordx4 v122, s[52:55], s80 offen offset:2048 lds
buffer_load_dwordx4 v123, s[52:55], s80 offen offset:3072 lds
s_add_u32 m0, s99, 49152
s_nop 0
buffer_load_dwordx4 v120, s[52:55], s81 offen offset:0 lds
buffer_load_dwordx4 v121, s[52:55], s81 offen offset:1024 lds
buffer_load_dwordx4 v122, s[52:55], s81 offen offset:2048 lds
buffer_load_dwordx4 v123, s[52:55], s81 offen offset:3072 lds
s_add_u32 m0, s99, 65536
s_nop 0
buffer_load_dwordx4 v120, s[52:55], s82 offen offset:0 lds
buffer_load_dwordx4 v121, s[52:55], s82 offen offset:1024 lds
buffer_load_dwordx4 v122, s[52:55], s82 offen offset:2048 lds
buffer_load_dwordx4 v123, s[52:55], s82 offen offset:3072 lds
buffer_load_dwordx2 v[20:21], v9, s[48:51], s15 offen sc1
s_waitcnt vmcnt(17)
s_mov_b64 exec, 0xffff
buffer_store_dwordx2 v[252:253], v254, s[48:51], s69 offen sc1
s_mov_b64 exec, -1
s_mul_i32 s23, s0, 20
s_add_u32 s23, s23, s22
buffer_load_dwordx4 a[160:163], v22, s[48:51], s23 offen offset:0 sc1
buffer_load_dwordx4 a[164:167], v22, s[48:51], s23 offen offset:1024 sc1
buffer_load_dwordx4 a[168:171], v22, s[48:51], s23 offen offset:2048 sc1
buffer_load_dwordx4 a[172:175], v22, s[48:51], s23 offen offset:3072 sc1
buffer_load_dwordx4 a[176:179], v23, s[48:51], s23 offen offset:0 sc1
s_mul_i32 s23, s1, 20
s_add_u32 s23, s23, s22
buffer_load_dwordx4 a[180:183], v22, s[48:51], s23 offen offset:0 sc1
buffer_load_dwordx4 a[184:187], v22, s[48:51], s23 offen offset:1024 sc1
buffer_load_dwordx4 a[188:191], v22, s[48:51], s23 offen offset:2048 sc1
L_b3:
v_mul_u32_u24 v4, 1280, v2
v_lshl_add_u32 v4, v3, 3, v4
v_lshlrev_b32 v10, 7, v3
s_mov_b32 s7, 22745088
s_mul_i32 s68, s62, 2560
s_add_u32 s68, s68, 21757952
s_lshl_b32 s69, s63, 9
s_add_u32 s69, s69, 21626880
s_mul_i32 s70, s62, 57344
s_lshl_b32 s12, s63, 13
s_add_u32 s70, s70, s12
s_add_u32 s70, s70, 10485760
s_lshl_b32 s71, s62, 12
s_lshl_b32 s12, s63, 8
s_add_u32 s71, s71, s12
s_add_u32 s71, s71, 22413312
s_waitcnt vmcnt(9)
v_cmp_ne_u64 vcc, s[8:9], v[20:21]
s_cbranch_vccz L_chk4x
s_mov_b32 s10, 0x20000
L_chk4:
buffer_load_dwordx2 v[20:21], v9, s[48:51], s15 offen sc1
s_sub_u32 s10, s10, 1
s_waitcnt vmcnt(0)
s_cbranch_scc1 L_chk4x
v_cmp_ne_u64 vcc, s[8:9], v[20:21]
s_cbranch_vccnz L_chk4
L_chk4x:
buffer_load_dwordx4 a[0:3], v8, s[48:51], s83 offen offset:0 sc1
buffer_load_dwordx4 a[4:7], v8, s[48:51], s83 offen offset:1024 sc1
buffer_load_dwordx4 a[8:11], v8, s[48:51], s83 offen offset:2048 sc1
buffer_load_dwordx4 a[12:15], v8, s[48:51], s83 offen offset:3072 sc1
buffer_load_dwordx4 a[16:19], v8, s[48:51], s84 offen offset:0 sc1
buffer_load_dwordx4 a[20:23], v8, s[48:51], s84 offen offset:1024 sc1
buffer_load_dwordx4 a[24:27], v8, s[48:51], s84 offen offset:2048 sc1
buffer_load_dwordx4 a[28:31], v8, s[48:51], s84 offen offset:3072 sc1
s_barrier
buffer_load_dwordx4 a[32:35], v8, s[48:51], s85 offen offset:0 sc1
buffer_load_dwordx4 a[36:39], v8, s[48:51], s85 offen offset:1024 sc1
buffer_load_dwordx4 a[40:43], v8, s[48:51], s85 offen offset:2048 sc1
buffer_load_dwordx4 a[44:47], v8, s[48:51], s85 offen offset:3072 sc1
ds_read_b64_tr_b16 v[224:225], v16 offset:0
ds_read_b64_tr_b16 v[226:227], v16 offset:1024
ds_read_b64_tr_b16 v[228:229], v17 offset:0
ds_read_b64_tr_b16 v[230:231], v17 offset:1024
ds_read_b64_tr_b16 v[232:233], v16 offset:2048
ds_read_b64_tr_b16 v[234:235], v16 offset:3072
ds_read_b64_tr_b16 v[236:237], v17 offset:2048
ds_read_b64_tr_b16 v[238:239], v17 offset:3072
s_waitcnt vmcnt(11) lgkmcnt(4)
v_mfma_f32_32x32x16_bf16 v[32:47], v[224:227], a[0:3], 0
ds_read_b64_tr_b16 v[240:241], v16 offset:4096
ds_read_b64_tr_b16 v[242:243], v16 offset:5120
buffer_load_dwordx2 v[80:81], v4, s[48:51], s68 offen offset:0 sc1
v_mfma_f32_32x32x16_bf16 v[48:63], v[228:231], a[0:3], 0
ds_read_b64_tr_b16 v[244:245], v17 offset:4096
ds_read_b64_tr_b16 v[246:247], v17 offset:5120
buffer_load_dwordx4 a[48:51], v8, s[48:51], s86 offen offset:0 sc1
s_waitcnt vmcnt(12) lgkmcnt(4)
v_mfma_f32_32x32x16_bf16 v[32:47], v[232:235], a[4:7], v[32:47]
ds_read_b64_tr_b16 v[224:225], v16 offset:6144
ds_read_b64_tr_b16 v[226:227], v16 offset:7168
buffer_load_dwordx2 v[82:83], v4, s[48:51], s68 offen offset:256 sc1
v_mfma_f32_32x32x16_bf16 v[48:63], v[236:239], a[4:7], v[48:63]
ds_read_b64_tr_b16 v[228:229], v17 offset:6144
ds_read_b64_tr_b16 v[230:231], v17 offset:7168
buffer_load_dwordx4 a[52:55], v8, s[48:51], s86 offen offset:1024 sc1
s_waitcnt vmcnt(13) lgkmcnt(4)
v_mfma_f32_32x32x16_bf16 v[32:47], v[240:243], a[8:11], v[32:47]
ds_read_b64_tr_b16 v[232:233], v16 offset:8192
ds_read_b64_tr_b16 v[234:235], v16 offset:9216
buffer_load_dwordx2 v[84:85], v4, s[48:51], s68 offen offset:512 sc1
v_mfma_f32_32x32x16_bf16 v[48:63], v[244:247], a[8:11], v[48:63]
ds_read_b64_tr_b16 v[236:237], v17 offset:8192
ds_read_b64_tr_b16 v[238:239], v17 offset:9216
buffer_load_dwordx4 a[56:59], v8, s[48:51], s86 offen offset:2048 sc1
s_waitcnt vmcnt(14) lgkmcnt(4)
v_mfma_f32_32x32x16_bf16 v[32:47], v[224:227], a[12:15], v[32:47]
ds_read_b64_tr_b16 v[240:241], v16 offset:10240
ds_read_b64_tr_b16 v[242:243], v16 offset:11264
buffer_load_dwordx2 v[86:87], v4, s[48:51], s68 offen offset:768 sc1
v_mfma_f32_32x32x16_bf16 v[48:63], v[228:231], a[12:15], v[48:63]
ds_read_b64_tr_b16 v[244:245], v17 offset:10240
ds_read_b64_tr_b16 v[246:247], v17 offset:11264
buffer_load_dwordx4 a[60:63], v8, s[48:51], s86 offen offset:3072 sc1
s_waitcnt vmcnt(15) lgkmcnt(4)
v_mfma_f32_32x32x16_bf16 v[32:47], v[232:235], a[16:19], v[32:47]
ds_read_b64_tr_b16 v[224:225], v16 offset:12288
ds_read_b64_tr_b16 v[226:227], v16 offset:13312
buffer_load_dwordx2 v[88:89], v4, s[48:51], s68 offen offset:1024 sc1
v_mfma_f32_32x32x16_bf16 v[48:63], v[236:239], a[16:19], v[48:63]
ds_read_b64_tr_b16 v[228:229], v17 offset:12288
ds_read_b64_tr_b16 v[230:231], v17 offset:13312
buffer_load_dwordx4 a[64:67], v8, s[48:51], s87 offen offset:0 sc1
s_waitcnt vmcnt(16) lgkmcnt(4)
v_mfma_f32_32x32x16_bf16 v[32:47], v[240:243], a[20:23], v[32:47]
ds_read_b64_tr_b16 v[232:233], v16 offset:14336
ds_read_b64_tr_b16 v[234:235], v16 offset:15360
v_mfma_f32_32x32x16_bf16 v[48:63], v[244:247], a[20:23], v[48:63]
ds_read_b64_tr_b16 v[236:237], v17 offset:14336
ds_read_b64_tr_b16 v[238:239], v17 offset:15360
buffer_load_dwordx4 a[68:71], v8, s[48:51], s87 offen offset:1024 sc1
s_waitcnt vmcnt(16) lgkmcnt(4)
v_mfma_f32_32x32x16_bf16 v[32:47], v[224:227], a[24:27], v[32:47]
ds_read_b64_tr_b16 v[240:241], v16 offset:16384
ds_read_b64_tr_b16 v[242:243], v16 offset:17408
buffer_load_dwordx2 v[98:99], v10, s[48:51], s7 offen sc1
v_mfma_f32_32x32x16_bf16 v[48:63], v[228:231], a[24:27], v[48:63]
ds_read_b64_tr_b16 v[244:245], v17 offset:16384
ds_read_b64_tr_b16 v[246:247], v17 offset:17408
buffer_load_dwordx4 a[72:75], v8, s[48:51], s87 offen offset:2048 sc1
s_waitcnt vmcnt(17) lgkmcnt(4)
v_mfma_f32_32x32x16_bf16 v[32:47], v[232:235], a[28:31], v[32:47]
ds_read_b64_tr_b16 v[224:225], v16 offset:18432
ds_read_b64_tr_b16 v[226:227], v16 offset:19456
v_mfma_f32_32x32x16_bf16 v[48:63], v[236:239], a[28:31], v[48:63]
ds_read_b64_tr_b16 v[228:229], v17 offset:18432
ds_read_b64_tr_b16 v[230:231], v17 offset:19456
buffer_load_dwordx4 a[76:79], v8, s[48:51], s87 offen offset:3072 sc1
s_waitcnt vmcnt(17) lgkmcnt(4)
v_mfma_f32_32x32x16_bf16 v[32:47], v[240:243], a[32:35], v[32:47]
ds_read_b64_tr_b16 v[232:233], v16 offset:20480
ds_read_b64_tr_b16 v[234:235], v16 offset:21504
v_mfma_f32_32x32x16_bf16 v[48:63], v[244:247], a[32:35], v[48:63]
ds_read_b64_tr_b16 v[236:237], v17 offset:20480
ds_read_b64_tr_b16 v[238:239], v17 offset:21504
buffer_load_dwordx4 a[80:83], v8, s[48:51], s88 offen offset:0 sc1
s_waitcnt vmcnt(17) lgkmcnt(4)
v_mfma_f32_32x32x16_bf16 v[32:47], v[224:227], a[36:39], v[32:47]
ds_read_b64_tr_b16 v[240:241], v16 offset:22528
ds_read_b64_tr_b16 v[242:243], v16 offset:23552
v_mfma_f32_32x32x16_bf16 v[48:63], v[228:231], a[36:39], v[48:63]
ds_read_b64_tr_b16 v[244:245], v17 offset:22528
ds_read_b64_tr_b16 v[246:247], v17 offset:23552
buffer_load_dwordx4 a[84:87], v8, s[48:51], s88 offen offset:1024 sc1
s_waitcnt vmcnt(17) lgkmcnt(4)
v_mfma_f32_32x32x16_bf16 v[32:47], v[232:235], a[40:43], v[32:47]
ds_read_b64_tr_b16 v[224:225], v16 offset:24576
ds_read_b64_tr_b16 v[226:227], v16 offset:25600
v_mfma_f32_32x32x16_bf16 v[48:63], v[236:239], a[40:43], v[48:63]
ds_read_b64_tr_b16 v[228:229], v17 offset:24576
ds_read_b64_tr_b16 v[230:231], v17 offset:25600
buffer_load_dwordx4 a[88:91], v8, s[48:51], s88 offen offset:2048 sc1
s_waitcnt vmcnt(17) lgkmcnt(4)
v_mfma_f32_32x32x16_bf16 v[32:47], v[240:243], a[44:47], v[32:47]
ds_read_b64_tr_b16 v[232:233], v16 offset:26624
ds_read_b64_tr_b16 v[234:235], v16 offset:27648
v_mfma_f32_32x32x16_bf16 v[48:63], v[244:247], a[44:47], v[48:63]
ds_read_b64_tr_b16 v[236:237], v17 offset:26624
ds_read_b64_tr_b16 v[238:239], v17 offset:27648
buffer_load_dwordx4 a[92:95], v8, s[48:51], s88 offen offset:3072 sc1
s_waitcnt vmcnt(16) lgkmcnt(4)
v_mfma_f32_32x32x16_bf16 v[32:47], v[224:227], a[48:51], v[32:47]
ds_read_b64_tr_b16 v[240:241], v16 offset:28672
ds_read_b64_tr_b16 v[242:243], v16 offset:29696
v_mfma_f32_32x32x16_bf16 v[48:63], v[228:231], a[48:51], v[48:63]
ds_read_b64_tr_b16 v[244:245], v17 offset:28672
ds_read_b64_tr_b16 v[246:247], v17 offset:29696
buffer_load_dwordx4 a[96:99], v8, s[48:51], s89 offen offset:0 sc1
s_waitcnt vmcnt(15) lgkmcnt(4)
v_mfma_f32_32x32x16_bf16 v[32:47], v[232:235], a[52:55], v[32:47]
ds_read_b64_tr_b16 v[224:225], v16 offset:30720
ds_read_b64_tr_b16 v[226:227], v16 offset:31744
v_mfma_f32_32x32x16_bf16 v[48:63], v[236:239], a[52:55], v[48:63]
ds_read_b64_tr_b16 v[228:229], v17 offset:30720
ds_read_b64_tr_b16 v[230:231], v17 offset:31744
buffer_load_dwordx4 a[100:103], v8, s[48:51], s89 offen offset:1024 sc1
s_waitcnt vmcnt(14) lgkmcnt(4)
v_mfma_f32_32x32x16_bf16 v[32:47], v[240:243], a[56:59], v[32:47]
ds_read_b64_tr_b16 v[232:233], v16 offset:32768
ds_read_b64_tr_b16 v[234:235], v16 offset:33792
v_mfma_f32_32x32x16_bf16 v[48:63], v[244:247], a[56:59], v[48:63]
ds_read_b64_tr_b16 v[236:237], v17 offset:32768
ds_read_b64_tr_b16 v[238:239], v17 offset:33792
buffer_load_dwordx4 a[104:107], v8, s[48:51], s89 offen offset:2048 sc1
s_waitcnt vmcnt(13) lgkmcnt(4)
v_mfma_f32_32x32x16_bf16 v[32:47], v[224:227], a[60:63], v[32:47]
ds_read_b64_tr_b16 v[240:241], v16 offset:34816
ds_read_b64_tr_b16 v[242:243], v16 offset:35840
v_mfma_f32_32x32x16_bf16 v[48:63], v[228:231], a[60:63], v[48:63]
ds_read_b64_tr_b16 v[244:245], v17 offset:34816
ds_read_b64_tr_b16 v[246:247], v17 offset:35840
buffer_load_dwordx4 a[108:111], v8, s[48:51], s89 offen offset:3072 sc1
s_waitcnt vmcnt(12) lgkmcnt(4)
v_mfma_f32_32x32x16_bf16 v[32:47], v[232:235], a[64:67], v[32:47]
ds_read_b64_tr_b16 v[224:225], v16 offset:36864
ds_read_b64_tr_b16 v[226:227], v16 offset:37888
v_mfma_f32_32x32x16_bf16 v[48:63], v[236:239], a[64:67], v[48:63]
ds_read_b64_tr_b16 v[228:229], v17 offset:36864
ds_read_b64_tr_b16 v[230:231], v17 offset:37888
buffer_load_dwordx4 a[112:115], v8, s[48:51], s90 offen offset:0 sc1
s_waitcnt vmcnt(12) lgkmcnt(4)
v_mfma_f32_32x32x16_bf16 v[32:47], v[240:243], a[68:71], v[32:47]
ds_read_b64_tr_b16 v[232:233], v16 offset:38912
ds_read_b64_tr_b16 v[234:235], v16 offset:39936
v_mfma_f32_32x32x16_bf16 v[48:63], v[244:247], a[68:71], v[48:63]
ds_read_b64_tr_b16 v[236:237], v17 offset:38912
ds_read_b64_tr_b16 v[238:239], v17 offset:39936
buffer_load_dwordx4 a[116:119], v8, s[48:51], s90 offen offset:1024 sc1
s_waitcnt vmcnt(11) lgkmcnt(4)
v_mfma_f32_32x32x16_bf16 v[32:47], v[224:227], a[72:75], v[32:47]
ds_read_b64_tr_b16 v[240:241], v16 offset:40960
ds_read_b64_tr_b16 v[242:243], v16 offset:41984
v_mfma_f32_32x32x16_bf16 v[48:63], v[228:231], a[72:75], v[48:63]
ds_read_b64_tr_b16 v[244:245], v17 offset:40960
ds_read_b64_tr_b16 v[246:247], v17 offset:41984
buffer_load_dwordx4 a[120:123], v8, s[48:51], s90 offen offset:2048 sc1
s_waitcnt vmcnt(11) lgkmcnt(4)
v_mfma_f32_32x32x16_bf16 v[32:47], v[232:235], a[76:79], v[32:47]
ds_read_b64_tr_b16 v[224:225], v16 offset:43008
ds_read_b64_tr_b16 v[226:227], v16 offset:44032
v_cmp_ne_u64 vcc, s[8:9], v[98:99]
s_cbranch_vccz L_chk5x
s_mov_b32 s10, 0x20000
L_chk5:
buffer_load_dwordx2 v[98:99], v10, s[48:51], s7 offen sc1
s_sub_u32 s10, s10, 1
s_waitcnt vmcnt(0)
s_cbranch_scc1 L_chk5x
v_cmp_ne_u64 vcc, s[8:9], v[98:99]
s_cbranch_vccnz L_chk5
L_chk5x:
v_mfma_f32_32x32x16_bf16 v[48:63], v[236:239], a[76:79], v[48:63]
ds_read_b64_tr_b16 v[228:229], v17 offset:43008
ds_read_b64_tr_b16 v[230:231], v17 offset:44032
buffer_load_dwordx4 a[124:127], v8, s[48:51], s90 offen offset:3072 sc1
s_waitcnt vmcnt(11) lgkmcnt(4)
v_mfma_f32_32x32x16_bf16 v[32:47], v[240:243], a[80:83], v[32:47]
ds_read_b64_tr_b16 v[232:233], v16 offset:45056
ds_read_b64_tr_b16 v[234:235], v16 offset:46080
buffer_load_dword v100, v11, s[48:51], s69 offen offset:0 sc1
v_mfma_f32_32x32x16_bf16 v[48:63], v[244:247], a[80:83], v[48:63]
ds_read_b64_tr_b16 v[236:237], v17 offset:45056
ds_read_b64_tr_b16 v[238:239], v17 offset:46080
buffer_load_dwordx4 a[128:131], v8, s[48:51], s91 offen offset:0 sc1
s_waitcnt vmcnt(12) lgkmcnt(4)
v_mfma_f32_32x32x16_bf16 v[32:47], v[224:227], a[84:87], v[32:47]
ds_read_b64_tr_b16 v[240:241], v16 offset:47104
ds_read_b64_tr_b16 v[242:243], v16 offset:48128
buffer_load_dword v102, v11, s[48:51], s69 offen offset:128 sc1
v_mfma_f32_32x32x16_bf16 v[48:63], v[228:231], a[84:87], v[48:63]
ds_read_b64_tr_b16 v[244:245], v17 offset:47104
ds_read_b64_tr_b16 v[246:247], v17 offset:48128
buffer_load_dwordx4 a[132:135], v8, s[48:51], s91 offen offset:1024 sc1
s_waitcnt vmcnt(13) lgkmcnt(4)
v_mfma_f32_32x32x16_bf16 v[32:47], v[232:235], a[88:91], v[32:47]
ds_read_b64_tr_b16 v[224:225], v16 offset:49152
ds_read_b64_tr_b16 v[226:227], v16 offset:50176
buffer_load_dword v104, v11, s[48:51], s69 offen offset:256 sc1
v_mfma_f32_32x32x16_bf16 v[48:63], v[236:239], a[88:91], v[48:63]
ds_read_b64_tr_b16 v[228:229], v17 offset:49152
ds_read_b64_tr_b16 v[230:231], v17 offset:50176
buffer_load_dwordx4 a[136:139], v8, s[48:51], s91 offen offset:2048 sc1
s_waitcnt vmcnt(14) lgkmcnt(4)
v_mfma_f32_32x32x16_bf16 v[32:47], v[240:243], a[92:95], v[32:47]
ds_read_b64_tr_b16 v[232:233], v16 offset:51200
ds_read_b64_tr_b16 v[234:235], v16 offset:52224
buffer_load_dword v106, v11, s[48:51], s69 offen offset:384 sc1
v_mfma_f32_32x32x16_bf16 v[48:63], v[244:247], a[92:95], v[48:63]
ds_read_b64_tr_b16 v[236:237], v17 offset:51200
ds_read_b64_tr_b16 v[238:239], v17 offset:52224
buffer_load_dwordx4 a[140:143], v8, s[48:51], s91 offen offset:3072 sc1
s_waitcnt vmcnt(15) lgkmcnt(4)
v_mfma_f32_32x32x16_bf16 v[32:47], v[224:227], a[96:99], v[32:47]
ds_read_b64_tr_b16 v[240:241], v16 offset:53248
ds_read_b64_tr_b16 v[242:243], v16 offset:54272
v_add_f32 v80, v80, v82
v_add_f32 v81, v81, v83
v_mfma_f32_32x32x16_bf16 v[48:63], v[228:231], a[96:99], v[48:63]
ds_read_b64_tr_b16 v[244:245], v17 offset:53248
ds_read_b64_tr_b16 v[246:247], v17 offset:54272
buffer_load_dwordx4 a[144:147], v8, s[48:51], s92 offen offset:0 sc1
v_add_f32 v84, v84, v86
v_add_f32 v85, v85, v87
s_waitcnt vmcnt(15) lgkmcnt(4)
v_mfma_f32_32x32x16_bf16 v[32:47], v[232:235], a[100:103], v[32:47]
ds_read_b64_tr_b16 v[224:225], v16 offset:55296
ds_read_b64_tr_b16 v[226:227], v16 offset:56320
v_add_f32 v80, v80, v84
v_add_f32 v81, v81, v85
v_mfma_f32_32x32x16_bf16 v[48:63], v[236:239], a[100:103], v[48:63]
ds_read_b64_tr_b16 v[228:229], v17 offset:55296
ds_read_b64_tr_b16 v[230:231], v17 offset:56320
buffer_load_dwordx4 a[148:151], v8, s[48:51], s92 offen offset:1024 sc1
v_add_f32 v80, v80, v88
v_add_f32 v81, v81, v89
s_waitcnt vmcnt(15) lgkmcnt(4)
v_mfma_f32_32x32x16_bf16 v[32:47], v[240:243], a[104:107], v[32:47]
ds_read_b64_tr_b16 v[232:233], v16 offset:57344
ds_read_b64_tr_b16 v[234:235], v16 offset:58368
v_mov_b32 v248, v80
s_nop 1
v_permlane32_swap_b32 v80, v248
v_mfma_f32_32x32x16_bf16 v[48:63], v[244:247], a[104:107], v[48:63]
ds_read_b64_tr_b16 v[236:237], v17 offset:57344
ds_read_b64_tr_b16 v[238:239], v17 offset:58368
buffer_load_dwordx4 a[152:155], v8, s[48:51], s92 offen offset:2048 sc1
v_add_f32 v80, v80, v248
v_mov_b32 v249, v81
s_waitcnt vmcnt(15) lgkmcnt(4)
v_mfma_f32_32x32x16_bf16 v[32:47], v[224:227], a[108:111], v[32:47]
ds_read_b64_tr_b16 v[240:241], v16 offset:59392
ds_read_b64_tr_b16 v[242:243], v16 offset:60416
v_permlane32_swap_b32 v81, v249
v_add_f32 v81, v81, v249
v_mfma_f32_32x32x16_bf16 v[48:63], v[228:231], a[108:111], v[48:63]
ds_read_b64_tr_b16 v[244:245], v17 offset:59392
ds_read_b64_tr_b16 v[246:247], v17 offset:60416
buffer_load_dwordx4 a[156:159], v8, s[48:51], s92 offen offset:3072 sc1
v_mul_f32 v20, 0x3acccccd, v80
v_mul_f32 v249, 0.5, v20
s_waitcnt vmcnt(15) lgkmcnt(4)
v_mfma_f32_32x32x16_bf16 v[32:47], v[232:235], a[112:115], v[32:47]
ds_read_b64_tr_b16 v[224:225], v16 offset:61440
ds_read_b64_tr_b16 v[226:227], v16 offset:62464
v_cvt_pk_bf16_f32 v26, -v249, -v249
v_and_b32 v248, 0xffff0000, v26
v_mfma_f32_32x32x16_bf16 v[48:63], v[236:239], a[112:115], v[48:63]
ds_read_b64_tr_b16 v[228:229], v17 offset:61440
ds_read_b64_tr_b16 v[230:231], v17 offset:62464
buffer_load_dwordx4 a[192:195], v22, s[48:51], s23 offen offset:3072 sc1
v_sub_f32_e64 v248, -v249, v248
v_cvt_pk_bf16_f32 v27, v248, v248
s_waitcnt vmcnt(15) lgkmcnt(4)
v_mfma_f32_32x32x16_bf16 v[32:47], v[240:243], a[116:119], v[32:47]
ds_read_b64_tr_b16 v[232:233], v16 offset:63488
ds_read_b64_tr_b16 v[234:235], v16 offset:64512
v_mul_f32 v21, 0x3acccccd, v81
v_fma_f32 v21, -v20, v20, v21
v_mfma_f32_32x32x16_bf16 v[48:63], v[244:247], a[116:119], v[48:63]
ds_read_b64_tr_b16 v[236:237], v17 offset:63488
ds_read_b64_tr_b16 v[238:239], v17 offset:64512
buffer_load_dwordx4 a[196:199], v23, s[48:51], s23 offen offset:0 sc1
v_max_f32 v21, 0, v21
v_add_f32 v248, 0x3727c5ac, v21
s_waitcnt vmcnt(15) lgkmcnt(4)
v_mfma_f32_32x32x16_bf16 v[32:47], v[224:227], a[120:123], v[32:47]
ds_read_b64_tr_b16 v[240:241], v18 offset:0
ds_read_b64_tr_b16 v[242:243], v18 offset:1024
v_rsq_f32 v248, v248
s_nop 0
v_mul_f32 v24, 0xc0135761, v248
v_mfma_f32_32x32x16_bf16 v[48:63], v[228:231], a[120:123], v[48:63]
ds_read_b64_tr_b16 v[244:245], v19 offset:0
ds_read_b64_tr_b16 v[246:247], v19 offset:1024
s_mul_i32 s23, s18, 20
s_add_u32 s23, s23, s22
buffer_load_dwordx4 a[200:203], v22, s[48:51], s23 offen offset:0 sc1
v_mul_f32 v28, v248, v248
v_rcp_f32 v30, v248
s_waitcnt vmcnt(15) lgkmcnt(4)
v_mfma_f32_32x32x16_bf16 v[32:47], v[232:235], a[124:127], v[32:47]
ds_read_b64_tr_b16 v[224:225], v18 offset:2048
ds_read_b64_tr_b16 v[226:227], v18 offset:3072
v_mul_f32 v28, v28, v248
v_mul_f32 v28, 0xbdd2d3e8, v28
v_mfma_f32_32x32x16_bf16 v[48:63], v[236:239], a[124:127], v[48:63]
ds_read_b64_tr_b16 v[228:229], v19 offset:2048
ds_read_b64_tr_b16 v[230:231], v19 offset:3072
buffer_load_dwordx4 a[204:207], v22, s[48:51], s23 offen offset:1024 sc1
s_waitcnt vmcnt(14) lgkmcnt(4)
v_mfma_f32_32x32x16_bf16 v[32:47], v[240:243], a[128:131], v[32:47]
ds_read_b64_tr_b16 v[232:233], v18 offset:4096
ds_read_b64_tr_b16 v[234:235], v18 offset:5120
v_mfma_f32_32x32x16_bf16 v[48:63], v[244:247], a[128:131], v[48:63]
ds_read_b64_tr_b16 v[236:237], v19 offset:4096
ds_read_b64_tr_b16 v[238:239], v19 offset:5120
buffer_load_dwordx4 a[208:211], v22, s[48:51], s23 offen offset:2048 sc1
s_waitcnt vmcnt(13) lgkmcnt(4)
v_mfma_f32_32x32x16_bf16 v[32:47], v[224:227], a[132:135], v[32:47]
ds_read_b64_tr_b16 v[240:241], v18 offset:6144
ds_read_b64_tr_b16 v[242:243], v18 offset:7168
v_mfma_f32_32x32x16_bf16 v[48:63], v[228:231], a[132:135], v[48:63]
ds_read_b64_tr_b16 v[244:245], v19 offset:6144
ds_read_b64_tr_b16 v[246:247], v19 offset:7168
buffer_load_dwordx4 a[212:215], v22, s[48:51], s23 offen offset:3072 sc1
s_waitcnt vmcnt(12) lgkmcnt(4)
v_mfma_f32_32x32x16_bf16 v[32:47], v[232:235], a[136:139], v[32:47]
ds_read_b64_tr_b16 v[224:225], v18 offset:8192
ds_read_b64_tr_b16 v[226:227], v18 offset:9216
v_mfma_f32_32x32x16_bf16 v[48:63], v[236:239], a[136:139], v[48:63]
ds_read_b64_tr_b16 v[228:229], v19 offset:8192
ds_read_b64_tr_b16 v[230:231], v19 offset:9216
buffer_load_dwordx4 a[216:219], v23, s[48:51], s23 offen offset:0 sc1
s_waitcnt vmcnt(11) lgkmcnt(4)
v_mfma_f32_32x32x16_bf16 v[32:47], v[240:243], a[140:143], v[32:47]
ds_read_b64_tr_b16 v[232:233], v18 offset:10240
ds_read_b64_tr_b16 v[234:235], v18 offset:11264
v_mfma_f32_32x32x16_bf16 v[48:63], v[244:247], a[140:143], v[48:63]
ds_read_b64_tr_b16 v[236:237], v19 offset:10240
ds_read_b64_tr_b16 v[238:239], v19 offset:11264
s_mul_i32 s23, s19, 20
s_add_u32 s23, s23, s22
buffer_load_dwordx4 a[220:223], v22, s[48:51], s23 offen offset:0 sc1
s_waitcnt vmcnt(11) lgkmcnt(4)
v_mfma_f32_32x32x16_bf16 v[32:47], v[224:227], a[144:147], v[32:47]
ds_read_b64_tr_b16 v[240:241], v18 offset:12288
ds_read_b64_tr_b16 v[242:243], v18 offset:13312
v_mfma_f32_32x32x16_bf16 v[48:63], v[228:231], a[144:147], v[48:63]
ds_read_b64_tr_b16 v[244:245], v19 offset:12288
ds_read_b64_tr_b16 v[246:247], v19 offset:13312
buffer_load_dwordx4 a[224:227], v22, s[48:51], s23 offen offset:1024 sc1
s_waitcnt vmcnt(11) lgkmcnt(4)
v_mfma_f32_32x32x16_bf16 v[32:47], v[232:235], a[148:151], v[32:47]
ds_read_b64_tr_b16 v[224:225], v18 offset:14336
ds_read_b64_tr_b16 v[226:227], v18 offset:15360
v_mov_b32 v101, v100
v_mov_b32 v103, v102
v_mfma_f32_32x32x16_bf16 v[48:63], v[236:239], a[148:151], v[48:63]
ds_read_b64_tr_b16 v[228:229], v19 offset:14336
ds_read_b64_tr_b16 v[230:231], v19 offset:15360
buffer_load_dwordx4 a[228:231], v22, s[48:51], s23 offen offset:2048 sc1
s_waitcnt vmcnt(11) lgkmcnt(4)
v_mfma_f32_32x32x16_bf16 v[32:47], v[240:243], a[152:155], v[32:47]
v_mov_b32 v105, v104
v_mov_b32 v107, v106
v_mfma_f32_32x32x16_bf16 v[48:63], v[244:247], a[152:155], v[48:63]
buffer_load_dwordx4 a[232:235], v22, s[48:51], s23 offen offset:3072 sc1
s_waitcnt vmcnt(11) lgkmcnt(0)
v_mfma_f32_32x32x16_bf16 v[32:47], v[224:227], a[156:159], v[32:47]
v_mfma_f32_32x32x16_bf16 v[48:63], v[228:231], a[156:159], v[48:63]
buffer_load_dwordx4 a[236:239], v23, s[48:51], s23 offen offset:0 sc1
s_nop 7
v_mfma_f32_32x32x8_bf16 v[32:47], v[100:101], v[26:27], v[32:47]
v_mfma_f32_32x32x8_bf16 v[48:63], v[102:103], v[26:27], v[48:63]
v_add_u32 v16, 4294885376, v16
v_add_u32 v17, 4294885376, v17
v_add_u32 v18, 4294885376, v18
v_add_u32 v19, 4294885376, v19
ds_read_b64_tr_b16 v[224:225], v16 offset:0
ds_read_b64_tr_b16 v[226:227], v16 offset:1024
ds_read_b64_tr_b16 v[228:229], v17 offset:0
ds_read_b64_tr_b16 v[230:231], v17 offset:1024
ds_read_b64_tr_b16 v[232:233], v16 offset:2048
ds_read_b64_tr_b16 v[234:235], v16 offset:3072
ds_read_b64_tr_b16 v[236:237], v17 offset:2048
ds_read_b64_tr_b16 v[238:239], v17 offset:3072
v_pk_mul_f32 v[90:91], v[32:33], v[32:33]
v_pk_mul_f32 v[92:93], v[34:35], v[34:35]
v_pk_mul_f32 v[94:95], v[36:37], v[36:37]
v_pk_mul_f32 v[96:97], v[38:39], v[38:39]
v_pk_fma_f32 v[90:91], v[90:91], v[28:29], v[24:25] op_sel_hi:[1,0,0]
v_pk_fma_f32 v[92:93], v[92:93], v[28:29], v[24:25] op_sel_hi:[1,0,0]
v_pk_fma_f32 v[94:95], v[94:95], v[28:29], v[24:25] op_sel_hi:[1,0,0]
v_pk_fma_f32 v[96:97], v[96:97], v[28:29], v[24:25] op_sel_hi:[1,0,0]
v_pk_mul_f32 v[90:91], v[90:91], v[32:33]
v_pk_mul_f32 v[92:93], v[92:93], v[34:35]
v_pk_mul_f32 v[94:95], v[94:95], v[36:37]
v_pk_mul_f32 v[96:97], v[96:97], v[38:39]
s_mul_i32 s23, s20, 20
s_add_u32 s23, s23, s22
buffer_load_dwordx4 a[240:243], v22, s[48:51], s23 offen offset:0 sc1
v_exp_f32 v90, v90
v_exp_f32 v91, v91
v_exp_f32 v92, v92
v_exp_f32 v93, v93
v_exp_f32 v94, v94
v_exp_f32 v95, v95
v_exp_f32 v96, v96
v_exp_f32 v97, v97
v_pk_fma_f32 v[90:91], v[90:91], v[30:31], v[30:31] op_sel_hi:[1,0,0]
v_pk_fma_f32 v[92:93], v[92:93], v[30:31], v[30:31] op_sel_hi:[1,0,0]
v_pk_fma_f32 v[94:95], v[94:95], v[30:31], v[30:31] op_sel_hi:[1,0,0]
v_pk_fma_f32 v[96:97], v[96:97], v[30:31], v[30:31] op_sel_hi:[1,0,0]
buffer_load_dwordx4 a[244:247], v22, s[48:51], s23 offen offset:1024 sc1
v_rcp_f32 v90, v90
v_rcp_f32 v91, v91
v_rcp_f32 v92, v92
v_rcp_f32 v93, v93
v_rcp_f32 v94, v94
v_rcp_f32 v95, v95
v_rcp_f32 v96, v96
v_rcp_f32 v97, v97
v_pk_mul_f32 v[32:33], v[32:33], v[90:91]
v_pk_mul_f32 v[34:35], v[34:35], v[92:93]
v_pk_mul_f32 v[36:37], v[36:37], v[94:95]
v_pk_mul_f32 v[38:39], v[38:39], v[96:97]
buffer_load_dwordx4 a[248:251], v22, s[48:51], s23 offen offset:2048 sc1
v_cvt_pk_bf16_f32 v64, v32, v33
v_cvt_pk_bf16_f32 v65, v34, v35
v_cvt_pk_bf16_f32 v66, v36, v37
v_cvt_pk_bf16_f32 v67, v38, v39
buffer_store_dwordx4 v[64:67], v8, s[48:51], s70 offen offset:0 sc1
v_pk_mul_f32 v[90:91], v[40:41], v[40:41]
v_pk_mul_f32 v[92:93], v[42:43], v[42:43]
v_pk_mul_f32 v[94:95], v[44:45], v[44:45]
v_pk_mul_f32 v[96:97], v[46:47], v[46:47]
v_pk_fma_f32 v[90:91], v[90:91], v[28:29], v[24:25] op_sel_hi:[1,0,0]
v_pk_fma_f32 v[92:93], v[92:93], v[28:29], v[24:25] op_sel_hi:[1,0,0]
v_pk_fma_f32 v[94:95], v[94:95], v[28:29], v[24:25] op_sel_hi:[1,0,0]
v_pk_fma_f32 v[96:97], v[96:97], v[28:29], v[24:25] op_sel_hi:[1,0,0]
v_pk_mul_f32 v[90:91], v[90:91], v[40:41]
v_pk_mul_f32 v[92:93], v[92:93], v[42:43]
v_pk_mul_f32 v[94:95], v[94:95], v[44:45]
v_pk_mul_f32 v[96:97], v[96:97], v[46:47]
buffer_load_dwordx4 a[252:255], v22, s[48:51], s23 offen offset:3072 sc1
v_exp_f32 v90, v90
v_exp_f32 v91, v91
v_exp_f32 v92, v92
v_exp_f32 v93, v93
v_exp_f32 v94, v94
v_exp_f32 v95, v95
v_exp_f32 v96, v96
v_exp_f32 v97, v97
v_pk_fma_f32 v[90:91], v[90:91], v[30:31], v[30:31] op_sel_hi:[1,0,0]
v_pk_fma_f32 v[92:93], v[92:93], v[30:31], v[30:31] op_sel_hi:[1,0,0]
v_pk_fma_f32 v[94:95], v[94:95], v[30:31], v[30:31] op_sel_hi:[1,0,0]
v_pk_fma_f32 v[96:97], v[96:97], v[30:31], v[30:31] op_sel_hi:[1,0,0]
buffer_load_dwordx4 v[160:163], v23, s[48:51], s23 offen offset:0 sc1
v_rcp_f32 v90, v90
v_rcp_f32 v91, v91
v_rcp_f32 v92, v92
v_rcp_f32 v93, v93
v_rcp_f32 v94, v94
v_rcp_f32 v95, v95
v_rcp_f32 v96, v96
v_rcp_f32 v97, v97
v_pk_mul_f32 v[40:41], v[40:41], v[90:91]
v_pk_mul_f32 v[42:43], v[42:43], v[92:93]
v_pk_mul_f32 v[44:45], v[44:45], v[94:95]
v_pk_mul_f32 v[46:47], v[46:47], v[96:97]
s_mul_i32 s23, s21, 20
s_add_u32 s23, s23, s22
buffer_load_dwordx4 v[164:167], v22, s[48:51], s23 offen offset:0 sc1
v_cvt_pk_bf16_f32 v68, v40, v41
v_cvt_pk_bf16_f32 v69, v42, v43
v_cvt_pk_bf16_f32 v70, v44, v45
v_cvt_pk_bf16_f32 v71, v46, v47
buffer_store_dwordx4 v[68:71], v8, s[48:51], s70 offen offset:1024 sc1
v_pk_mul_f32 v[90:91], v[48:49], v[48:49]
v_pk_mul_f32 v[92:93], v[50:51], v[50:51]
v_pk_mul_f32 v[94:95], v[52:53], v[52:53]
v_pk_mul_f32 v[96:97], v[54:55], v[54:55]
v_pk_fma_f32 v[90:91], v[90:91], v[28:29], v[24:25] op_sel_hi:[1,0,0]
v_pk_fma_f32 v[92:93], v[92:93], v[28:29], v[24:25] op_sel_hi:[1,0,0]
v_pk_fma_f32 v[94:95], v[94:95], v[28:29], v[24:25] op_sel_hi:[1,0,0]
v_pk_fma_f32 v[96:97], v[96:97], v[28:29], v[24:25] op_sel_hi:[1,0,0]
v_pk_mul_f32 v[90:91], v[90:91], v[48:49]
v_pk_mul_f32 v[92:93], v[92:93], v[50:51]
v_pk_mul_f32 v[94:95], v[94:95], v[52:53]
v_pk_mul_f32 v[96:97], v[96:97], v[54:55]
buffer_load_dwordx4 v[168:171], v22, s[48:51], s23 offen offset:1024 sc1
v_exp_f32 v90, v90
v_exp_f32 v91, v91
v_exp_f32 v92, v92
v_exp_f32 v93, v93
v_exp_f32 v94, v94
v_exp_f32 v95, v95
v_exp_f32 v96, v96
v_exp_f32 v97, v97
v_pk_fma_f32 v[90:91], v[90:91], v[30:31], v[30:31] op_sel_hi:[1,0,0]
v_pk_fma_f32 v[92:93], v[92:93], v[30:31], v[30:31] op_sel_hi:[1,0,0]
v_pk_fma_f32 v[94:95], v[94:95], v[30:31], v[30:31] op_sel_hi:[1,0,0]
v_pk_fma_f32 v[96:97], v[96:97], v[30:31], v[30:31] op_sel_hi:[1,0,0]
buffer_load_dwordx4 v[172:175], v22, s[48:51], s23 offen offset:2048 sc1
v_rcp_f32 v90, v90
v_rcp_f32 v91, v91
v_rcp_f32 v92, v92
v_rcp_f32 v93, v93
v_rcp_f32 v94, v94
v_rcp_f32 v95, v95
v_rcp_f32 v96, v96
v_rcp_f32 v97, v97
v_pk_mul_f32 v[48:49], v[48:49], v[90:91]
v_pk_mul_f32 v[50:51], v[50:51], v[92:93]
v_pk_mul_f32 v[52:53], v[52:53], v[94:95]
v_pk_mul_f32 v[54:55], v[54:55], v[96:97]
buffer_load_dwordx4 v[176:179], v22, s[48:51], s23 offen offset:3072 sc1
v_cvt_pk_bf16_f32 v72, v48, v49
v_cvt_pk_bf16_f32 v73, v50, v51
v_cvt_pk_bf16_f32 v74, v52, v53
v_cvt_pk_bf16_f32 v75, v54, v55
buffer_store_dwordx4 v[72:75], v8, s[48:51], s70 offen offset:2048 sc1
v_pk_mul_f32 v[90:91], v[56:57], v[56:57]
v_pk_mul_f32 v[92:93], v[58:59], v[58:59]
v_pk_mul_f32 v[94:95], v[60:61], v[60:61]
v_pk_mul_f32 v[96:97], v[62:63], v[62:63]
v_pk_fma_f32 v[90:91], v[90:91], v[28:29], v[24:25] op_sel_hi:[1,0,0]
v_pk_fma_f32 v[92:93], v[92:93], v[28:29], v[24:25] op_sel_hi:[1,0,0]
v_pk_fma_f32 v[94:95], v[94:95], v[28:29], v[24:25] op_sel_hi:[1,0,0]
v_pk_fma_f32 v[96:97], v[96:97], v[28:29], v[24:25] op_sel_hi:[1,0,0]
v_pk_mul_f32 v[90:91], v[90:91], v[56:57]
v_pk_mul_f32 v[92:93], v[92:93], v[58:59]
v_pk_mul_f32 v[94:95], v[94:95], v[60:61]
v_pk_mul_f32 v[96:97], v[96:97], v[62:63]
buffer_load_dwordx4 v[180:183], v23, s[48:51], s23 offen offset:0 sc1
v_exp_f32 v90, v90
v_exp_f32 v91, v91
v_exp_f32 v92, v92
v_exp_f32 v93, v93
v_exp_f32 v94, v94
v_exp_f32 v95, v95
v_exp_f32 v96, v96
v_exp_f32 v97, v97
v_pk_fma_f32 v[90:91], v[90:91], v[30:31], v[30:31] op_sel_hi:[1,0,0]
v_pk_fma_f32 v[92:93], v[92:93], v[30:31], v[30:31] op_sel_hi:[1,0,0]
v_pk_fma_f32 v[94:95], v[94:95], v[30:31], v[30:31] op_sel_hi:[1,0,0]
v_pk_fma_f32 v[96:97], v[96:97], v[30:31], v[30:31] op_sel_hi:[1,0,0]
s_mul_i32 s23, s73, 20
s_add_u32 s23, s23, s31
buffer_load_dwordx4 v[184:187], v22, s[48:51], s23 offen offset:0 sc1
v_rcp_f32 v90, v90
v_rcp_f32 v91, v91
v_rcp_f32 v92, v92
v_rcp_f32 v93, v93
v_rcp_f32 v94, v94
v_rcp_f32 v95, v95
v_rcp_f32 v96, v96
v_rcp_f32 v97, v97
v_pk_mul_f32 v[56:57], v[56:57], v[90:91]
v_pk_mul_f32 v[58:59], v[58:59], v[92:93]
v_pk_mul_f32 v[60:61], v[60:61], v[94:95]
v_pk_mul_f32 v[62:63], v[62:63], v[96:97]
buffer_load_dwordx4 v[188:191], v22, s[48:51], s23 offen offset:1024 sc1
v_cvt_pk_bf16_f32 v76, v56, v57
v_cvt_pk_bf16_f32 v77, v58, v59
v_cvt_pk_bf16_f32 v78, v60, v61
v_cvt_pk_bf16_f32 v79, v62, v63
buffer_store_dwordx4 v[76:79], v8, s[48:51], s70 offen offset:3072 sc1
s_barrier
v_mfma_f32_32x32x8_bf16 v[32:47], v[104:105], v[26:27], 0
v_mfma_f32_32x32x8_bf16 v[48:63], v[106:107], v[26:27], 0
s_waitcnt lgkmcnt(4)
s_nop 7
v_mfma_f32_32x32x16_bf16 v[32:47], v[224:227], a[0:3], v[32:47]
ds_read_b64_tr_b16 v[240:241], v16 offset:4096
ds_read_b64_tr_b16 v[242:243], v16 offset:5120
v_and_b32 v248, 1, v1
v_lshrrev_b32 v249, 1, v1
v_min_u32 v249, 2, v249
v_mfma_f32_32x32x16_bf16 v[48:63], v[228:231], a[0:3], v[48:63]
ds_read_b64_tr_b16 v[244:245], v17 offset:4096
ds_read_b64_tr_b16 v[246:247], v17 offset:5120
buffer_load_dwordx4 v[192:195], v22, s[48:51], s23 offen offset:2048 sc1
v_lshlrev_b32 v249, 8, v249
s_waitcnt lgkmcnt(4)
v_mfma_f32_32x32x16_bf16 v[32:47], v[232:235], a[4:7], v[32:47]
ds_read_b64_tr_b16 v[224:225], v16 offset:6144
ds_read_b64_tr_b16 v[226:227], v16 offset:7168
v_lshl_add_u32 v10, v248, 12, v249
v_lshlrev_b32 v11, 7, v248
s_lshl_b32 s83, s25, 13
v_mfma_f32_32x32x16_bf16 v[48:63], v[236:239], a[4:7], v[48:63]
ds_read_b64_tr_b16 v[228:229], v17 offset:6144
ds_read_b64_tr_b16 v[230:231], v17 offset:7168
buffer_load_dwordx4 v[196:199], v22, s[48:51], s23 offen offset:3072 sc1
s_mul_i32 s11, s3, 768
s_waitcnt lgkmcnt(4)
v_mfma_f32_32x32x16_bf16 v[32:47], v[240:243], a[8:11], v[32:47]
ds_read_b64_tr_b16 v[232:233], v16 offset:8192
ds_read_b64_tr_b16 v[234:235], v16 offset:9216
s_add_u32 s83, s83, s11
s_add_u32 s83, s83, 22413312
s_add_u32 s84, s83, 128
v_mfma_f32_32x32x16_bf16 v[48:63], v[244:247], a[8:11], v[48:63]
ds_read_b64_tr_b16 v[236:237], v17 offset:8192
ds_read_b64_tr_b16 v[238:239], v17 offset:9216
buffer_load_dwordx4 v[200:203], v23, s[48:51], s23 offen offset:0 sc1
s_lshl_b32 s85, s25, 10
s_waitcnt lgkmcnt(4)
v_mfma_f32_32x32x16_bf16 v[32:47], v[224:227], a[12:15], v[32:47]
ds_read_b64_tr_b16 v[240:241], v16 offset:10240
ds_read_b64_tr_b16 v[242:243], v16 offset:11264
s_lshl_b32 s11, s3, 8
s_add_u32 s85, s85, s11
s_add_u32 s85, s85, 22708224
v_mfma_f32_32x32x16_bf16 v[48:63], v[228:231], a[12:15], v[48:63]
ds_read_b64_tr_b16 v[244:245], v17 offset:10240
ds_read_b64_tr_b16 v[246:247], v17 offset:11264
s_mul_i32 s23, s74, 20
s_add_u32 s23, s23, s31
buffer_load_dwordx4 v[204:207], v22, s[48:51], s23 offen offset:0 sc1
s_mul_i32 s86, s3, 24576
s_waitcnt lgkmcnt(4)
v_mfma_f32_32x32x16_bf16 v[32:47], v[232:235], a[16:19], v[32:47]
ds_read_b64_tr_b16 v[224:225], v16 offset:12288
ds_read_b64_tr_b16 v[226:227], v16 offset:13312
s_add_u32 s86, s86, 10485760
s_add_u32 s87, s86, 4096
s_mul_i32 s88, s3, 10240
v_mfma_f32_32x32x16_bf16 v[48:63], v[236:239], a[16:19], v[48:63]
ds_read_b64_tr_b16 v[228:229], v17 offset:12288
ds_read_b64_tr_b16 v[230:231], v17 offset:13312
buffer_load_dwordx4 v[208:211], v22, s[48:51], s23 offen offset:1024 sc1
s_add_u32 s88, s88, 7864320
s_waitcnt lgkmcnt(4)
v_mfma_f32_32x32x16_bf16 v[32:47], v[240:243], a[20:23], v[32:47]
ds_read_b64_tr_b16 v[232:233], v16 offset:14336
ds_read_b64_tr_b16 v[234:235], v16 offset:15360
v_lshl_add_u32 v29, v1, 4, s65
v_and_b32 v248, 15, v1
v_lshrrev_b32 v249, 4, v1
v_mfma_f32_32x32x16_bf16 v[48:63], v[244:247], a[20:23], v[48:63]
ds_read_b64_tr_b16 v[236:237], v17 offset:14336
ds_read_b64_tr_b16 v[238:239], v17 offset:15360
buffer_load_dwordx4 v[212:215], v22, s[48:51], s23 offen offset:2048 sc1
v_lshlrev_b32 v250, 9, v249
s_waitcnt lgkmcnt(4)
v_mfma_f32_32x32x16_bf16 v[32:47], v[224:227], a[24:27], v[32:47]
ds_read_b64_tr_b16 v[240:241], v16 offset:16384
ds_read_b64_tr_b16 v[242:243], v16 offset:17408
v_lshl_add_u32 v250, v248, 4, v250
s_add_u32 s11, s3, 0
s_and_b32 s11, s11, 3
v_mfma_f32_32x32x16_bf16 v[48:63], v[228:231], a[24:27], v[48:63]
ds_read_b64_tr_b16 v[244:245], v17 offset:16384
ds_read_b64_tr_b16 v[246:247], v17 offset:17408
buffer_load_dwordx4 v[216:219], v22, s[48:51], s23 offen offset:3072 sc1
s_lshr_b32 s12, s11, 1
s_waitcnt lgkmcnt(4)
v_mfma_f32_32x32x16_bf16 v[32:47], v[232:235], a[28:31], v[32:47]
ds_read_b64_tr_b16 v[224:225], v16 offset:18432
ds_read_b64_tr_b16 v[226:227], v16 offset:19456
s_lshl_b32 s13, s25, 1
s_add_u32 s12, s12, s13
s_and_b32 s13, s11, 1
v_mfma_f32_32x32x16_bf16 v[48:63], v[236:239], a[28:31], v[48:63]
ds_read_b64_tr_b16 v[228:229], v17 offset:18432
ds_read_b64_tr_b16 v[230:231], v17 offset:19456
buffer_load_dwordx4 v[220:223], v23, s[48:51], s23 offen offset:0 sc1
s_lshl_b32 s13, s13, 8
s_waitcnt lgkmcnt(4)
v_mfma_f32_32x32x16_bf16 v[32:47], v[240:243], a[32:35], v[32:47]
ds_read_b64_tr_b16 v[232:233], v16 offset:20480
ds_read_b64_tr_b16 v[234:235], v16 offset:21504
s_mul_i32 s14, s12, 98304
s_add_u32 s14, s14, s13
v_add_u32 v12, s14, v250
v_mfma_f32_32x32x16_bf16 v[48:63], v[244:247], a[32:35], v[48:63]
ds_read_b64_tr_b16 v[236:237], v17 offset:20480
ds_read_b64_tr_b16 v[238:239], v17 offset:21504
s_mul_i32 s23, s75, 20
s_add_u32 s23, s23, s31
s_add_u32 m0, s65, 0
s_nop 0
buffer_load_dwordx4 v22, s[48:51], s23 offen offset:0 sc1 lds
s_mul_i32 s14, s12, 40960
s_waitcnt lgkmcnt(4)
v_mfma_f32_32x32x16_bf16 v[32:47], v[224:227], a[36:39], v[32:47]
ds_read_b64_tr_b16 v[240:241], v16 offset:22528
ds_read_b64_tr_b16 v[242:243], v16 offset:23552
s_add_u32 s14, s14, s13
v_add_u32 v4, s14, v250
s_mul_i32 s89, s11, 15360
v_mfma_f32_32x32x16_bf16 v[48:63], v[228:231], a[36:39], v[48:63]
ds_read_b64_tr_b16 v[244:245], v17 offset:22528
ds_read_b64_tr_b16 v[246:247], v17 offset:23552
buffer_load_dwordx4 v22, s[48:51], s23 offen offset:1024 sc1 lds
s_add_u32 s89, s89, 0
s_waitcnt lgkmcnt(4)
v_mfma_f32_32x32x16_bf16 v[32:47], v[232:235], a[40:43], v[32:47]
ds_read_b64_tr_b16 v[224:225], v16 offset:24576
ds_read_b64_tr_b16 v[226:227], v16 offset:25600
s_mul_i32 s13, s24, 5120
s_add_u32 s14, s14, s13
s_add_u32 s14, s14, 5242880
v_mfma_f32_32x32x16_bf16 v[48:63], v[236:239], a[40:43], v[48:63]
ds_read_b64_tr_b16 v[228:229], v17 offset:24576
ds_read_b64_tr_b16 v[230:231], v17 offset:25600
buffer_load_dwordx4 v22, s[48:51], s23 offen offset:2048 sc1 lds
v_and_b32 v251, 1, v249
s_waitcnt lgkmcnt(4)
v_mfma_f32_32x32x16_bf16 v[32:47], v[240:243], a[44:47], v[32:47]
ds_read_b64_tr_b16 v[232:233], v16 offset:26624
ds_read_b64_tr_b16 v[234:235], v16 offset:27648
v_lshlrev_b32 v251, 9, v251
v_lshl_add_u32 v251, v248, 4, v251
v_lshl_add_u32 v251, v2, 3, v251
v_mfma_f32_32x32x16_bf16 v[48:63], v[244:247], a[44:47], v[48:63]
ds_read_b64_tr_b16 v[236:237], v17 offset:26624
ds_read_b64_tr_b16 v[238:239], v17 offset:27648
buffer_load_dwordx4 v22, s[48:51], s23 offen offset:3072 sc1 lds
v_add_u32 v9, s14, v251
s_waitcnt lgkmcnt(4)
v_mfma_f32_32x32x16_bf16 v[32:47], v[224:227], a[48:51], v[32:47]
ds_read_b64_tr_b16 v[240:241], v16 offset:28672
ds_read_b64_tr_b16 v[242:243], v16 offset:29696
s_add_u32 s11, s3, 1
s_and_b32 s11, s11, 3
s_lshr_b32 s12, s11, 1
v_mfma_f32_32x32x16_bf16 v[48:63], v[228:231], a[48:51], v[48:63]
ds_read_b64_tr_b16 v[244:245], v17 offset:28672
ds_read_b64_tr_b16 v[246:247], v17 offset:29696
s_waitcnt vmcnt(12)
s_mov_b64 exec, 0xffff
buffer_store_dwordx2 v[252:253], v254, s[48:51], s71 offen sc1
s_mov_b64 exec, -1
s_add_u32 s70, s70, 4096
s_add_u32 s71, s71, 128
s_waitcnt lgkmcnt(4)
v_mfma_f32_32x32x16_bf16 v[32:47], v[232:235], a[52:55], v[32:47]
ds_read_b64_tr_b16 v[224:225], v16 offset:30720
ds_read_b64_tr_b16 v[226:227], v16 offset:31744
s_lshl_b32 s13, s25, 1
s_add_u32 s12, s12, s13
s_and_b32 s13, s11, 1
v_mfma_f32_32x32x16_bf16 v[48:63], v[236:239], a[52:55], v[48:63]
ds_read_b64_tr_b16 v[228:229], v17 offset:30720
ds_read_b64_tr_b16 v[230:231], v17 offset:31744
s_add_u32 m0, s65, 4096
s_nop 0
buffer_load_dwordx4 v23, s[48:51], s23 offen offset:0 sc1 lds
s_lshl_b32 s13, s13, 8
s_waitcnt lgkmcnt(4)
v_mfma_f32_32x32x16_bf16 v[32:47], v[240:243], a[56:59], v[32:47]
ds_read_b64_tr_b16 v[232:233], v16 offset:32768
ds_read_b64_tr_b16 v[234:235], v16 offset:33792
s_mul_i32 s14, s12, 98304
s_add_u32 s14, s14, s13
v_add_u32 v13, s14, v250
v_mfma_f32_32x32x16_bf16 v[48:63], v[244:247], a[56:59], v[48:63]
ds_read_b64_tr_b16 v[236:237], v17 offset:32768
ds_read_b64_tr_b16 v[238:239], v17 offset:33792
s_mul_i32 s23, s76, 20
s_add_u32 s23, s23, s31
s_add_u32 m0, s65, 5120
s_nop 0
buffer_load_dwordx4 v22, s[48:51], s23 offen offset:0 sc1 lds
s_mul_i32 s14, s12, 40960
s_waitcnt lgkmcnt(4)
v_mfma_f32_32x32x16_bf16 v[32:47], v[224:227], a[60:63], v[32:47]
ds_read_b64_tr_b16 v[240:241], v16 offset:34816
ds_read_b64_tr_b16 v[242:243], v16 offset:35840
s_add_u32 s14, s14, s13
v_add_u32 v5, s14, v250
s_mul_i32 s90, s11, 15360
v_mfma_f32_32x32x16_bf16 v[48:63], v[228:231], a[60:63], v[48:63]
ds_read_b64_tr_b16 v[244:245], v17 offset:34816
ds_read_b64_tr_b16 v[246:247], v17 offset:35840
buffer_load_dwordx4 v22, s[48:51], s23 offen offset:1024 sc1 lds
s_add_u32 s90, s90, 0
s_waitcnt lgkmcnt(4)
v_mfma_f32_32x32x16_bf16 v[32:47], v[232:235], a[64:67], v[32:47]
ds_read_b64_tr_b16 v[224:225], v16 offset:36864
ds_read_b64_tr_b16 v[226:227], v16 offset:37888
s_add_u32 s11, s3, 2
s_and_b32 s11, s11, 3
s_lshr_b32 s12, s11, 1
v_mfma_f32_32x32x16_bf16 v[48:63], v[236:239], a[64:67], v[48:63]
ds_read_b64_tr_b16 v[228:229], v17 offset:36864
ds_read_b64_tr_b16 v[230:231], v17 offset:37888
buffer_load_dwordx4 v22, s[48:51], s23 offen offset:2048 sc1 lds
s_lshl_b32 s13, s25, 1
s_waitcnt lgkmcnt(4)
v_mfma_f32_32x32x16_bf16 v[32:47], v[240:243], a[68:71], v[32:47]
ds_read_b64_tr_b16 v[232:233], v16 offset:38912
ds_read_b64_tr_b16 v[234:235], v16 offset:39936
s_add_u32 s12, s12, s13
s_and_b32 s13, s11, 1
s_lshl_b32 s13, s13, 8
v_mfma_f32_32x32x16_bf16 v[48:63], v[244:247], a[68:71], v[48:63]
ds_read_b64_tr_b16 v[236:237], v17 offset:38912
ds_read_b64_tr_b16 v[238:239], v17 offset:39936
buffer_load_dwordx4 v22, s[48:51], s23 offen offset:3072 sc1 lds
s_mul_i32 s14, s12, 98304
s_waitcnt lgkmcnt(4)
v_mfma_f32_32x32x16_bf16 v[32:47], v[224:227], a[72:75], v[32:47]
ds_read_b64_tr_b16 v[240:241], v16 offset:40960
ds_read_b64_tr_b16 v[242:243], v16 offset:41984
s_add_u32 s14, s14, s13
v_add_u32 v14, s14, v250
s_mul_i32 s14, s12, 40960
v_mfma_f32_32x32x16_bf16 v[48:63], v[228:231], a[72:75], v[48:63]
ds_read_b64_tr_b16 v[244:245], v17 offset:40960
ds_read_b64_tr_b16 v[246:247], v17 offset:41984
s_add_u32 m0, s65, 9216
s_nop 0
buffer_load_dwordx4 v23, s[48:51], s23 offen offset:0 sc1 lds
s_add_u32 s14, s14, s13
s_waitcnt lgkmcnt(4)
v_mfma_f32_32x32x16_bf16 v[32:47], v[232:235], a[76:79], v[32:47]
ds_read_b64_tr_b16 v[224:225], v16 offset:43008
ds_read_b64_tr_b16 v[226:227], v16 offset:44032
v_add_u32 v6, s14, v250
s_mul_i32 s91, s11, 15360
s_add_u32 s91, s91, 5120
v_mfma_f32_32x32x16_bf16 v[48:63], v[236:239], a[76:79], v[48:63]
ds_read_b64_tr_b16 v[228:229], v17 offset:43008
ds_read_b64_tr_b16 v[230:231], v17 offset:44032
s_mul_i32 s23, s77, 20
s_add_u32 s23, s23, s31
s_add_u32 m0, s65, 10240
s_nop 0
buffer_load_dwordx4 v22, s[48:51], s23 offen offset:0 sc1 lds
s_add_u32 s11, s3, 3
s_waitcnt lgkmcnt(4)
v_mfma_f32_32x32x16_bf16 v[32:47], v[240:243], a[80:83], v[32:47]
ds_read_b64_tr_b16 v[232:233], v16 offset:45056
ds_read_b64_tr_b16 v[234:235], v16 offset:46080
s_and_b32 s11, s11, 3
s_lshr_b32 s12, s11, 1
s_lshl_b32 s13, s25, 1
v_mfma_f32_32x32x16_bf16 v[48:63], v[244:247], a[80:83], v[48:63]
ds_read_b64_tr_b16 v[236:237], v17 offset:45056
ds_read_b64_tr_b16 v[238:239], v17 offset:46080
buffer_load_dwordx4 v22, s[48:51], s23 offen offset:1024 sc1 lds
s_add_u32 s12, s12, s13
s_waitcnt lgkmcnt(4)
v_mfma_f32_32x32x16_bf16 v[32:47], v[224:227], a[84:87], v[32:47]
ds_read_b64_tr_b16 v[240:241], v16 offset:47104
ds_read_b64_tr_b16 v[242:243], v16 offset:48128
s_and_b32 s13, s11, 1
s_lshl_b32 s13, s13, 8
s_mul_i32 s14, s12, 98304
v_mfma_f32_32x32x16_bf16 v[48:63], v[228:231], a[84:87], v[48:63]
ds_read_b64_tr_b16 v[244:245], v17 offset:47104
ds_read_b64_tr_b16 v[246:247], v17 offset:48128
buffer_load_dwordx4 v22, s[48:51], s23 offen offset:2048 sc1 lds
s_add_u32 s14, s14, s13
s_waitcnt lgkmcnt(4)
v_mfma_f32_32x32x16_bf16 v[32:47], v[232:235], a[88:91], v[32:47]
ds_read_b64_tr_b16 v[224:225], v16 offset:49152
ds_read_b64_tr_b16 v[226:227], v16 offset:50176
v_add_u32 v15, s14, v250
s_mul_i32 s14, s12, 40960
s_add_u32 s14, s14, s13
v_mfma_f32_32x32x16_bf16 v[48:63], v[236:239], a[88:91], v[48:63]
ds_read_b64_tr_b16 v[228:229], v17 offset:49152
ds_read_b64_tr_b16 v[230:231], v17 offset:50176
buffer_load_dwordx4 v22, s[48:51], s23 offen offset:3072 sc1 lds
v_add_u32 v7, s14, v250
s_waitcnt lgkmcnt(4)
v_mfma_f32_32x32x16_bf16 v[32:47], v[240:243], a[92:95], v[32:47]
ds_read_b64_tr_b16 v[232:233], v16 offset:51200
ds_read_b64_tr_b16 v[234:235], v16 offset:52224
s_mul_i32 s92, s11, 15360
s_add_u32 s92, s92, 10240
v_and_b32 v248, 15, v1
v_mfma_f32_32x32x16_bf16 v[48:63], v[244:247], a[92:95], v[48:63]
ds_read_b64_tr_b16 v[236:237], v17 offset:51200
ds_read_b64_tr_b16 v[238:239], v17 offset:52224
s_add_u32 m0, s65, 14336
s_nop 0
buffer_load_dwordx4 v23, s[48:51], s23 offen offset:0 sc1 lds
v_lshrrev_b32 v249, 4, v1
s_waitcnt lgkmcnt(4)
v_mfma_f32_32x32x16_bf16 v[32:47], v[224:227], a[96:99], v[32:47]
ds_read_b64_tr_b16 v[240:241], v16 offset:53248
ds_read_b64_tr_b16 v[242:243], v16 offset:54272
v_mul_u32_u24 v248, 160, v248
v_lshl_add_u32 v248, v249, 3, v248
v_add_u32 v26, s65, v248
v_mfma_f32_32x32x16_bf16 v[48:63], v[228:231], a[96:99], v[48:63]
ds_read_b64_tr_b16 v[244:245], v17 offset:53248
ds_read_b64_tr_b16 v[246:247], v17 offset:54272
s_mul_i32 s23, s0, 20
s_add_u32 s23, s23, s22
s_add_u32 s23, s23, 81920
s_add_u32 m0, s65, 15360
s_nop 0
buffer_load_dwordx4 v22, s[48:51], s23 offen offset:0 sc1 lds
s_lshl_b32 s11, s25, 2
s_waitcnt lgkmcnt(4)
v_mfma_f32_32x32x16_bf16 v[32:47], v[232:235], a[100:103], v[32:47]
ds_read_b64_tr_b16 v[224:225], v16 offset:55296
ds_read_b64_tr_b16 v[226:227], v16 offset:56320
s_add_u32 s11, s11, s3
s_mul_i32 s11, s11, 20480
s_mul_i32 s12, s24, 160
v_mfma_f32_32x32x16_bf16 v[48:63], v[236:239], a[100:103], v[48:63]
ds_read_b64_tr_b16 v[228:229], v17 offset:55296
ds_read_b64_tr_b16 v[230:231], v17 offset:56320
buffer_load_dwordx4 v22, s[48:51], s23 offen offset:1024 sc1 lds
s_add_u32 s11, s11, s12
s_waitcnt lgkmcnt(4)
v_mfma_f32_32x32x16_bf16 v[32:47], v[240:243], a[104:107], v[32:47]
ds_read_b64_tr_b16 v[232:233], v16 offset:57344
ds_read_b64_tr_b16 v[234:235], v16 offset:58368
s_movk_i32 s13, 1120
v_add_u32 v248, 0, v1
v_mul_u32_u24 v249, 205, v248
v_mfma_f32_32x32x16_bf16 v[48:63], v[244:247], a[104:107], v[48:63]
ds_read_b64_tr_b16 v[236:237], v17 offset:57344
ds_read_b64_tr_b16 v[238:239], v17 offset:58368
buffer_load_dwordx4 v22, s[48:51], s23 offen offset:2048 sc1 lds
v_lshrrev_b32 v249, 11, v249
s_waitcnt lgkmcnt(4)
v_mfma_f32_32x32x16_bf16 v[32:47], v[224:227], a[108:111], v[32:47]
ds_read_b64_tr_b16 v[240:241], v16 offset:59392
ds_read_b64_tr_b16 v[242:243], v16 offset:60416
v_lshl_add_u32 v248, v248, 4, s11
v_mad_u32_u24 v25, v249, s13, v248
v_add_u32 v248, 64, v1
v_mfma_f32_32x32x16_bf16 v[48:63], v[228:231], a[108:111], v[48:63]
ds_read_b64_tr_b16 v[244:245], v17 offset:59392
ds_read_b64_tr_b16 v[246:247], v17 offset:60416
buffer_load_dwordx4 v22, s[48:51], s23 offen offset:3072 sc1 lds
v_mul_u32_u24 v249, 205, v248
s_waitcnt lgkmcnt(4)
v_mfma_f32_32x32x16_bf16 v[32:47], v[232:235], a[112:115], v[32:47]
ds_read_b64_tr_b16 v[224:225], v16 offset:61440
ds_read_b64_tr_b16 v[226:227], v16 offset:62464
v_lshrrev_b32 v249, 11, v249
v_lshl_add_u32 v248, v248, 4, s11
v_mad_u32_u24 v27, v249, s13, v248
v_mfma_f32_32x32x16_bf16 v[48:63], v[236:239], a[112:115], v[48:63]
ds_read_b64_tr_b16 v[228:229], v17 offset:61440
ds_read_b64_tr_b16 v[230:231], v17 offset:62464
s_add_u32 m0, s65, 19456
s_nop 0
buffer_load_dwordx4 v23, s[48:51], s23 offen offset:0 sc1 lds
v_add_u32 v248, 128, v1
s_waitcnt lgkmcnt(4)
v_mfma_f32_32x32x16_bf16 v[32:47], v[240:243], a[116:119], v[32:47]
ds_read_b64_tr_b16 v[232:233], v16 offset:63488
ds_read_b64_tr_b16 v[234:235], v16 offset:64512
v_mul_u32_u24 v249, 205, v248
v_lshrrev_b32 v249, 11, v249
v_lshl_add_u32 v248, v248, 4, s11
v_mfma_f32_32x32x16_bf16 v[48:63], v[244:247], a[116:119], v[48:63]
ds_read_b64_tr_b16 v[236:237], v17 offset:63488
ds_read_b64_tr_b16 v[238:239], v17 offset:64512
s_mul_i32 s23, s1, 20
s_add_u32 s23, s23, s22
s_add_u32 s23, s23, 81920
buffer_load_dwordx4 a[0:3], v22, s[48:51], s23 offen offset:0 sc1
v_mad_u32_u24 v31, v249, s13, v248
s_waitcnt lgkmcnt(4)
v_mfma_f32_32x32x16_bf16 v[32:47], v[224:227], a[120:123], v[32:47]
ds_read_b64_tr_b16 v[240:241], v18 offset:0
ds_read_b64_tr_b16 v[242:243], v18 offset:1024
s_mov_b32 s40, s16
s_mov_b32 s41, s17
s_mov_b32 s42, 2621440
v_mfma_f32_32x32x16_bf16 v[48:63], v[228:231], a[120:123], v[48:63]
ds_read_b64_tr_b16 v[244:245], v19 offset:0
ds_read_b64_tr_b16 v[246:247], v19 offset:1024
buffer_load_dwordx4 a[4:7], v22, s[48:51], s23 offen offset:1024 sc1
s_mov_b32 s43, 0x20000
s_waitcnt lgkmcnt(4)
v_mfma_f32_32x32x16_bf16 v[32:47], v[232:235], a[124:127], v[32:47]
ds_read_b64_tr_b16 v[224:225], v18 offset:2048
ds_read_b64_tr_b16 v[226:227], v18 offset:3072
v_mfma_f32_32x32x16_bf16 v[48:63], v[236:239], a[124:127], v[48:63]
ds_read_b64_tr_b16 v[228:229], v19 offset:2048
ds_read_b64_tr_b16 v[230:231], v19 offset:3072
buffer_load_dwordx4 a[8:11], v22, s[48:51], s23 offen offset:2048 sc1
s_waitcnt lgkmcnt(4)
v_mfma_f32_32x32x16_bf16 v[32:47], v[240:243], a[128:131], v[32:47]
ds_read_b64_tr_b16 v[232:233], v18 offset:4096
ds_read_b64_tr_b16 v[234:235], v18 offset:5120
v_mfma_f32_32x32x16_bf16 v[48:63], v[244:247], a[128:131], v[48:63]
ds_read_b64_tr_b16 v[236:237], v19 offset:4096
ds_read_b64_tr_b16 v[238:239], v19 offset:5120
buffer_load_dwordx4 a[12:15], v22, s[48:51], s23 offen offset:3072 sc1
s_waitcnt lgkmcnt(4)
v_mfma_f32_32x32x16_bf16 v[32:47], v[224:227], a[132:135], v[32:47]
ds_read_b64_tr_b16 v[240:241], v18 offset:6144
ds_read_b64_tr_b16 v[242:243], v18 offset:7168
v_mfma_f32_32x32x16_bf16 v[48:63], v[228:231], a[132:135], v[48:63]
ds_read_b64_tr_b16 v[244:245], v19 offset:6144
ds_read_b64_tr_b16 v[246:247], v19 offset:7168
buffer_load_dwordx4 a[16:19], v23, s[48:51], s23 offen offset:0 sc1
s_waitcnt lgkmcnt(4)
v_mfma_f32_32x32x16_bf16 v[32:47], v[232:235], a[136:139], v[32:47]
ds_read_b64_tr_b16 v[224:225], v18 offset:8192
ds_read_b64_tr_b16 v[226:227], v18 offset:9216
v_mfma_f32_32x32x16_bf16 v[48:63], v[236:239], a[136:139], v[48:63]
ds_read_b64_tr_b16 v[228:229], v19 offset:8192
ds_read_b64_tr_b16 v[230:231], v19 offset:9216
s_mul_i32 s23, s18, 20
s_add_u32 s23, s23, s22
s_add_u32 s23, s23, 81920
buffer_load_dwordx4 a[20:23], v22, s[48:51], s23 offen offset:0 sc1
s_waitcnt lgkmcnt(4)
v_mfma_f32_32x32x16_bf16 v[32:47], v[240:243], a[140:143], v[32:47]
ds_read_b64_tr_b16 v[232:233], v18 offset:10240
ds_read_b64_tr_b16 v[234:235], v18 offset:11264
v_mfma_f32_32x32x16_bf16 v[48:63], v[244:247], a[140:143], v[48:63]
ds_read_b64_tr_b16 v[236:237], v19 offset:10240
ds_read_b64_tr_b16 v[238:239], v19 offset:11264
buffer_load_dwordx4 a[24:27], v22, s[48:51], s23 offen offset:1024 sc1
s_waitcnt lgkmcnt(4)
v_mfma_f32_32x32x16_bf16 v[32:47], v[224:227], a[144:147], v[32:47]
ds_read_b64_tr_b16 v[240:241], v18 offset:12288
ds_read_b64_tr_b16 v[242:243], v18 offset:13312
v_mfma_f32_32x32x16_bf16 v[48:63], v[228:231], a[144:147], v[48:63]
ds_read_b64_tr_b16 v[244:245], v19 offset:12288
ds_read_b64_tr_b16 v[246:247], v19 offset:13312
buffer_load_dwordx4 a[28:31], v22, s[48:51], s23 offen offset:2048 sc1
s_waitcnt lgkmcnt(4)
v_mfma_f32_32x32x16_bf16 v[32:47], v[232:235], a[148:151], v[32:47]
ds_read_b64_tr_b16 v[224:225], v18 offset:14336
ds_read_b64_tr_b16 v[226:227], v18 offset:15360
v_mfma_f32_32x32x16_bf16 v[48:63], v[236:239], a[148:151], v[48:63]
ds_read_b64_tr_b16 v[228:229], v19 offset:14336
ds_read_b64_tr_b16 v[230:231], v19 offset:15360
buffer_load_dwordx4 a[32:35], v22, s[48:51], s23 offen offset:3072 sc1
s_waitcnt lgkmcnt(4)
v_mfma_f32_32x32x16_bf16 v[32:47], v[240:243], a[152:155], v[32:47]
v_mfma_f32_32x32x16_bf16 v[48:63], v[244:247], a[152:155], v[48:63]
buffer_load_dwordx4 a[36:39], v23, s[48:51], s23 offen offset:0 sc1
s_waitcnt lgkmcnt(0)
v_mfma_f32_32x32x16_bf16 v[32:47], v[224:227], a[156:159], v[32:47]
v_mfma_f32_32x32x16_bf16 v[48:63], v[228:231], a[156:159], v[48:63]
s_mul_i32 s23, s19, 20
s_add_u32 s23, s23, s22
s_add_u32 s23, s23, 81920
buffer_load_dwordx4 a[40:43], v22, s[48:51], s23 offen offset:0 sc1
s_waitcnt vmcnt(11)
ds_read_b128 a[100:103], v29 offset:0
ds_read_b128 a[104:107], v29 offset:1024
ds_read_b128 a[108:111], v29 offset:2048
ds_read_b128 a[112:115], v29 offset:3072
ds_read_b128 a[116:119], v29 offset:4096
ds_read_b128 a[120:123], v29 offset:5120
ds_read_b128 a[124:127], v29 offset:6144
ds_read_b128 a[128:131], v29 offset:7168
ds_read_b128 a[132:135], v29 offset:8192
ds_read_b128 a[136:139], v29 offset:9216
ds_read_b128 a[140:143], v29 offset:10240
ds_read_b128 a[144:147], v29 offset:11264
ds_read_b128 a[148:151], v29 offset:12288
ds_read_b128 a[152:155], v29 offset:13312
ds_read_b128 a[156:159], v29 offset:14336
v_pk_mul_f32 v[90:91], v[32:33], v[32:33]
v_pk_mul_f32 v[92:93], v[34:35], v[34:35]
v_pk_mul_f32 v[94:95], v[36:37], v[36:37]
v_pk_mul_f32 v[96:97], v[38:39], v[38:39]
v_pk_fma_f32 v[90:91], v[90:91], v[28:29], v[24:25] op_sel_hi:[1,0,0]
v_pk_fma_f32 v[92:93], v[92:93], v[28:29], v[24:25] op_sel_hi:[1,0,0]
v_pk_fma_f32 v[94:95], v[94:95], v[28:29], v[24:25] op_sel_hi:[1,0,0]
v_pk_fma_f32 v[96:97], v[96:97], v[28:29], v[24:25] op_sel_hi:[1,0,0]
v_pk_mul_f32 v[90:91], v[90:91], v[32:33]
v_pk_mul_f32 v[92:93], v[92:93], v[34:35]
v_pk_mul_f32 v[94:95], v[94:95], v[36:37]
v_pk_mul_f32 v[96:97], v[96:97], v[38:39]
v_exp_f32 v90, v90
v_exp_f32 v91, v91
v_exp_f32 v92, v92
v_exp_f32 v93, v93
v_exp_f32 v94, v94
v_exp_f32 v95, v95
v_exp_f32 v96, v96
v_exp_f32 v97, v97
v_pk_fma_f32 v[90:91], v[90:91], v[30:31], v[30:31] op_sel_hi:[1,0,0]
v_pk_fma_f32 v[92:93], v[92:93], v[30:31], v[30:31] op_sel_hi:[1,0,0]
v_pk_fma_f32 v[94:95], v[94:95], v[30:31], v[30:31] op_sel_hi:[1,0,0]
v_pk_fma_f32 v[96:97], v[96:97], v[30:31], v[30:31] op_sel_hi:[1,0,0]
s_waitcnt lgkmcnt(0)
s_add_u32 m0, s65, 0
s_nop 0
buffer_load_dwordx4 v25, s[40:43], 0 offen lds
v_rcp_f32 v90, v90
v_rcp_f32 v91, v91
v_rcp_f32 v92, v92
v_rcp_f32 v93, v93
v_rcp_f32 v94, v94
v_rcp_f32 v95, v95
v_rcp_f32 v96, v96
v_rcp_f32 v97, v97
v_pk_mul_f32 v[32:33], v[32:33], v[90:91]
v_pk_mul_f32 v[34:35], v[34:35], v[92:93]
v_pk_mul_f32 v[36:37], v[36:37], v[94:95]
v_pk_mul_f32 v[38:39], v[38:39], v[96:97]
s_add_u32 m0, s65, 1024
s_nop 0
buffer_load_dwordx4 v27, s[40:43], 0 offen lds
v_cvt_pk_bf16_f32 v64, v32, v33
v_cvt_pk_bf16_f32 v65, v34, v35
v_cvt_pk_bf16_f32 v66, v36, v37
v_cvt_pk_bf16_f32 v67, v38, v39
buffer_load_dwordx2 v[20:21], v10, s[48:51], s83 offen sc1
buffer_store_dwordx4 v[64:67], v8, s[48:51], s70 offen offset:0 sc1
v_pk_mul_f32 v[90:91], v[40:41], v[40:41]
v_pk_mul_f32 v[92:93], v[42:43], v[42:43]
v_pk_mul_f32 v[94:95], v[44:45], v[44:45]
v_pk_mul_f32 v[96:97], v[46:47], v[46:47]
v_pk_fma_f32 v[90:91], v[90:91], v[28:29], v[24:25] op_sel_hi:[1,0,0]
v_pk_fma_f32 v[92:93], v[92:93], v[28:29], v[24:25] op_sel_hi:[1,0,0]
v_pk_fma_f32 v[94:95], v[94:95], v[28:29], v[24:25] op_sel_hi:[1,0,0]
v_pk_fma_f32 v[96:97], v[96:97], v[28:29], v[24:25] op_sel_hi:[1,0,0]
v_pk_mul_f32 v[90:91], v[90:91], v[40:41]
v_pk_mul_f32 v[92:93], v[92:93], v[42:43]
v_pk_mul_f32 v[94:95], v[94:95], v[44:45]
v_pk_mul_f32 v[96:97], v[96:97], v[46:47]
s_add_u32 m0, s65, 2048
s_nop 0
buffer_load_dwordx4 v31, s[40:43], 0 offen lds
v_exp_f32 v90, v90
v_exp_f32 v91, v91
v_exp_f32 v92, v92
v_exp_f32 v93, v93
v_exp_f32 v94, v94
v_exp_f32 v95, v95
v_exp_f32 v96, v96
v_exp_f32 v97, v97
v_pk_fma_f32 v[90:91], v[90:91], v[30:31], v[30:31] op_sel_hi:[1,0,0]
v_pk_fma_f32 v[92:93], v[92:93], v[30:31], v[30:31] op_sel_hi:[1,0,0]
v_pk_fma_f32 v[94:95], v[94:95], v[30:31], v[30:31] op_sel_hi:[1,0,0]
v_pk_fma_f32 v[96:97], v[96:97], v[30:31], v[30:31] op_sel_hi:[1,0,0]
buffer_load_dwordx4 a[44:47], v22, s[48:51], s23 offen offset:1024 sc1
v_rcp_f32 v90, v90
v_rcp_f32 v91, v91
v_rcp_f32 v92, v92
v_rcp_f32 v93, v93
v_rcp_f32 v94, v94
v_rcp_f32 v95, v95
v_rcp_f32 v96, v96
v_rcp_f32 v97, v97
v_pk_mul_f32 v[40:41], v[40:41], v[90:91]
v_pk_mul_f32 v[42:43], v[42:43], v[92:93]
v_pk_mul_f32 v[44:45], v[44:45], v[94:95]
v_pk_mul_f32 v[46:47], v[46:47], v[96:97]
buffer_load_dwordx4 a[48:51], v22, s[48:51], s23 offen offset:2048 sc1
v_cvt_pk_bf16_f32 v68, v40, v41
v_cvt_pk_bf16_f32 v69, v42, v43
v_cvt_pk_bf16_f32 v70, v44, v45
v_cvt_pk_bf16_f32 v71, v46, v47
buffer_store_dwordx4 v[68:71], v8, s[48:51], s70 offen offset:1024 sc1
v_pk_mul_f32 v[90:91], v[48:49], v[48:49]
v_pk_mul_f32 v[92:93], v[50:51], v[50:51]
v_pk_mul_f32 v[94:95], v[52:53], v[52:53]
v_pk_mul_f32 v[96:97], v[54:55], v[54:55]
v_pk_fma_f32 v[90:91], v[90:91], v[28:29], v[24:25] op_sel_hi:[1,0,0]
v_pk_fma_f32 v[92:93], v[92:93], v[28:29], v[24:25] op_sel_hi:[1,0,0]
v_pk_fma_f32 v[94:95], v[94:95], v[28:29], v[24:25] op_sel_hi:[1,0,0]
v_pk_fma_f32 v[96:97], v[96:97], v[28:29], v[24:25] op_sel_hi:[1,0,0]
v_pk_mul_f32 v[90:91], v[90:91], v[48:49]
v_pk_mul_f32 v[92:93], v[92:93], v[50:51]
v_pk_mul_f32 v[94:95], v[94:95], v[52:53]
v_pk_mul_f32 v[96:97], v[96:97], v[54:55]
buffer_load_dwordx4 a[52:55], v22, s[48:51], s23 offen offset:3072 sc1
v_exp_f32 v90, v90
v_exp_f32 v91, v91
v_exp_f32 v92, v92
v_exp_f32 v93, v93
v_exp_f32 v94, v94
v_exp_f32 v95, v95
v_exp_f32 v96, v96
v_exp_f32 v97, v97
v_pk_fma_f32 v[90:91], v[90:91], v[30:31], v[30:31] op_sel_hi:[1,0,0]
v_pk_fma_f32 v[92:93], v[92:93], v[30:31], v[30:31] op_sel_hi:[1,0,0]
v_pk_fma_f32 v[94:95], v[94:95], v[30:31], v[30:31] op_sel_hi:[1,0,0]
v_pk_fma_f32 v[96:97], v[96:97], v[30:31], v[30:31] op_sel_hi:[1,0,0]
buffer_load_dwordx4 a[56:59], v23, s[48:51], s23 offen offset:0 sc1
v_rcp_f32 v90, v90
v_rcp_f32 v91, v91
v_rcp_f32 v92, v92
v_rcp_f32 v93, v93
v_rcp_f32 v94, v94
v_rcp_f32 v95, v95
v_rcp_f32 v96, v96
v_rcp_f32 v97, v97
v_pk_mul_f32 v[48:49], v[48:49], v[90:91]
v_pk_mul_f32 v[50:51], v[50:51], v[92:93]
v_pk_mul_f32 v[52:53], v[52:53], v[94:95]
v_pk_mul_f32 v[54:55], v[54:55], v[96:97]
v_cvt_pk_bf16_f32 v72, v48, v49
v_cvt_pk_bf16_f32 v73, v50, v51
v_cvt_pk_bf16_f32 v74, v52, v53
v_cvt_pk_bf16_f32 v75, v54, v55
buffer_store_dwordx4 v[72:75], v8, s[48:51], s70 offen offset:2048 sc1
v_pk_mul_f32 v[90:91], v[56:57], v[56:57]
v_pk_mul_f32 v[92:93], v[58:59], v[58:59]
v_pk_mul_f32 v[94:95], v[60:61], v[60:61]
v_pk_mul_f32 v[96:97], v[62:63], v[62:63]
v_pk_fma_f32 v[90:91], v[90:91], v[28:29], v[24:25] op_sel_hi:[1,0,0]
v_pk_fma_f32 v[92:93], v[92:93], v[28:29], v[24:25] op_sel_hi:[1,0,0]
v_pk_fma_f32 v[94:95], v[94:95], v[28:29], v[24:25] op_sel_hi:[1,0,0]
v_pk_fma_f32 v[96:97], v[96:97], v[28:29], v[24:25] op_sel_hi:[1,0,0]
v_pk_mul_f32 v[90:91], v[90:91], v[56:57]
v_pk_mul_f32 v[92:93], v[92:93], v[58:59]
v_pk_mul_f32 v[94:95], v[94:95], v[60:61]
v_pk_mul_f32 v[96:97], v[96:97], v[62:63]
v_exp_f32 v90, v90
v_exp_f32 v91, v91
v_exp_f32 v92, v92
v_exp_f32 v93, v93
v_exp_f32 v94, v94
v_exp_f32 v95, v95
v_exp_f32 v96, v96
v_exp_f32 v97, v97
v_pk_fma_f32 v[90:91], v[90:91], v[30:31], v[30:31] op_sel_hi:[1,0,0]
v_pk_fma_f32 v[92:93], v[92:93], v[30:31], v[30:31] op_sel_hi:[1,0,0]
v_pk_fma_f32 v[94:95], v[94:95], v[30:31], v[30:31] op_sel_hi:[1,0,0]
v_pk_fma_f32 v[96:97], v[96:97], v[30:31], v[30:31] op_sel_hi:[1,0,0]
v_rcp_f32 v90, v90
v_rcp_f32 v91, v91
v_rcp_f32 v92, v92
v_rcp_f32 v93, v93
v_rcp_f32 v94, v94
v_rcp_f32 v95, v95
v_rcp_f32 v96, v96
v_rcp_f32 v97, v97
v_pk_mul_f32 v[56:57], v[56:57], v[90:91]
v_pk_mul_f32 v[58:59], v[58:59], v[92:93]
v_pk_mul_f32 v[60:61], v[60:61], v[94:95]
v_pk_mul_f32 v[62:63], v[62:63], v[96:97]
v_cvt_pk_bf16_f32 v76, v56, v57
v_cvt_pk_bf16_f32 v77, v58, v59
v_cvt_pk_bf16_f32 v78, v60, v61
v_cvt_pk_bf16_f32 v79, v62, v63
buffer_store_dwordx4 v[76:79], v8, s[48:51], s70 offen offset:3072 sc1
s_waitcnt vmcnt(9)
v_cmp_ne_u64 vcc, s[8:9], v[20:21]
s_cbranch_vccz L_chk6x
s_waitcnt vmcnt(0)
s_mov_b64 exec, 0xffff
buffer_store_dwordx2 v[252:253], v254, s[48:51], s71 offen sc1
s_mov_b64 exec, -1
s_mov_b32 s10, 0x20000
L_chk6:
buffer_load_dwordx2 v[20:21], v10, s[48:51], s83 offen sc1
s_sub_u32 s10, s10, 1
s_waitcnt vmcnt(0)
s_cbranch_scc1 L_chk6x
v_cmp_ne_u64 vcc, s[8:9], v[20:21]
s_cbranch_vccnz L_chk6
L_chk6x:
s_waitcnt vmcnt(7)
buffer_load_dwordx2 v[240:241], v9, s[48:51], 0 offen offset:0 sc1
ds_read_b64 v[52:53], v26 offset:0
ds_read_b64 v[54:55], v26 offset:32
buffer_load_dwordx2 v[242:243], v9, s[48:51], 0 offen offset:1024 sc1
ds_read_b64 v[56:57], v26 offset:64
ds_read_b64 v[58:59], v26 offset:96
buffer_load_dwordx2 v[244:245], v9, s[48:51], 0 offen offset:2048 sc1
ds_read_b64 v[60:61], v26 offset:128
buffer_load_dwordx2 v[246:247], v9, s[48:51], 0 offen offset:3072 sc1
s_movk_i32 s12, 0x1000
buffer_load_dwordx2 v[250:251], v9, s[48:51], s12 offen offset:0 sc1
s_waitcnt lgkmcnt(0)
s_add_u32 s7, s86, s0
buffer_load_dwordx4 v[112:115], v12, s[48:51], s7 offen sc1
v_lshlrev_b32 v32, 16, v52
v_and_b32 v33, 0xffff0000, v52
buffer_load_dwordx4 v[116:119], v13, s[48:51], s7 offen sc1
v_lshlrev_b32 v34, 16, v53
v_and_b32 v35, 0xffff0000, v53
buffer_load_dwordx4 v[120:123], v14, s[48:51], s7 offen sc1
v_lshlrev_b32 v36, 16, v54
v_and_b32 v37, 0xffff0000, v54
buffer_load_dwordx4 v[124:127], v15, s[48:51], s7 offen sc1
v_lshlrev_b32 v38, 16, v55
v_and_b32 v39, 0xffff0000, v55
s_add_u32 s7, s86, s1
buffer_load_dwordx4 v[128:131], v12, s[48:51], s7 offen sc1
v_lshlrev_b32 v40, 16, v56
v_and_b32 v41, 0xffff0000, v56
buffer_load_dwordx4 v[132:135], v13, s[48:51], s7 offen sc1
v_lshlrev_b32 v42, 16, v57
v_and_b32 v43, 0xffff0000, v57
buffer_load_dwordx4 v[136:139], v14, s[48:51], s7 offen sc1
v_lshlrev_b32 v44, 16, v58
v_and_b32 v45, 0xffff0000, v58
buffer_load_dwordx4 v[140:143], v15, s[48:51], s7 offen sc1
v_lshlrev_b32 v46, 16, v59
v_and_b32 v47, 0xffff0000, v59
s_add_u32 s7, s86, s18
buffer_load_dwordx4 v[144:147], v12, s[48:51], s7 offen sc1
v_lshlrev_b32 v48, 16, v60
v_and_b32 v49, 0xffff0000, v60
buffer_load_dwordx4 v[148:151], v13, s[48:51], s7 offen sc1
v_lshlrev_b32 v50, 16, v61
v_and_b32 v51, 0xffff0000, v61
buffer_load_dwordx4 v[152:155], v14, s[48:51], s7 offen sc1
buffer_load_dwordx4 v[156:159], v15, s[48:51], s7 offen sc1
L_b4:
s_waitcnt vmcnt(12)
v_lshlrev_b32 v248, 16, v240
v_and_b32 v240, 0xffff0000, v240
v_add_f32 v32, v32, v248
v_add_f32 v33, v33, v240
v_lshlrev_b32 v248, 16, v241
v_and_b32 v241, 0xffff0000, v241
v_add_f32 v34, v34, v248
v_add_f32 v35, v35, v241
v_lshlrev_b32 v248, 16, v242
v_and_b32 v242, 0xffff0000, v242
v_add_f32 v36, v36, v248
v_add_f32 v37, v37, v242
v_lshlrev_b32 v248, 16, v243
v_and_b32 v243, 0xffff0000, v243
v_add_f32 v38, v38, v248
v_add_f32 v39, v39, v243
s_waitcnt vmcnt(8)
v_mfma_f32_16x16x32_bf16 v[52:55], a[160:163], v[116:119], 0
s_mov_b64 exec, 0xffff
buffer_store_dwordx2 v[252:253], v254, s[48:51], s71 offen sc1
s_mov_b64 exec, -1
v_mfma_f32_16x16x32_bf16 v[56:59], a[164:167], v[116:119], 0
v_lshlrev_b32 v248, 16, v244
v_and_b32 v244, 0xffff0000, v244
v_mfma_f32_16x16x32_bf16 v[60:63], a[168:171], v[116:119], 0
v_add_f32 v40, v40, v248
v_add_f32 v41, v41, v244
v_mfma_f32_16x16x32_bf16 v[64:67], a[172:175], v[116:119], 0
s_add_u32 s7, s86, s19
buffer_load_dwordx4 v[224:227], v12, s[48:51], s7 offen sc1
v_mfma_f32_16x16x32_bf16 v[68:71], a[176:179], v[116:119], 0
v_lshlrev_b32 v248, 16, v245
v_and_b32 v245, 0xffff0000, v245
v_mfma_f32_16x16x32_bf16 v[72:75], a[160:163], v[120:123], 0
v_add_f32 v42, v42, v248
v_add_f32 v43, v43, v245
v_mfma_f32_16x16x32_bf16 v[76:79], a[164:167], v[120:123], 0
buffer_load_dwordx4 v[228:231], v13, s[48:51], s7 offen sc1
v_mfma_f32_16x16x32_bf16 v[80:83], a[168:171], v[120:123], 0
v_lshlrev_b32 v248, 16, v246
v_and_b32 v246, 0xffff0000, v246
v_mfma_f32_16x16x32_bf16 v[84:87], a[172:175], v[120:123], 0
v_add_f32 v44, v44, v248
v_add_f32 v45, v45, v246
v_mfma_f32_16x16x32_bf16 v[88:91], a[176:179], v[120:123], 0
buffer_load_dwordx4 v[232:235], v14, s[48:51], s7 offen sc1
v_mfma_f32_16x16x32_bf16 v[92:95], a[160:163], v[124:127], 0
v_lshlrev_b32 v248, 16, v247
v_and_b32 v247, 0xffff0000, v247
v_mfma_f32_16x16x32_bf16 v[96:99], a[164:167], v[124:127], 0
v_add_f32 v46, v46, v248
v_add_f32 v47, v47, v247
v_mfma_f32_16x16x32_bf16 v[100:103], a[168:171], v[124:127], 0
buffer_load_dwordx4 v[236:239], v15, s[48:51], s7 offen sc1
v_mfma_f32_16x16x32_bf16 v[104:107], a[172:175], v[124:127], 0
v_lshlrev_b32 v248, 16, v250
v_and_b32 v250, 0xffff0000, v250
v_mfma_f32_16x16x32_bf16 v[108:111], a[176:179], v[124:127], 0
v_add_f32 v48, v48, v248
v_add_f32 v49, v49, v250
v_lshlrev_b32 v248, 16, v251
v_and_b32 v251, 0xffff0000, v251
v_add_f32 v50, v50, v248
v_add_f32 v51, v51, v251
v_mfma_f32_16x16x32_bf16 v[32:35], a[160:163], v[112:115], v[32:35]
v_mfma_f32_16x16x32_bf16 v[36:39], a[164:167], v[112:115], v[36:39]
v_mfma_f32_16x16x32_bf16 v[40:43], a[168:171], v[112:115], v[40:43]
v_lshl_add_u32 v16, v1, 4, s89
v_lshl_add_u32 v17, v1, 4, s90
v_mfma_f32_16x16x32_bf16 v[44:47], a[172:175], v[112:115], v[44:47]
v_mfma_f32_16x16x32_bf16 v[48:51], a[176:179], v[112:115], v[48:51]
s_waitcnt vmcnt(9)
v_mfma_f32_16x16x32_bf16 v[32:35], a[180:183], v[128:131], v[32:35]
s_barrier
v_mfma_f32_16x16x32_bf16 v[36:39], a[184:187], v[128:131], v[36:39]
v_mfma_f32_16x16x32_bf16 v[40:43], a[188:191], v[128:131], v[40:43]
v_lshl_add_u32 v18, v1, 4, s91
v_lshl_add_u32 v19, v1, 4, s92
v_mfma_f32_16x16x32_bf16 v[44:47], a[192:195], v[128:131], v[44:47]
buffer_load_dwordx2 v[20:21], v11, s[48:51], s85 offen sc1
v_mfma_f32_16x16x32_bf16 v[48:51], a[196:199], v[128:131], v[48:51]
v_mfma_f32_16x16x32_bf16 v[52:55], a[180:183], v[132:135], v[52:55]
s_mov_b32 s56, s32
s_mov_b32 s57, s33
v_mfma_f32_16x16x32_bf16 v[56:59], a[184:187], v[132:135], v[56:59]
s_add_u32 s7, s86, s20
buffer_load_dwordx4 v[112:115], v12, s[48:51], s7 offen sc1
v_mfma_f32_16x16x32_bf16 v[60:63], a[188:191], v[132:135], v[60:63]
v_mfma_f32_16x16x32_bf16 v[64:67], a[192:195], v[132:135], v[64:67]
s_mov_b32 s58, 2621440
s_mov_b32 s59, 0x20000
v_mfma_f32_16x16x32_bf16 v[68:71], a[196:199], v[132:135], v[68:71]
buffer_load_dwordx4 v[116:119], v13, s[48:51], s7 offen sc1
v_mfma_f32_16x16x32_bf16 v[72:75], a[180:183], v[136:139], v[72:75]
v_mfma_f32_16x16x32_bf16 v[76:79], a[184:187], v[136:139], v[76:79]
s_add_u32 s93, s87, s0
s_add_u32 s94, s87, s1
v_mfma_f32_16x16x32_bf16 v[80:83], a[188:191], v[136:139], v[80:83]
buffer_load_dwordx4 v[120:123], v14, s[48:51], s7 offen sc1
v_mfma_f32_16x16x32_bf16 v[84:87], a[192:195], v[136:139], v[84:87]
v_mfma_f32_16x16x32_bf16 v[88:91], a[196:199], v[136:139], v[88:91]
s_add_u32 s95, s87, s18
s_add_u32 s96, s87, s19
v_mfma_f32_16x16x32_bf16 v[92:95], a[180:183], v[140:143], v[92:95]
buffer_load_dwordx4 v[124:127], v15, s[48:51], s7 offen sc1
v_mfma_f32_16x16x32_bf16 v[96:99], a[184:187], v[140:143], v[96:99]
v_mfma_f32_16x16x32_bf16 v[100:103], a[188:191], v[140:143], v[100:103]
s_add_u32 s97, s87, s20
s_add_u32 s98, s87, s21
v_mfma_f32_16x16x32_bf16 v[104:107], a[192:195], v[140:143], v[104:107]
v_mfma_f32_16x16x32_bf16 v[108:111], a[196:199], v[140:143], v[108:111]
s_waitcnt vmcnt(10)
v_mfma_f32_16x16x32_bf16 v[32:35], a[200:203], v[144:147], v[32:35]
s_add_u32 s7, s86, s21
buffer_load_dwordx4 v[128:131], v12, s[48:51], s7 offen sc1
v_mfma_f32_16x16x32_bf16 v[36:39], a[204:207], v[144:147], v[36:39]
v_mfma_f32_16x16x32_bf16 v[40:43], a[208:211], v[144:147], v[40:43]
v_mfma_f32_16x16x32_bf16 v[44:47], a[212:215], v[144:147], v[44:47]
buffer_load_dwordx4 v[132:135], v13, s[48:51], s7 offen sc1
v_mfma_f32_16x16x32_bf16 v[48:51], a[216:219], v[144:147], v[48:51]
v_mfma_f32_16x16x32_bf16 v[52:55], a[200:203], v[148:151], v[52:55]
v_mfma_f32_16x16x32_bf16 v[56:59], a[204:207], v[148:151], v[56:59]
buffer_load_dwordx4 v[136:139], v14, s[48:51], s7 offen sc1
v_mfma_f32_16x16x32_bf16 v[60:63], a[208:211], v[148:151], v[60:63]
v_mfma_f32_16x16x32_bf16 v[64:67], a[212:215], v[148:151], v[64:67]
v_mfma_f32_16x16x32_bf16 v[68:71], a[216:219], v[148:151], v[68:71]
buffer_load_dwordx4 v[140:143], v15, s[48:51], s7 offen sc1
v_mfma_f32_16x16x32_bf16 v[72:75], a[200:203], v[152:155], v[72:75]
v_mfma_f32_16x16x32_bf16 v[76:79], a[204:207], v[152:155], v[76:79]
v_mfma_f32_16x16x32_bf16 v[80:83], a[208:211], v[152:155], v[80:83]
ds_read_b128 a[160:163], v29 offset:15360
ds_read_b128 a[164:167], v29 offset:16384
ds_read_b128 a[168:171], v29 offset:17408
ds_read_b128 a[172:175], v29 offset:18432
ds_read_b128 a[176:179], v29 offset:19456
v_mfma_f32_16x16x32_bf16 v[84:87], a[212:215], v[152:155], v[84:87]
v_mfma_f32_16x16x32_bf16 v[88:91], a[216:219], v[152:155], v[88:91]
v_mfma_f32_16x16x32_bf16 v[92:95], a[200:203], v[156:159], v[92:95]
v_mfma_f32_16x16x32_bf16 v[96:99], a[204:207], v[156:159], v[96:99]
v_mfma_f32_16x16x32_bf16 v[100:103], a[208:211], v[156:159], v[100:103]
v_mfma_f32_16x16x32_bf16 v[104:107], a[212:215], v[156:159], v[104:107]
v_mfma_f32_16x16x32_bf16 v[108:111], a[216:219], v[156:159], v[108:111]
s_waitcnt vmcnt(8)
v_cmp_ne_u64 vcc, s[8:9], v[20:21]
s_cbranch_vccz L_chk7x
s_mov_b32 s10, 0x20000
L_chk7:
buffer_load_dwordx2 v[20:21], v11, s[48:51], s85 offen sc1
s_sub_u32 s10, s10, 1
s_waitcnt vmcnt(0)
s_cbranch_scc1 L_chk7x
v_cmp_ne_u64 vcc, s[8:9], v[20:21]
s_cbranch_vccnz L_chk7
L_chk7x:
v_mfma_f32_16x16x32_bf16 v[32:35], a[220:223], v[224:227], v[32:35]
s_add_u32 s7, s88, s73
buffer_load_dwordx4 v[144:147], v4, s[48:51], s7 offen sc1
v_mfma_f32_16x16x32_bf16 v[36:39], a[224:227], v[224:227], v[36:39]
v_mfma_f32_16x16x32_bf16 v[40:43], a[228:231], v[224:227], v[40:43]
v_mfma_f32_16x16x32_bf16 v[44:47], a[232:235], v[224:227], v[44:47]
buffer_load_dwordx4 v[148:151], v5, s[48:51], s7 offen sc1
v_mfma_f32_16x16x32_bf16 v[48:51], a[236:239], v[224:227], v[48:51]
v_mfma_f32_16x16x32_bf16 v[52:55], a[220:223], v[228:231], v[52:55]
v_mfma_f32_16x16x32_bf16 v[56:59], a[224:227], v[228:231], v[56:59]
buffer_load_dwordx4 v[152:155], v6, s[48:51], s7 offen sc1
v_mfma_f32_16x16x32_bf16 v[60:63], a[228:231], v[228:231], v[60:63]
v_mfma_f32_16x16x32_bf16 v[64:67], a[232:235], v[228:231], v[64:67]
v_mfma_f32_16x16x32_bf16 v[68:71], a[236:239], v[228:231], v[68:71]
buffer_load_dwordx4 v[156:159], v7, s[48:51], s7 offen sc1
v_mfma_f32_16x16x32_bf16 v[72:75], a[220:223], v[232:235], v[72:75]
v_mfma_f32_16x16x32_bf16 v[76:79], a[224:227], v[232:235], v[76:79]
v_mfma_f32_16x16x32_bf16 v[80:83], a[228:231], v[232:235], v[80:83]
v_mfma_f32_16x16x32_bf16 v[84:87], a[232:235], v[232:235], v[84:87]
v_mfma_f32_16x16x32_bf16 v[88:91], a[236:239], v[232:235], v[88:91]
v_mfma_f32_16x16x32_bf16 v[92:95], a[220:223], v[236:239], v[92:95]
v_mfma_f32_16x16x32_bf16 v[96:99], a[224:227], v[236:239], v[96:99]
v_mfma_f32_16x16x32_bf16 v[100:103], a[228:231], v[236:239], v[100:103]
v_mfma_f32_16x16x32_bf16 v[104:107], a[232:235], v[236:239], v[104:107]
v_mfma_f32_16x16x32_bf16 v[108:111], a[236:239], v[236:239], v[108:111]
s_waitcnt vmcnt(8)
v_mfma_f32_16x16x32_bf16 v[32:35], a[240:243], v[112:115], v[32:35]
s_add_u32 s7, s88, s74
buffer_load_dwordx4 v[224:227], v4, s[48:51], s7 offen sc1
v_mfma_f32_16x16x32_bf16 v[36:39], a[244:247], v[112:115], v[36:39]
v_mfma_f32_16x16x32_bf16 v[40:43], a[248:251], v[112:115], v[40:43]
v_mfma_f32_16x16x32_bf16 v[44:47], a[252:255], v[112:115], v[44:47]
buffer_load_dwordx4 v[228:231], v5, s[48:51], s7 offen sc1
v_mfma_f32_16x16x32_bf16 v[48:51], v[160:163], v[112:115], v[48:51]
v_mfma_f32_16x16x32_bf16 v[52:55], a[240:243], v[116:119], v[52:55]
v_mfma_f32_16x16x32_bf16 v[56:59], a[244:247], v[116:119], v[56:59]
buffer_load_dwordx4 v[232:235], v6, s[48:51], s7 offen sc1
v_mfma_f32_16x16x32_bf16 v[60:63], a[248:251], v[116:119], v[60:63]
v_mfma_f32_16x16x32_bf16 v[64:67], a[252:255], v[116:119], v[64:67]
v_mfma_f32_16x16x32_bf16 v[68:71], v[160:163], v[116:119], v[68:71]
buffer_load_dwordx4 v[236:239], v7, s[48:51], s7 offen sc1
v_mfma_f32_16x16x32_bf16 v[72:75], a[240:243], v[120:123], v[72:75]
v_mfma_f32_16x16x32_bf16 v[76:79], a[244:247], v[120:123], v[76:79]
v_mfma_f32_16x16x32_bf16 v[80:83], a[248:251], v[120:123], v[80:83]
v_mfma_f32_16x16x32_bf16 v[84:87], a[252:255], v[120:123], v[84:87]
v_mfma_f32_16x16x32_bf16 v[88:91], v[160:163], v[120:123], v[88:91]
v_mfma_f32_16x16x32_bf16 v[92:95], a[240:243], v[124:127], v[92:95]
v_mfma_f32_16x16x32_bf16 v[96:99], a[244:247], v[124:127], v[96:99]
v_mfma_f32_16x16x32_bf16 v[100:103], a[248:251], v[124:127], v[100:103]
v_mfma_f32_16x16x32_bf16 v[104:107], a[252:255], v[124:127], v[104:107]
v_mfma_f32_16x16x32_bf16 v[108:111], v[160:163], v[124:127], v[108:111]
s_waitcnt vmcnt(8) lgkmcnt(0)
v_mfma_f32_16x16x32_bf16 v[32:35], v[164:167], v[128:131], v[32:35]
s_add_u32 s7, s88, s75
buffer_load_dwordx4 v[112:115], v4, s[48:51], s7 offen sc1
v_mfma_f32_16x16x32_bf16 v[36:39], v[168:171], v[128:131], v[36:39]
v_mfma_f32_16x16x32_bf16 v[40:43], v[172:175], v[128:131], v[40:43]
v_mfma_f32_16x16x32_bf16 v[44:47], v[176:179], v[128:131], v[44:47]
buffer_load_dwordx4 v[116:119], v5, s[48:51], s7 offen sc1
v_mfma_f32_16x16x32_bf16 v[48:51], v[180:183], v[128:131], v[48:51]
v_mfma_f32_16x16x32_bf16 v[52:55], v[164:167], v[132:135], v[52:55]
v_mfma_f32_16x16x32_bf16 v[56:59], v[168:171], v[132:135], v[56:59]
buffer_load_dwordx4 v[120:123], v6, s[48:51], s7 offen sc1
v_mfma_f32_16x16x32_bf16 v[60:63], v[172:175], v[132:135], v[60:63]
v_mfma_f32_16x16x32_bf16 v[64:67], v[176:179], v[132:135], v[64:67]
v_mfma_f32_16x16x32_bf16 v[68:71], v[180:183], v[132:135], v[68:71]
buffer_load_dwordx4 v[124:127], v7, s[48:51], s7 offen sc1
v_mfma_f32_16x16x32_bf16 v[72:75], v[164:167], v[136:139], v[72:75]
v_mfma_f32_16x16x32_bf16 v[76:79], v[168:171], v[136:139], v[76:79]
v_mfma_f32_16x16x32_bf16 v[80:83], v[172:175], v[136:139], v[80:83]
v_mfma_f32_16x16x32_bf16 v[84:87], v[176:179], v[136:139], v[84:87]
v_mfma_f32_16x16x32_bf16 v[88:91], v[180:183], v[136:139], v[88:91]
v_mfma_f32_16x16x32_bf16 v[92:95], v[164:167], v[140:143], v[92:95]
v_mfma_f32_16x16x32_bf16 v[96:99], v[168:171], v[140:143], v[96:99]
v_mfma_f32_16x16x32_bf16 v[100:103], v[172:175], v[140:143], v[100:103]
v_mfma_f32_16x16x32_bf16 v[104:107], v[176:179], v[140:143], v[104:107]
v_mfma_f32_16x16x32_bf16 v[108:111], v[180:183], v[140:143], v[108:111]
s_waitcnt vmcnt(8)
v_mfma_f32_16x16x32_bf16 v[32:35], v[184:187], v[144:147], v[32:35]
s_add_u32 s7, s88, s76
buffer_load_dwordx4 v[128:131], v4, s[48:51], s7 offen sc1
v_mfma_f32_16x16x32_bf16 v[36:39], v[188:191], v[144:147], v[36:39]
v_mfma_f32_16x16x32_bf16 v[40:43], v[192:195], v[144:147], v[40:43]
v_mfma_f32_16x16x32_bf16 v[44:47], v[196:199], v[144:147], v[44:47]
buffer_load_dwordx4 v[132:135], v5, s[48:51], s7 offen sc1
v_mfma_f32_16x16x32_bf16 v[48:51], v[200:203], v[144:147], v[48:51]
v_mfma_f32_16x16x32_bf16 v[52:55], v[184:187], v[148:151], v[52:55]
v_mfma_f32_16x16x32_bf16 v[56:59], v[188:191], v[148:151], v[56:59]
buffer_load_dwordx2 v[20:21], v10, s[48:51], s84 offen sc1
v_mfma_f32_16x16x32_bf16 v[60:63], v[192:195], v[148:151], v[60:63]
v_mfma_f32_16x16x32_bf16 v[64:67], v[196:199], v[148:151], v[64:67]
v_mfma_f32_16x16x32_bf16 v[68:71], v[200:203], v[148:151], v[68:71]
buffer_load_dwordx4 v[136:139], v6, s[48:51], s7 offen sc1
v_mfma_f32_16x16x32_bf16 v[72:75], v[184:187], v[152:155], v[72:75]
v_mfma_f32_16x16x32_bf16 v[76:79], v[188:191], v[152:155], v[76:79]
v_mfma_f32_16x16x32_bf16 v[80:83], v[192:195], v[152:155], v[80:83]
buffer_load_dwordx4 v[140:143], v7, s[48:51], s7 offen sc1
v_mfma_f32_16x16x32_bf16 v[84:87], v[196:199], v[152:155], v[84:87]
v_mfma_f32_16x16x32_bf16 v[88:91], v[200:203], v[152:155], v[88:91]
v_mfma_f32_16x16x32_bf16 v[92:95], v[184:187], v[156:159], v[92:95]
v_mfma_f32_16x16x32_bf16 v[96:99], v[188:191], v[156:159], v[96:99]
v_mfma_f32_16x16x32_bf16 v[100:103], v[192:195], v[156:159], v[100:103]
v_mfma_f32_16x16x32_bf16 v[104:107], v[196:199], v[156:159], v[104:107]
v_mfma_f32_16x16x32_bf16 v[108:111], v[200:203], v[156:159], v[108:111]
s_waitcnt vmcnt(9)
v_mfma_f32_16x16x32_bf16 v[32:35], v[204:207], v[224:227], v[32:35]
s_add_u32 s7, s88, s77
buffer_load_dwordx4 v[144:147], v4, s[48:51], s7 offen sc1
v_mfma_f32_16x16x32_bf16 v[36:39], v[208:211], v[224:227], v[36:39]
v_mfma_f32_16x16x32_bf16 v[40:43], v[212:215], v[224:227], v[40:43]
v_mfma_f32_16x16x32_bf16 v[44:47], v[216:219], v[224:227], v[44:47]
buffer_load_dwordx4 v[148:151], v5, s[48:51], s7 offen sc1
v_mfma_f32_16x16x32_bf16 v[48:51], v[220:223], v[224:227], v[48:51]
v_mfma_f32_16x16x32_bf16 v[52:55], v[204:207], v[228:231], v[52:55]
v_mfma_f32_16x16x32_bf16 v[56:59], v[208:211], v[228:231], v[56:59]
buffer_load_dwordx4 v[152:155], v6, s[48:51], s7 offen sc1
v_mfma_f32_16x16x32_bf16 v[60:63], v[212:215], v[228:231], v[60:63]
v_mfma_f32_16x16x32_bf16 v[64:67], v[216:219], v[228:231], v[64:67]
v_mfma_f32_16x16x32_bf16 v[68:71], v[220:223], v[228:231], v[68:71]
buffer_load_dwordx4 v[156:159], v7, s[48:51], s7 offen sc1
v_mfma_f32_16x16x32_bf16 v[72:75], v[204:207], v[232:235], v[72:75]
v_mfma_f32_16x16x32_bf16 v[76:79], v[208:211], v[232:235], v[76:79]
v_mfma_f32_16x16x32_bf16 v[80:83], v[212:215], v[232:235], v[80:83]
v_mfma_f32_16x16x32_bf16 v[84:87], v[216:219], v[232:235], v[84:87]
v_mfma_f32_16x16x32_bf16 v[88:91], v[220:223], v[232:235], v[88:91]
v_mfma_f32_16x16x32_bf16 v[92:95], v[204:207], v[236:239], v[92:95]
v_mfma_f32_16x16x32_bf16 v[96:99], v[208:211], v[236:239], v[96:99]
v_mfma_f32_16x16x32_bf16 v[100:103], v[212:215], v[236:239], v[100:103]
v_mfma_f32_16x16x32_bf16 v[104:107], v[216:219], v[236:239], v[104:107]
v_mfma_f32_16x16x32_bf16 v[108:111], v[220:223], v[236:239], v[108:111]
s_waitcnt vmcnt(6)
v_cmp_ne_u64 vcc, s[8:9], v[20:21]
s_cbranch_vccz L_chk8x
s_mov_b32 s10, 0x20000
L_chk8:
buffer_load_dwordx2 v[20:21], v10, s[48:51], s84 offen sc1
s_sub_u32 s10, s10, 1
s_waitcnt vmcnt(0)
s_cbranch_scc1 L_chk8x
v_cmp_ne_u64 vcc, s[8:9], v[20:21]
s_cbranch_vccnz L_chk8
L_chk8x:
v_mfma_f32_16x16x32_bf16 v[32:35], a[100:103], v[112:115], v[32:35]
buffer_load_dwordx4 v[160:163], v13, s[48:51], s93 offen sc1
v_mfma_f32_16x16x32_bf16 v[36:39], a[104:107], v[112:115], v[36:39]
v_mfma_f32_16x16x32_bf16 v[40:43], a[108:111], v[112:115], v[40:43]
v_mfma_f32_16x16x32_bf16 v[44:47], a[112:115], v[112:115], v[44:47]
buffer_load_dwordx4 v[164:167], v13, s[48:51], s94 offen sc1
v_mfma_f32_16x16x32_bf16 v[48:51], a[116:119], v[112:115], v[48:51]
v_mfma_f32_16x16x32_bf16 v[52:55], a[100:103], v[116:119], v[52:55]
v_mfma_f32_16x16x32_bf16 v[56:59], a[104:107], v[116:119], v[56:59]
s_mul_i32 s23, s20, 20
s_add_u32 s23, s23, s22
s_add_u32 s23, s23, 81920
buffer_load_dwordx4 a[60:63], v22, s[48:51], s23 offen offset:0 sc1
v_mfma_f32_16x16x32_bf16 v[60:63], a[108:111], v[116:119], v[60:63]
v_mfma_f32_16x16x32_bf16 v[64:67], a[112:115], v[116:119], v[64:67]
v_mfma_f32_16x16x32_bf16 v[68:71], a[116:119], v[116:119], v[68:71]
buffer_load_dwordx4 a[64:67], v22, s[48:51], s23 offen offset:1024 sc1
v_mfma_f32_16x16x32_bf16 v[72:75], a[100:103], v[120:123], v[72:75]
v_mfma_f32_16x16x32_bf16 v[76:79], a[104:107], v[120:123], v[76:79]
v_mfma_f32_16x16x32_bf16 v[80:83], a[108:111], v[120:123], v[80:83]
buffer_load_dwordx4 a[68:71], v22, s[48:51], s23 offen offset:2048 sc1
v_mfma_f32_16x16x32_bf16 v[84:87], a[112:115], v[120:123], v[84:87]
v_mfma_f32_16x16x32_bf16 v[88:91], a[116:119], v[120:123], v[88:91]
v_mfma_f32_16x16x32_bf16 v[92:95], a[100:103], v[124:127], v[92:95]
buffer_load_dwordx4 a[72:75], v22, s[48:51], s23 offen offset:3072 sc1
v_mfma_f32_16x16x32_bf16 v[96:99], a[104:107], v[124:127], v[96:99]
v_mfma_f32_16x16x32_bf16 v[100:103], a[108:111], v[124:127], v[100:103]
v_mfma_f32_16x16x32_bf16 v[104:107], a[112:115], v[124:127], v[104:107]
v_mfma_f32_16x16x32_bf16 v[108:111], a[116:119], v[124:127], v[108:111]
s_waitcnt vmcnt(10)
v_mfma_f32_16x16x32_bf16 v[32:35], a[120:123], v[128:131], v[32:35]
buffer_load_dwordx4 v[168:171], v13, s[48:51], s95 offen sc1
v_mfma_f32_16x16x32_bf16 v[36:39], a[124:127], v[128:131], v[36:39]
v_mfma_f32_16x16x32_bf16 v[40:43], a[128:131], v[128:131], v[40:43]
v_mfma_f32_16x16x32_bf16 v[44:47], a[132:135], v[128:131], v[44:47]
buffer_load_dwordx4 v[172:175], v13, s[48:51], s96 offen sc1
v_mfma_f32_16x16x32_bf16 v[48:51], a[136:139], v[128:131], v[48:51]
v_mfma_f32_16x16x32_bf16 v[52:55], a[120:123], v[132:135], v[52:55]
v_mfma_f32_16x16x32_bf16 v[56:59], a[124:127], v[132:135], v[56:59]
buffer_load_dwordx4 a[76:79], v23, s[48:51], s23 offen offset:0 sc1
v_mfma_f32_16x16x32_bf16 v[60:63], a[128:131], v[132:135], v[60:63]
v_mfma_f32_16x16x32_bf16 v[64:67], a[132:135], v[132:135], v[64:67]
v_mfma_f32_16x16x32_bf16 v[68:71], a[136:139], v[132:135], v[68:71]
s_mul_i32 s23, s21, 20
s_add_u32 s23, s23, s22
s_add_u32 s23, s23, 81920
buffer_load_dwordx4 a[80:83], v22, s[48:51], s23 offen offset:0 sc1
v_mfma_f32_16x16x32_bf16 v[72:75], a[120:123], v[136:139], v[72:75]
v_mfma_f32_16x16x32_bf16 v[76:79], a[124:127], v[136:139], v[76:79]
v_mfma_f32_16x16x32_bf16 v[80:83], a[128:131], v[136:139], v[80:83]
buffer_load_dwordx4 a[84:87], v22, s[48:51], s23 offen offset:1024 sc1
v_mfma_f32_16x16x32_bf16 v[84:87], a[132:135], v[136:139], v[84:87]
v_mfma_f32_16x16x32_bf16 v[88:91], a[136:139], v[136:139], v[88:91]
v_mfma_f32_16x16x32_bf16 v[92:95], a[120:123], v[140:143], v[92:95]
buffer_load_dwordx4 a[88:91], v22, s[48:51], s23 offen offset:2048 sc1
v_mfma_f32_16x16x32_bf16 v[96:99], a[124:127], v[140:143], v[96:99]
v_mfma_f32_16x16x32_bf16 v[100:103], a[128:131], v[140:143], v[100:103]
v_mfma_f32_16x16x32_bf16 v[104:107], a[132:135], v[140:143], v[104:107]
v_mfma_f32_16x16x32_bf16 v[108:111], a[136:139], v[140:143], v[108:111]
s_waitcnt vmcnt(12)
v_mfma_f32_16x16x32_bf16 v[32:35], a[140:143], v[144:147], v[32:35]
buffer_load_dwordx4 v[176:179], v13, s[48:51], s97 offen sc1
v_mfma_f32_16x16x32_bf16 v[36:39], a[144:147], v[144:147], v[36:39]
v_mfma_f32_16x16x32_bf16 v[40:43], a[148:151], v[144:147], v[40:43]
v_mfma_f32_16x16x32_bf16 v[44:47], a[152:155], v[144:147], v[44:47]
buffer_load_dwordx4 v[180:183], v13, s[48:51], s98 offen sc1
v_mfma_f32_16x16x32_bf16 v[48:51], a[156:159], v[144:147], v[48:51]
v_mfma_f32_16x16x32_bf16 v[52:55], a[140:143], v[148:151], v[52:55]
v_mfma_f32_16x16x32_bf16 v[56:59], a[144:147], v[148:151], v[56:59]
buffer_load_dwordx4 a[92:95], v22, s[48:51], s23 offen offset:3072 sc1
v_mfma_f32_16x16x32_bf16 v[60:63], a[148:151], v[148:151], v[60:63]
v_mfma_f32_16x16x32_bf16 v[64:67], a[152:155], v[148:151], v[64:67]
v_mfma_f32_16x16x32_bf16 v[68:71], a[156:159], v[148:151], v[68:71]
buffer_load_dwordx4 a[96:99], v23, s[48:51], s23 offen offset:0 sc1
v_mfma_f32_16x16x32_bf16 v[72:75], a[140:143], v[152:155], v[72:75]
v_mfma_f32_16x16x32_bf16 v[76:79], a[144:147], v[152:155], v[76:79]
v_mfma_f32_16x16x32_bf16 v[80:83], a[148:151], v[152:155], v[80:83]
buffer_load_dwordx4 v[184:187], v14, s[48:51], s93 offen sc1
v_mfma_f32_16x16x32_bf16 v[84:87], a[152:155], v[152:155], v[84:87]
v_mfma_f32_16x16x32_bf16 v[88:91], a[156:159], v[152:155], v[88:91]
v_mfma_f32_16x16x32_bf16 v[92:95], a[140:143], v[156:159], v[92:95]
buffer_load_dwordx4 v[188:191], v14, s[48:51], s94 offen sc1
v_mfma_f32_16x16x32_bf16 v[96:99], a[144:147], v[156:159], v[96:99]
v_mfma_f32_16x16x32_bf16 v[100:103], a[148:151], v[156:159], v[100:103]
v_mfma_f32_16x16x32_bf16 v[104:107], a[152:155], v[156:159], v[104:107]
v_mfma_f32_16x16x32_bf16 v[108:111], a[156:159], v[156:159], v[108:111]
s_waitcnt vmcnt(17)
v_mfma_f32_16x16x32_bf16 v[52:55], a[160:163], v[160:163], v[52:55]
buffer_load_dwordx4 v[192:195], v14, s[48:51], s95 offen sc1
v_mfma_f32_16x16x32_bf16 v[56:59], a[164:167], v[160:163], v[56:59]
v_mfma_f32_16x16x32_bf16 v[60:63], a[168:171], v[160:163], v[60:63]
v_mfma_f32_16x16x32_bf16 v[64:67], a[172:175], v[160:163], v[64:67]
v_mfma_f32_16x16x32_bf16 v[68:71], a[176:179], v[160:163], v[68:71]
buffer_load_dwordx4 v[196:199], v14, s[48:51], s96 offen sc1
s_waitcnt vmcnt(18)
v_mfma_f32_16x16x32_bf16 v[52:55], a[0:3], v[164:167], v[52:55]
v_mfma_f32_16x16x32_bf16 v[56:59], a[4:7], v[164:167], v[56:59]
v_mfma_f32_16x16x32_bf16 v[60:63], a[8:11], v[164:167], v[60:63]
v_mfma_f32_16x16x32_bf16 v[64:67], a[12:15], v[164:167], v[64:67]
buffer_load_dwordx4 v[200:203], v14, s[48:51], s97 offen sc1
v_mfma_f32_16x16x32_bf16 v[68:71], a[16:19], v[164:167], v[68:71]
s_waitcnt vmcnt(14)
v_mfma_f32_16x16x32_bf16 v[52:55], a[20:23], v[168:171], v[52:55]
v_mfma_f32_16x16x32_bf16 v[56:59], a[24:27], v[168:171], v[56:59]
v_mfma_f32_16x16x32_bf16 v[60:63], a[28:31], v[168:171], v[60:63]
buffer_load_dwordx4 v[204:207], v14, s[48:51], s98 offen sc1
v_mfma_f32_16x16x32_bf16 v[64:67], a[32:35], v[168:171], v[64:67]
v_mfma_f32_16x16x32_bf16 v[68:71], a[36:39], v[168:171], v[68:71]
s_waitcnt vmcnt(14)
v_mfma_f32_16x16x32_bf16 v[52:55], a[40:43], v[172:175], v[52:55]
v_mfma_f32_16x16x32_bf16 v[56:59], a[44:47], v[172:175], v[56:59]
buffer_load_dwordx4 v[208:211], v15, s[48:51], s93 offen sc1
v_mfma_f32_16x16x32_bf16 v[60:63], a[48:51], v[172:175], v[60:63]
v_mfma_f32_16x16x32_bf16 v[64:67], a[52:55], v[172:175], v[64:67]
v_mfma_f32_16x16x32_bf16 v[68:71], a[56:59], v[172:175], v[68:71]
s_waitcnt vmcnt(10)
v_mfma_f32_16x16x32_bf16 v[52:55], a[60:63], v[176:179], v[52:55]
buffer_load_dwordx4 v[212:215], v15, s[48:51], s94 offen sc1
v_mfma_f32_16x16x32_bf16 v[56:59], a[64:67], v[176:179], v[56:59]
v_mfma_f32_16x16x32_bf16 v[60:63], a[68:71], v[176:179], v[60:63]
v_mfma_f32_16x16x32_bf16 v[64:67], a[72:75], v[176:179], v[64:67]
v_mfma_f32_16x16x32_bf16 v[68:71], a[76:79], v[176:179], v[68:71]
buffer_load_dwordx4 v[216:219], v15, s[48:51], s95 offen sc1
s_waitcnt vmcnt(9)
v_mfma_f32_16x16x32_bf16 v[52:55], a[80:83], v[180:183], v[52:55]
v_mfma_f32_16x16x32_bf16 v[56:59], a[84:87], v[180:183], v[56:59]
v_mfma_f32_16x16x32_bf16 v[60:63], a[88:91], v[180:183], v[60:63]
v_mfma_f32_16x16x32_bf16 v[64:67], a[92:95], v[180:183], v[64:67]
buffer_load_dwordx4 v[220:223], v15, s[48:51], s96 offen sc1
v_mfma_f32_16x16x32_bf16 v[68:71], a[96:99], v[180:183], v[68:71]
s_waitcnt vmcnt(9)
v_mfma_f32_16x16x32_bf16 v[72:75], a[160:163], v[184:187], v[72:75]
buffer_load_dwordx4 v[224:227], v15, s[48:51], s97 offen sc1
v_mfma_f32_16x16x32_bf16 v[76:79], a[164:167], v[184:187], v[76:79]
v_mfma_f32_16x16x32_bf16 v[80:83], a[168:171], v[184:187], v[80:83]
ds_write_b128 v17, v[52:55] offset:0
v_mfma_f32_16x16x32_bf16 v[84:87], a[172:175], v[184:187], v[84:87]
v_mfma_f32_16x16x32_bf16 v[88:91], a[176:179], v[184:187], v[88:91]
buffer_load_dwordx4 v[228:231], v15, s[48:51], s98 offen sc1
s_waitcnt vmcnt(10)
v_mfma_f32_16x16x32_bf16 v[72:75], a[0:3], v[188:191], v[72:75]
v_mfma_f32_16x16x32_bf16 v[76:79], a[4:7], v[188:191], v[76:79]
ds_write_b128 v17, v[56:59] offset:1024
v_mfma_f32_16x16x32_bf16 v[80:83], a[8:11], v[188:191], v[80:83]
v_mfma_f32_16x16x32_bf16 v[84:87], a[12:15], v[188:191], v[84:87]
buffer_load_dwordx4 v[232:235], v12, s[48:51], s93 offen sc1
v_mfma_f32_16x16x32_bf16 v[88:91], a[16:19], v[188:191], v[88:91]
s_waitcnt vmcnt(10)
v_mfma_f32_16x16x32_bf16 v[72:75], a[20:23], v[192:195], v[72:75]
ds_write_b128 v17, v[60:63] offset:2048
v_mfma_f32_16x16x32_bf16 v[76:79], a[24:27], v[192:195], v[76:79]
v_mfma_f32_16x16x32_bf16 v[80:83], a[28:31], v[192:195], v[80:83]
buffer_load_dwordx4 v[236:239], v12, s[48:51], s94 offen sc1
v_mfma_f32_16x16x32_bf16 v[84:87], a[32:35], v[192:195], v[84:87]
v_mfma_f32_16x16x32_bf16 v[88:91], a[36:39], v[192:195], v[88:91]
ds_write_b128 v17, v[64:67] offset:3072
s_waitcnt vmcnt(10)
v_mfma_f32_16x16x32_bf16 v[72:75], a[40:43], v[196:199], v[72:75]
v_mfma_f32_16x16x32_bf16 v[76:79], a[44:47], v[196:199], v[76:79]
buffer_load_dwordx4 v[112:115], v12, s[48:51], s95 offen sc1
v_mfma_f32_16x16x32_bf16 v[80:83], a[48:51], v[196:199], v[80:83]
v_mfma_f32_16x16x32_bf16 v[84:87], a[52:55], v[196:199], v[84:87]
ds_write_b128 v17, v[68:71] offset:4096
v_mfma_f32_16x16x32_bf16 v[88:91], a[56:59], v[196:199], v[88:91]
s_waitcnt vmcnt(10)
v_mfma_f32_16x16x32_bf16 v[72:75], a[60:63], v[200:203], v[72:75]
buffer_load_dwordx4 v[116:119], v12, s[48:51], s96 offen sc1
v_mfma_f32_16x16x32_bf16 v[76:79], a[64:67], v[200:203], v[76:79]
v_mfma_f32_16x16x32_bf16 v[80:83], a[68:71], v[200:203], v[80:83]
v_mfma_f32_16x16x32_bf16 v[84:87], a[72:75], v[200:203], v[84:87]
v_mfma_f32_16x16x32_bf16 v[88:91], a[76:79], v[200:203], v[88:91]
buffer_load_dwordx4 v[120:123], v12, s[48:51], s97 offen sc1
s_waitcnt vmcnt(11)
v_mfma_f32_16x16x32_bf16 v[72:75], a[80:83], v[204:207], v[72:75]
v_mfma_f32_16x16x32_bf16 v[76:79], a[84:87], v[204:207], v[76:79]
v_mfma_f32_16x16x32_bf16 v[80:83], a[88:91], v[204:207], v[80:83]
v_mfma_f32_16x16x32_bf16 v[84:87], a[92:95], v[204:207], v[84:87]
s_waitcnt lgkmcnt(0)
s_barrier
v_mfma_f32_16x16x32_bf16 v[88:91], a[96:99], v[204:207], v[88:91]
s_waitcnt vmcnt(10)
v_mfma_f32_16x16x32_bf16 v[92:95], a[160:163], v[208:211], v[92:95]
buffer_load_dwordx4 v[124:127], v12, s[48:51], s98 offen sc1
v_mfma_f32_16x16x32_bf16 v[96:99], a[164:167], v[208:211], v[96:99]
ds_read_b128 v[52:55], v16 offset:0
v_mfma_f32_16x16x32_bf16 v[100:103], a[168:171], v[208:211], v[100:103]
ds_write_b128 v18, v[72:75] offset:0
v_mfma_f32_16x16x32_bf16 v[104:107], a[172:175], v[208:211], v[104:107]
ds_read_b128 v[56:59], v16 offset:1024
v_mfma_f32_16x16x32_bf16 v[108:111], a[176:179], v[208:211], v[108:111]
ds_read_b128 v[60:63], v16 offset:2048
s_waitcnt vmcnt(10)
v_mfma_f32_16x16x32_bf16 v[92:95], a[0:3], v[212:215], v[92:95]
ds_read_b128 v[64:67], v16 offset:3072
v_mfma_f32_16x16x32_bf16 v[96:99], a[4:7], v[212:215], v[96:99]
ds_write_b128 v18, v[76:79] offset:1024
v_mfma_f32_16x16x32_bf16 v[100:103], a[8:11], v[212:215], v[100:103]
ds_read_b128 v[68:71], v16 offset:4096
v_mfma_f32_16x16x32_bf16 v[104:107], a[12:15], v[212:215], v[104:107]
v_mfma_f32_16x16x32_bf16 v[108:111], a[16:19], v[212:215], v[108:111]
s_waitcnt vmcnt(9)
v_mfma_f32_16x16x32_bf16 v[92:95], a[20:23], v[216:219], v[92:95]
ds_write_b128 v18, v[80:83] offset:2048
v_mfma_f32_16x16x32_bf16 v[96:99], a[24:27], v[216:219], v[96:99]
v_mfma_f32_16x16x32_bf16 v[100:103], a[28:31], v[216:219], v[100:103]
v_mfma_f32_16x16x32_bf16 v[104:107], a[32:35], v[216:219], v[104:107]
v_mfma_f32_16x16x32_bf16 v[108:111], a[36:39], v[216:219], v[108:111]
ds_write_b128 v18, v[84:87] offset:3072
s_waitcnt vmcnt(8)
v_mfma_f32_16x16x32_bf16 v[92:95], a[40:43], v[220:223], v[92:95]
v_mfma_f32_16x16x32_bf16 v[96:99], a[44:47], v[220:223], v[96:99]
v_mfma_f32_16x16x32_bf16 v[100:103], a[48:51], v[220:223], v[100:103]
v_mfma_f32_16x16x32_bf16 v[104:107], a[52:55], v[220:223], v[104:107]
ds_write_b128 v18, v[88:91] offset:4096
v_mfma_f32_16x16x32_bf16 v[108:111], a[56:59], v[220:223], v[108:111]
s_waitcnt vmcnt(7)
v_mfma_f32_16x16x32_bf16 v[92:95], a[60:63], v[224:227], v[92:95]
v_mfma_f32_16x16x32_bf16 v[96:99], a[64:67], v[224:227], v[96:99]
v_mfma_f32_16x16x32_bf16 v[100:103], a[68:71], v[224:227], v[100:103]
v_mfma_f32_16x16x32_bf16 v[104:107], a[72:75], v[224:227], v[104:107]
v_mfma_f32_16x16x32_bf16 v[108:111], a[76:79], v[224:227], v[108:111]
s_waitcnt vmcnt(6)
v_mfma_f32_16x16x32_bf16 v[92:95], a[80:83], v[228:231], v[92:95]
v_mfma_f32_16x16x32_bf16 v[96:99], a[84:87], v[228:231], v[96:99]
v_mfma_f32_16x16x32_bf16 v[100:103], a[88:91], v[228:231], v[100:103]
v_mfma_f32_16x16x32_bf16 v[104:107], a[92:95], v[228:231], v[104:107]
s_waitcnt lgkmcnt(0)
s_barrier
v_mfma_f32_16x16x32_bf16 v[108:111], a[96:99], v[228:231], v[108:111]
s_waitcnt vmcnt(5)
v_mfma_f32_16x16x32_bf16 v[32:35], a[160:163], v[232:235], v[32:35]
ds_read_b128 v[72:75], v16 offset:5120
v_mfma_f32_16x16x32_bf16 v[36:39], a[164:167], v[232:235], v[36:39]
ds_read_b128 v[76:79], v16 offset:6144
v_mfma_f32_16x16x32_bf16 v[40:43], a[168:171], v[232:235], v[40:43]
ds_write_b128 v19, v[92:95] offset:0
v_mfma_f32_16x16x32_bf16 v[44:47], a[172:175], v[232:235], v[44:47]
ds_read_b128 v[80:83], v16 offset:7168
v_mfma_f32_16x16x32_bf16 v[48:51], a[176:179], v[232:235], v[48:51]
ds_read_b128 v[84:87], v16 offset:8192
s_waitcnt vmcnt(4)
v_mfma_f32_16x16x32_bf16 v[32:35], a[0:3], v[236:239], v[32:35]
ds_read_b128 v[88:91], v16 offset:9216
v_mfma_f32_16x16x32_bf16 v[36:39], a[4:7], v[236:239], v[36:39]
ds_write_b128 v19, v[96:99] offset:1024
v_mfma_f32_16x16x32_bf16 v[40:43], a[8:11], v[236:239], v[40:43]
v_mfma_f32_16x16x32_bf16 v[44:47], a[12:15], v[236:239], v[44:47]
v_mfma_f32_16x16x32_bf16 v[48:51], a[16:19], v[236:239], v[48:51]
s_waitcnt vmcnt(3)
v_mfma_f32_16x16x32_bf16 v[32:35], a[20:23], v[112:115], v[32:35]
ds_write_b128 v19, v[100:103] offset:2048
v_mfma_f32_16x16x32_bf16 v[36:39], a[24:27], v[112:115], v[36:39]
s_waitcnt lgkmcnt(2)
v_add_f32 v52, v52, v72
v_mfma_f32_16x16x32_bf16 v[40:43], a[28:31], v[112:115], v[40:43]
v_add_f32 v53, v53, v73
v_add_f32 v54, v54, v74
v_mfma_f32_16x16x32_bf16 v[44:47], a[32:35], v[112:115], v[44:47]
v_add_f32 v55, v55, v75
v_add_f32 v56, v56, v76
v_mfma_f32_16x16x32_bf16 v[48:51], a[36:39], v[112:115], v[48:51]
ds_write_b128 v19, v[104:107] offset:3072
s_waitcnt vmcnt(2)
v_mfma_f32_16x16x32_bf16 v[32:35], a[40:43], v[116:119], v[32:35]
v_add_f32 v57, v57, v77
v_add_f32 v58, v58, v78
v_mfma_f32_16x16x32_bf16 v[36:39], a[44:47], v[116:119], v[36:39]
v_add_f32 v59, v59, v79
v_add_f32 v60, v60, v80
v_mfma_f32_16x16x32_bf16 v[40:43], a[48:51], v[116:119], v[40:43]
v_add_f32 v61, v61, v81
v_add_f32 v62, v62, v82
v_mfma_f32_16x16x32_bf16 v[44:47], a[52:55], v[116:119], v[44:47]
ds_write_b128 v19, v[108:111] offset:4096
v_mfma_f32_16x16x32_bf16 v[48:51], a[56:59], v[116:119], v[48:51]
v_add_f32 v63, v63, v83
v_add_f32 v64, v64, v84
s_waitcnt vmcnt(1)
v_mfma_f32_16x16x32_bf16 v[32:35], a[60:63], v[120:123], v[32:35]
v_add_f32 v65, v65, v85
v_add_f32 v66, v66, v86
v_mfma_f32_16x16x32_bf16 v[36:39], a[64:67], v[120:123], v[36:39]
v_add_f32 v67, v67, v87
v_add_f32 v68, v68, v88
v_mfma_f32_16x16x32_bf16 v[40:43], a[68:71], v[120:123], v[40:43]
v_add_f32 v69, v69, v89
v_add_f32 v70, v70, v90
v_mfma_f32_16x16x32_bf16 v[44:47], a[72:75], v[120:123], v[44:47]
s_waitcnt lgkmcnt(0)
s_barrier
ds_read_b128 v[92:95], v16 offset:10240
ds_read_b128 v[96:99], v16 offset:11264
ds_read_b128 v[100:103], v16 offset:12288
ds_read_b128 v[104:107], v16 offset:13312
ds_read_b128 v[108:111], v16 offset:14336
v_mfma_f32_16x16x32_bf16 v[48:51], a[76:79], v[120:123], v[48:51]
v_add_f32 v71, v71, v91
s_waitcnt vmcnt(0)
v_mfma_f32_16x16x32_bf16 v[32:35], a[80:83], v[124:127], v[32:35]
v_mfma_f32_16x16x32_bf16 v[36:39], a[84:87], v[124:127], v[36:39]
v_mfma_f32_16x16x32_bf16 v[40:43], a[88:91], v[124:127], v[40:43]
v_mfma_f32_16x16x32_bf16 v[44:47], a[92:95], v[124:127], v[44:47]
v_mfma_f32_16x16x32_bf16 v[48:51], a[96:99], v[124:127], v[48:51]
s_waitcnt lgkmcnt(0)
v_pk_add_f32 v[52:53], v[52:53], v[92:93]
v_pk_add_f32 v[54:55], v[54:55], v[94:95]
v_pk_add_f32 v[56:57], v[56:57], v[96:97]
v_pk_add_f32 v[58:59], v[58:59], v[98:99]
v_pk_add_f32 v[60:61], v[60:61], v[100:101]
v_pk_add_f32 v[62:63], v[62:63], v[102:103]
v_pk_add_f32 v[64:65], v[64:65], v[104:105]
v_pk_add_f32 v[66:67], v[66:67], v[106:107]
v_pk_add_f32 v[68:69], v[68:69], v[108:109]
v_pk_add_f32 v[70:71], v[70:71], v[110:111]
v_pk_add_f32 v[52:53], v[52:53], v[32:33]
v_pk_add_f32 v[54:55], v[54:55], v[34:35]
v_cvt_pk_bf16_f32 v160, v52, v53
v_cvt_pk_bf16_f32 v161, v54, v55
ds_write_b64 v26, v[160:161] offset:0
v_pk_add_f32 v[56:57], v[56:57], v[36:37]
v_pk_add_f32 v[58:59], v[58:59], v[38:39]
v_cvt_pk_bf16_f32 v162, v56, v57
v_cvt_pk_bf16_f32 v163, v58, v59
ds_write_b64 v26, v[162:163] offset:32
v_pk_add_f32 v[60:61], v[60:61], v[40:41]
v_pk_add_f32 v[62:63], v[62:63], v[42:43]
v_cvt_pk_bf16_f32 v164, v60, v61
v_cvt_pk_bf16_f32 v165, v62, v63
ds_write_b64 v26, v[164:165] offset:64
v_pk_add_f32 v[64:65], v[64:65], v[44:45]
v_pk_add_f32 v[66:67], v[66:67], v[46:47]
v_cvt_pk_bf16_f32 v166, v64, v65
v_cvt_pk_bf16_f32 v167, v66, v67
ds_write_b64 v26, v[166:167] offset:96
v_pk_add_f32 v[68:69], v[68:69], v[48:49]
v_pk_add_f32 v[70:71], v[70:71], v[50:51]
v_cvt_pk_bf16_f32 v168, v68, v69
v_cvt_pk_bf16_f32 v169, v70, v71
ds_write_b64 v26, v[168:169] offset:128
ds_read_b128 v[176:179], v29 offset:0
ds_read_b128 v[180:183], v29 offset:1024
ds_read_b128 v[184:187], v29 offset:2048
s_waitcnt lgkmcnt(2)
buffer_store_dwordx4 v[176:179], v25, s[56:59], 0 offen
s_waitcnt lgkmcnt(1)
buffer_store_dwordx4 v[180:183], v27, s[56:59], 0 offen
s_waitcnt lgkmcnt(0)
s_mov_b32 exec_hi, 0
buffer_store_dwordx4 v[184:187], v31, s[56:59], 0 offen
s_mov_b32 exec_hi, -1
s_branch L_fin
L_kv:
s_sub_u32 s11, s6, 20
s_lshr_b32 s61, s11, 2
s_and_b32 s63, s11, 3
s_lshl_b32 s60, s4, 2
s_add_u32 s60, s60, s63
s_mul_i32 s64, s61, 5
s_lshl_b32 s11, s63, 1
s_add_u32 s64, s64, s11
s_mul_i32 s11, s5, 5
s_add_u32 s11, s11, 5
s_lshr_b32 s11, s11, 2
s_add_u32 s64, s64, s11
s_cmp_ge_u32 s64, 10
s_cselect_b32 s11, 10, 0
s_sub_u32 s64, s64, s11
s_cmp_ge_u32 s64, 10
s_cselect_b32 s11, 10, 0
s_sub_u32 s64, s64, s11
s_cmp_eq_u32 s61, 2
s_cbranch_scc1 L_g3
s_lshl_b32 s62, s5, 1
s_add_u32 s62, s62, s61
s_lshl_b32 s62, s62, 2
s_add_u32 s62, s62, s3
s_lshl_b32 s62, s62, 6
s_mul_i32 s12, s62, 1280
v_add_u32 v248, s12, v4
v_xor_b32 v249, 64, v248
v_add_u32 v4, 0, v248
v_add_u32 v5, 9216, v249
v_add_u32 v6, 18432, v248
v_add_u32 v7, 27648, v249
v_add_u32 v8, 40960, v248
v_add_u32 v9, 50176, v249
v_add_u32 v10, 59392, v248
v_add_u32 v11, 68608, v249
s_mul_i32 s95, s3, 5120
s_mul_i32 s96, s3, 8192
s_add_u32 s96, s96, 20480
s_mov_b32 s68, s64
s_mov_b32 s71, 0
s_mov_b32 s93, 0
s_mul_i32 s11, s3, 320
s_mul_i32 s12, s60, 160
s_add_u32 s12, s12, 1280
s_mov_b32 s13, 3840
v_add_u32 v248, s11, v1
v_add_u32 v248, 0, v248
v_mul_u32_u24 v249, 3277, v248
v_lshrrev_b32 v249, 16, v249
v_mul_u32_u24 v250, 20, v249
v_sub_u32 v248, v248, v250
v_lshrrev_b32 v250, 2, v249
v_and_b32 v250, 2, v250
v_xor_b32 v248, v248, v250
v_cmp_lt_u32 vcc, 9, v248
v_lshlrev_b32 v248, 4, v248
v_mad_u32_u24 v248, v249, s13, v248
v_add_u32 v248, s12, v248
v_add_u32 v249, 1120, v248
v_cndmask_b32 v248, v248, v249, vcc
v_subrev_u32 v12, 0, v248
v_add_u32 v248, s11, v1
v_add_u32 v248, 64, v248
v_mul_u32_u24 v249, 3277, v248
v_lshrrev_b32 v249, 16, v249
v_mul_u32_u24 v250, 20, v249
v_sub_u32 v248, v248, v250
v_lshrrev_b32 v250, 2, v249
v_and_b32 v250, 2, v250
v_xor_b32 v248, v248, v250
v_cmp_lt_u32 vcc, 9, v248
v_lshlrev_b32 v248, 4, v248
v_mad_u32_u24 v248, v249, s13, v248
v_add_u32 v248, s12, v248
v_add_u32 v249, 1120, v248
v_cndmask_b32 v248, v248, v249, vcc
v_subrev_u32 v13, 1024, v248
v_add_u32 v248, s11, v1
v_add_u32 v248, 128, v248
v_mul_u32_u24 v249, 3277, v248
v_lshrrev_b32 v249, 16, v249
v_mul_u32_u24 v250, 20, v249
v_sub_u32 v248, v248, v250
v_lshrrev_b32 v250, 2, v249
v_and_b32 v250, 2, v250
v_xor_b32 v248, v248, v250
v_cmp_lt_u32 vcc, 9, v248
v_lshlrev_b32 v248, 4, v248
v_mad_u32_u24 v248, v249, s13, v248
v_add_u32 v248, s12, v248
v_add_u32 v249, 1120, v248
v_cndmask_b32 v248, v248, v249, vcc
v_subrev_u32 v14, 2048, v248
v_add_u32 v248, s11, v1
v_add_u32 v248, 192, v248
v_mul_u32_u24 v249, 3277, v248
v_lshrrev_b32 v249, 16, v249
v_mul_u32_u24 v250, 20, v249
v_sub_u32 v248, v248, v250
v_lshrrev_b32 v250, 2, v249
v_and_b32 v250, 2, v250
v_xor_b32 v248, v248, v250
v_cmp_lt_u32 vcc, 9, v248
v_lshlrev_b32 v248, 4, v248
v_mad_u32_u24 v248, v249, s13, v248
v_add_u32 v248, s12, v248
v_add_u32 v249, 1120, v248
v_cndmask_b32 v248, v248, v249, vcc
v_subrev_u32 v15, 3072, v248
v_add_u32 v248, s11, v1
v_add_u32 v248, 256, v248
v_mul_u32_u24 v249, 3277, v248
v_lshrrev_b32 v249, 16, v249
v_mul_u32_u24 v250, 20, v249
v_sub_u32 v248, v248, v250
v_lshrrev_b32 v250, 2, v249
v_and_b32 v250, 2, v250
v_xor_b32 v248, v248, v250
v_cmp_lt_u32 vcc, 9, v248
v_lshlrev_b32 v248, 4, v248
v_mad_u32_u24 v248, v249, s13, v248
v_add_u32 v248, s12, v248
v_add_u32 v249, 1120, v248
v_cndmask_b32 v248, v248, v249, vcc
v_subrev_u32 v16, 0, v248
s_waitcnt lgkmcnt(0)
s_mov_b32 s40, s16
s_mov_b32 s41, s17
s_mov_b32 s42, 2621440
s_mov_b32 s43, 0x20000
s_mov_b32 s44, s18
s_mov_b32 s45, s19
s_mov_b32 s46, 2457600
s_mov_b32 s47, 0x20000
s_mul_i32 s69, s68, 245760
s_lshl_b32 s70, s68, 7
s_cmp_ge_u32 s93, 10
s_cselect_b32 s69, 2130706432, s69
s_cselect_b32 s71, 0x30000, s71
s_add_u32 m0, s95, s71
s_nop 0
buffer_load_dwordx4 v12, s[44:47], s69 offen offset:0 lds
buffer_load_dwordx4 v13, s[44:47], s69 offen offset:1024 lds
buffer_load_dwordx4 v14, s[44:47], s69 offen offset:2048 lds
buffer_load_dwordx4 v15, s[44:47], s69 offen offset:3072 lds
s_addk_i32 m0, 4096
s_nop 0
buffer_load_dwordx4 v16, s[44:47], s69 offen offset:0 lds
s_add_u32 m0, s96, s71
s_nop 0
buffer_load_dwordx4 v4, s[40:43], s70 offen offset:0 lds
buffer_load_dwordx4 v5, s[40:43], s70 offen offset:1024 lds
buffer_load_dwordx4 v6, s[40:43], s70 offen offset:2048 lds
buffer_load_dwordx4 v7, s[40:43], s70 offen offset:3072 lds
s_addk_i32 m0, 4096
s_mov_b32 s48, s36
s_mov_b32 s49, s37
s_mov_b32 s50, 23068672
s_mov_b32 s51, 0x20000
s_mov_b32 s56, s34
s_mov_b32 s57, s35
s_mov_b32 s58, 256
s_mov_b32 s59, 0x20000
v_and_b32 v248, 15, v1
v_lshrrev_b32 v249, 4, v1
v_lshrrev_b32 v250, 1, v248
v_xor_b32 v250, v250, v249
v_lshlrev_b32 v250, 4, v250
v_lshl_add_u32 v250, v248, 7, v250
v_add_u32 v17, s96, v250
v_xor_b32 v18, 64, v17
v_lshrrev_b32 v250, 2, v248
v_lshl_add_u32 v250, v249, 3, v250
v_mul_u32_u24 v250, 320, v250
v_and_b32 v248, 3, v248
v_lshl_add_u32 v250, v248, 3, v250
v_and_b32 v249, 1, v249
v_lshlrev_b32 v249, 5, v249
v_add_u32 v19, v250, v249
v_sub_u32 v20, v250, v249
s_cmp_ge_u32 s3, 2
s_cselect_b64 vcc, -1, 0
s_cselect_b32 s11, 160, 0
s_and_b32 s12, s3, 1
s_mul_i32 s12, s12, 10240
s_add_u32 s11, s11, s12
v_cndmask_b32 v24, v19, v20, vcc
v_cndmask_b32 v25, v20, v19, vcc
v_add_u32 v24, s11, v24
v_add_u32 v25, s11, v25
v_mov_b32 v248, s67
s_mov_b32 s97, 0
v_accvgpr_write_b32 a32, v248
v_accvgpr_write_b32 a33, v248
v_accvgpr_write_b32 a34, v248
v_accvgpr_write_b32 a35, v248
v_accvgpr_write_b32 a100, 0
v_accvgpr_write_b32 a101, 0
v_accvgpr_write_b32 a102, 0
v_accvgpr_write_b32 a103, 0
v_accvgpr_write_b32 a104, 0
v_accvgpr_write_b32 a105, 0
v_accvgpr_write_b32 a106, 0
v_accvgpr_write_b32 a107, 0
v_accvgpr_write_b32 a108, 0
v_accvgpr_write_b32 a109, 0
v_accvgpr_write_b32 a110, 0
v_accvgpr_write_b32 a111, 0
v_accvgpr_write_b32 a112, 0
v_accvgpr_write_b32 a113, 0
v_accvgpr_write_b32 a114, 0
v_accvgpr_write_b32 a115, 0
v_accvgpr_write_b32 a116, 0
v_accvgpr_write_b32 a117, 0
v_accvgpr_write_b32 a118, 0
v_accvgpr_write_b32 a119, 0
v_mov_b64 v[32:33], 0
v_mov_b64 v[34:35], 0
v_mov_b64 v[36:37], 0
v_mov_b64 v[38:39], 0
v_mov_b64 v[40:41], 0
v_mov_b64 v[42:43], 0
v_mov_b64 v[44:45], 0
v_mov_b64 v[46:47], 0
v_mov_b64 v[48:49], 0
v_mov_b64 v[50:51], 0
v_mov_b64 v[52:53], 0
v_mov_b64 v[54:55], 0
v_mov_b64 v[56:57], 0
v_mov_b64 v[58:59], 0
v_mov_b64 v[60:61], 0
v_mov_b64 v[62:63], 0
v_mov_b64 v[64:65], 0
v_mov_b64 v[66:67], 0
v_mov_b64 v[68:69], 0
v_mov_b64 v[70:71], 0
v_mov_b64 v[72:73], 0
v_mov_b64 v[74:75], 0
v_mov_b64 v[76:77], 0
v_mov_b64 v[78:79], 0
v_mov_b64 v[80:81], 0
v_mov_b64 v[82:83], 0
v_mov_b64 v[84:85], 0
v_mov_b64 v[86:87], 0
v_mov_b64 v[88:89], 0
v_mov_b64 v[90:91], 0
v_mov_b64 v[92:93], 0
v_mov_b64 v[94:95], 0
v_mov_b64 v[96:97], 0
v_mov_b64 v[98:99], 0
v_mov_b64 v[100:101], 0
v_mov_b64 v[102:103], 0
v_mov_b64 v[104:105], 0
v_mov_b64 v[106:107], 0
v_mov_b64 v[108:109], 0
v_mov_b64 v[110:111], 0
v_mov_b64 v[112:113], 0
v_mov_b64 v[114:115], 0
v_mov_b64 v[116:117], 0
v_mov_b64 v[118:119], 0
v_mov_b64 v[120:121], 0
v_mov_b64 v[122:123], 0
v_mov_b64 v[124:125], 0
v_mov_b64 v[126:127], 0
v_mov_b64 v[128:129], 0
v_mov_b64 v[130:131], 0
v_mov_b64 v[132:133], 0
v_mov_b64 v[134:135], 0
v_mov_b64 v[136:137], 0
v_mov_b64 v[138:139], 0
v_mov_b64 v[140:141], 0
v_mov_b64 v[142:143], 0
v_mov_b64 v[144:145], 0
v_mov_b64 v[146:147], 0
v_mov_b64 v[148:149], 0
v_mov_b64 v[150:151], 0
v_mov_b64 v[152:153], 0
v_mov_b64 v[154:155], 0
v_mov_b64 v[156:157], 0
v_mov_b64 v[158:159], 0
v_mov_b64 v[160:161], 0
v_mov_b64 v[162:163], 0
v_mov_b64 v[164:165], 0
v_mov_b64 v[166:167], 0
v_mov_b64 v[168:169], 0
v_mov_b64 v[170:171], 0
v_mov_b64 v[172:173], 0
v_mov_b64 v[174:175], 0
v_mov_b64 v[176:177], 0
v_mov_b64 v[178:179], 0
v_mov_b64 v[180:181], 0
v_mov_b64 v[182:183], 0
v_mov_b64 v[184:185], 0
v_mov_b64 v[186:187], 0
v_mov_b64 v[188:189], 0
v_mov_b64 v[190:191], 0
s_lshr_b32 s13, s6, 2
s_lshl_b32 s25, s5, 3
s_add_u32 s25, s25, s13
s_and_b32 s11, s6, 3
s_lshl_b32 s24, s4, 2
s_add_u32 s24, s24, s11
s_mul_i32 s22, s3, 491520
s_add_u32 s22, s22, 16777216
s_mul_i32 s31, s3, 204800
s_add_u32 s31, s31, 18743296
s_mul_i32 s65, s3, 20480
s_add_u32 s65, s65, 81920
s_mul_i32 s11, s11, 3
s_add_u32 s11, s11, 1
s_lshr_b32 s11, s11, 1
s_add_u32 s11, s11, s13
s_mul_i32 s12, s11, 52
s_lshr_b32 s12, s12, 8
s_mul_i32 s12, s12, 5
s_sub_u32 s30, s11, s12
s_mul_i32 s12, s11, 43
s_lshr_b32 s12, s12, 8
s_mul_i32 s12, s12, 6
s_sub_u32 s11, s11, s12
s_and_b32 s12, s11, 6
s_add_u32 s12, s12, s11
s_lshl_b32 s0, s12, 11
s_add_u32 s11, s11, 1
s_cmp_eq_u32 s11, 6
s_cselect_b32 s11, 0, s11
s_and_b32 s12, s11, 6
s_add_u32 s12, s12, s11
s_lshl_b32 s1, s12, 11
s_add_u32 s11, s11, 1
s_cmp_eq_u32 s11, 6
s_cselect_b32 s11, 0, s11
s_and_b32 s12, s11, 6
s_add_u32 s12, s12, s11
s_lshl_b32 s18, s12, 11
s_add_u32 s11, s11, 1
s_cmp_eq_u32 s11, 6
s_cselect_b32 s11, 0, s11
s_and_b32 s12, s11, 6
s_add_u32 s12, s12, s11
s_lshl_b32 s19, s12, 11
s_add_u32 s11, s11, 1
s_cmp_eq_u32 s11, 6
s_cselect_b32 s11, 0, s11
s_and_b32 s12, s11, 6
s_add_u32 s12, s12, s11
s_lshl_b32 s20, s12, 11
s_add_u32 s11, s11, 1
s_cmp_eq_u32 s11, 6
s_cselect_b32 s11, 0, s11
s_and_b32 s12, s11, 6
s_add_u32 s12, s12, s11
s_lshl_b32 s21, s12, 11
s_mul_i32 s23, s24, 5120
v_lshl_add_u32 v22, v1, 4, s23
v_add_u32 v23, 4096, v22
s_lshl_b32 s73, s30, 11
s_add_u32 s74, s73, 2048
s_cmp_eq_u32 s74, 10240
s_cselect_b32 s74, 0, s74
s_add_u32 s75, s74, 2048
s_cmp_eq_u32 s75, 10240
s_cselect_b32 s75, 0, s75
s_add_u32 s76, s75, 2048
s_cmp_eq_u32 s76, 10240
s_cselect_b32 s76, 0, s76
s_add_u32 s77, s76, 2048
s_cmp_eq_u32 s77, 10240
s_cselect_b32 s77, 0, s77
s_lshl_b32 s11, s3, 10
v_lshl_add_u32 v26, v1, 4, s11
s_lshl_b32 s11, s3, 11
v_lshl_add_u32 v27, v1, 4, s11
s_and_b32 s79, s60, 1
s_lshl_b32 s79, s79, 4
v_and_b32 v21, 15, v1
v_mov_b32 v31, s67
v_cmp_eq_u32 vcc, 0, v21
s_nop 1
v_cndmask_b32 v248, 0, v31, vcc
v_accvgpr_write_b32 a120, v248
v_accvgpr_write_b32 a121, v248
v_accvgpr_write_b32 a122, v248
v_accvgpr_write_b32 a123, v248
v_cmp_eq_u32 vcc, 1, v21
s_nop 1
v_cndmask_b32 v248, 0, v31, vcc
v_accvgpr_write_b32 a124, v248
v_accvgpr_write_b32 a125, v248
v_accvgpr_write_b32 a126, v248
v_accvgpr_write_b32 a127, v248
v_cmp_eq_u32 vcc, 2, v21
s_nop 1
v_cndmask_b32 v248, 0, v31, vcc
v_accvgpr_write_b32 a128, v248
v_accvgpr_write_b32 a129, v248
v_accvgpr_write_b32 a130, v248
v_accvgpr_write_b32 a131, v248
v_cmp_eq_u32 vcc, 3, v21
s_nop 1
v_cndmask_b32 v248, 0, v31, vcc
v_accvgpr_write_b32 a132, v248
v_accvgpr_write_b32 a133, v248
v_accvgpr_write_b32 a134, v248
v_accvgpr_write_b32 a135, v248
v_cmp_eq_u32 vcc, 4, v21
s_nop 1
v_cndmask_b32 v248, 0, v31, vcc
v_accvgpr_write_b32 a136, v248
v_accvgpr_write_b32 a137, v248
v_accvgpr_write_b32 a138, v248
v_accvgpr_write_b32 a139, v248
s_lshl_b32 s11, s3, 7
s_add_u32 s11, s11, 0
v_add_u32 v232, s11, v1
v_min_u32 v232, 479, v232
v_mul_u32_u24 v233, 3277, v232
v_lshrrev_b32 v233, 16, v233
v_mul_u32_u24 v234, 20, v233
v_sub_u32 v234, v232, v234
v_cmp_lt_u32 vcc, 19, v233
s_nop 1
v_cndmask_b32 v235, v233, v234, vcc
v_mul_u32_u24 v236, 52, v235
v_lshrrev_b32 v236, 8, v236
v_mad_u32_u24 v234, v236, 20, v234
v_lshl_add_u32 v233, v233, 2, v236
v_cndmask_b32 v233, v234, v233, vcc
v_mul_u32_u24 v233, 208, v233
v_lshl_add_u32 v236, v235, 2, s79
v_lshl_add_u32 v242, v236, 1, v233
v_lshrrev_b32 v236, 2, v235
v_and_b32 v235, 3, v235
v_lshrrev_b32 v237, 4, v234
v_lshl_add_u32 v237, v236, 1, v237
v_and_b32 v234, 15, v234
v_cndmask_b32_e64 v237, v237, 13, vcc
v_cndmask_b32 v234, v234, v236, vcc
v_lshl_add_u32 v234, v235, 4, v234
v_lshlrev_b32 v234, 4, v234
v_lshl_add_u32 v240, v237, 12, v234
s_lshl_b32 s11, s3, 7
s_add_u32 s11, s11, 64
v_add_u32 v232, s11, v1
v_min_u32 v232, 479, v232
v_mul_u32_u24 v233, 3277, v232
v_lshrrev_b32 v233, 16, v233
v_mul_u32_u24 v234, 20, v233
v_sub_u32 v234, v232, v234
v_cmp_lt_u32 vcc, 19, v233
s_nop 1
v_cndmask_b32 v235, v233, v234, vcc
v_mul_u32_u24 v236, 52, v235
v_lshrrev_b32 v236, 8, v236
v_mad_u32_u24 v234, v236, 20, v234
v_lshl_add_u32 v233, v233, 2, v236
v_cndmask_b32 v233, v234, v233, vcc
v_mul_u32_u24 v233, 208, v233
v_lshl_add_u32 v236, v235, 2, s79
v_lshl_add_u32 v243, v236, 1, v233
v_lshrrev_b32 v236, 2, v235
v_and_b32 v235, 3, v235
v_lshrrev_b32 v237, 4, v234
v_lshl_add_u32 v237, v236, 1, v237
v_and_b32 v234, 15, v234
v_cndmask_b32_e64 v237, v237, 13, vcc
v_cndmask_b32 v234, v234, v236, vcc
v_lshl_add_u32 v234, v235, 4, v234
v_lshlrev_b32 v234, 4, v234
v_lshl_add_u32 v241, v237, 12, v234
s_lshl_b32 s11, s5, 1
s_add_u32 s11, s11, s61
s_lshl_b32 s78, s11, 2
s_add_u32 s78, s78, s3
s_mul_i32 s80, s60, 65536
s_add_u32 s80, s80, 19660800
s_mul_i32 s81, s11, 8192
s_add_u32 s81, s81, s80
s_lshl_b32 s11, s11, 7
s_lshl_b32 s82, s60, 12
s_lshl_b32 s12, s3, 10
s_add_u32 s82, s82, s12
s_add_u32 s82, s82, 22675456
s_add_u32 s83, s11, s82
s_lshl_b32 s84, s78, 13
s_add_u32 s84, s84, 22806528
s_mul_i32 s11, s60, 80
s_lshr_b32 s11, s11, 5
s_lshl_b32 s11, s11, 11
s_mul_i32 s12, s78, 81920
s_add_u32 s85, s11, s12
s_add_u32 s85, s85, 2621440
s_mul_i32 s11, s60, 5120
s_add_u32 s98, s11, s12
s_add_u32 s98, s98, 7864320
s_lshl_b32 s99, s78, 10
s_lshl_b32 s12, s60, 7
s_add_u32 s99, s99, s12
s_add_u32 s99, s99, 22708224
s_lshl_b32 s86, s62, 2
s_add_u32 s86, s86, 21299200
s_add_u32 s87, s86, 8192
buffer_load_dwordx4 v8, s[40:43], s70 offen offset:0 lds
buffer_load_dwordx4 v9, s[40:43], s70 offen offset:1024 lds
buffer_load_dwordx4 v10, s[40:43], s70 offen offset:2048 lds
buffer_load_dwordx4 v11, s[40:43], s70 offen offset:3072 lds
s_add_u32 s68, s68, 1
s_cmp_eq_u32 s68, 10
s_cselect_b32 s68, 0, s68
s_add_u32 s93, s93, 1
s_add_u32 s71, s71, 53248
s_cmp_eq_u32 s71, 159744
s_cselect_b32 s71, 0, s71
v_and_b32 v248, 15, v1
v_lshlrev_b32 v248, 3, v248
s_sub_u32 s14, s99, s83
v_mul_lo_u32 v249, v2, s14
v_mov_b64 v[250:251], 0
v_add_u32 v31, v248, v249
s_mul_i32 s69, s68, 245760
s_lshl_b32 s70, s68, 7
s_cmp_ge_u32 s93, 10
s_cselect_b32 s69, 2130706432, s69
s_cselect_b32 s71, 0x30000, s71
s_add_u32 m0, s95, s71
s_nop 0
buffer_load_dwordx4 v12, s[44:47], s69 offen offset:0 lds
buffer_load_dwordx4 v13, s[44:47], s69 offen offset:1024 lds
buffer_load_dwordx4 v14, s[44:47], s69 offen offset:2048 lds
s_waitcnt vmcnt(3)
s_barrier
ds_read_b128 a[0:3], v17 offset:0
ds_read_b128 a[4:7], v17 offset:2048
ds_read_b128 a[8:11], v17 offset:4096
ds_read_b128 a[12:15], v17 offset:6144
ds_read_b64_tr_b16 v[192:193], v19 offset:0
ds_read_b64_tr_b16 v[194:195], v19 offset:1280
ds_read_b64_tr_b16 v[196:197], v20 offset:32
ds_read_b64_tr_b16 v[198:199], v20 offset:1312
ds_read_b64_tr_b16 v[200:201], v19 offset:64
ds_read_b64_tr_b16 v[202:203], v19 offset:1344
ds_read_b64_tr_b16 v[204:205], v20 offset:96
ds_read_b64_tr_b16 v[206:207], v20 offset:1376
ds_read_b64_tr_b16 v[208:209], v19 offset:128
ds_read_b64_tr_b16 v[210:211], v19 offset:1408
buffer_load_dwordx4 v15, s[44:47], s69 offen offset:3072 lds
s_addk_i32 m0, 4096
s_nop 0
buffer_load_dwordx4 v16, s[44:47], s69 offen offset:0 lds
s_add_u32 m0, s96, s71
s_nop 0
buffer_load_dwordx4 v4, s[40:43], s70 offen offset:0 lds
buffer_load_dwordx4 v5, s[40:43], s70 offen offset:1024 lds
buffer_load_dwordx4 v6, s[40:43], s70 offen offset:2048 lds
buffer_load_dwordx4 v7, s[40:43], s70 offen offset:3072 lds
s_addk_i32 m0, 4096
s_nop 0
buffer_load_dwordx4 v8, s[40:43], s70 offen offset:0 lds
s_add_u32 s68, s68, 1
s_cmp_eq_u32 s68, 10
s_cselect_b32 s68, 0, s68
s_add_u32 s93, s93, 1
s_add_u32 s71, s71, 53248
s_cmp_eq_u32 s71, 159744
s_cselect_b32 s71, 0, s71
L_kvloop:
s_waitcnt lgkmcnt(8)
v_mfma_f32_16x16x32_bf16 v[32:35], a[0:3], v[192:195], v[32:35]
ds_read_b64_tr_b16 v[212:213], v20 offset:160
s_add_u32 s97, s97, 1
v_mfma_f32_16x16x32_bf16 v[36:39], a[4:7], v[192:195], v[36:39]
ds_read_b64_tr_b16 v[214:215], v20 offset:1440
v_mfma_f32_16x16x32_bf16 v[40:43], a[8:11], v[192:195], v[40:43]
ds_read_b64_tr_b16 v[216:217], v19 offset:192
v_mfma_f32_16x16x32_bf16 v[44:47], a[12:15], v[192:195], v[44:47]
ds_read_b64_tr_b16 v[218:219], v19 offset:1472
s_waitcnt lgkmcnt(10)
v_mfma_f32_16x16x32_bf16 v[48:51], a[0:3], v[196:199], v[48:51]
buffer_load_dwordx4 v9, s[40:43], s70 offen offset:1024 lds
v_mfma_f32_16x16x32_bf16 v[52:55], a[4:7], v[196:199], v[52:55]
ds_read_b64_tr_b16 v[220:221], v20 offset:224
v_mfma_f32_16x16x32_bf16 v[56:59], a[8:11], v[196:199], v[56:59]
ds_read_b64_tr_b16 v[222:223], v20 offset:1504
v_mfma_f32_16x16x32_bf16 v[60:63], a[12:15], v[196:199], v[60:63]
ds_read_b64_tr_b16 v[224:225], v19 offset:256
s_waitcnt lgkmcnt(11)
v_mfma_f32_16x16x32_bf16 v[64:67], a[0:3], v[200:203], v[64:67]
ds_read_b64_tr_b16 v[226:227], v19 offset:1536
v_mfma_f32_16x16x32_bf16 v[68:71], a[4:7], v[200:203], v[68:71]
ds_read_b64_tr_b16 v[228:229], v20 offset:288
v_mfma_f32_16x16x32_bf16 v[72:75], a[8:11], v[200:203], v[72:75]
buffer_load_dwordx4 v10, s[40:43], s70 offen offset:2048 lds
v_mfma_f32_16x16x32_bf16 v[76:79], a[12:15], v[200:203], v[76:79]
ds_read_b64_tr_b16 v[230:231], v20 offset:1568
s_waitcnt lgkmcnt(12)
v_mfma_f32_16x16x32_bf16 v[80:83], a[0:3], v[204:207], v[80:83]
ds_read_b64_tr_b16 a[80:81], v24 offset:0
v_mfma_f32_16x16x32_bf16 v[84:87], a[4:7], v[204:207], v[84:87]
ds_read_b64_tr_b16 a[82:83], v24 offset:1280
v_mfma_f32_16x16x32_bf16 v[88:91], a[8:11], v[204:207], v[88:91]
ds_read_b64_tr_b16 a[84:85], v25 offset:32
v_mfma_f32_16x16x32_bf16 v[92:95], a[12:15], v[204:207], v[92:95]
s_waitcnt lgkmcnt(13)
v_mfma_f32_16x16x32_bf16 v[96:99], a[0:3], v[208:211], v[96:99]
ds_read_b64_tr_b16 a[86:87], v25 offset:1312
v_mfma_f32_16x16x32_bf16 v[100:103], a[4:7], v[208:211], v[100:103]
buffer_load_dwordx4 v11, s[40:43], s70 offen offset:3072 lds
v_mfma_f32_16x16x32_bf16 v[104:107], a[8:11], v[208:211], v[104:107]
s_cmp_eq_u32 s97, 3
s_cselect_b32 s94, -2, 1
v_mfma_f32_16x16x32_bf16 v[108:111], a[12:15], v[208:211], v[108:111]
s_mul_i32 s94, s94, 53248
s_cmp_eq_u32 s97, 3
s_cselect_b32 s97, 0, s97
s_waitcnt lgkmcnt(12)
v_mfma_f32_16x16x32_bf16 v[112:115], a[0:3], v[212:215], v[112:115]
ds_read_b128 a[16:19], v18 offset:0
s_mul_i32 s69, s68, 245760
v_mfma_f32_16x16x32_bf16 v[116:119], a[4:7], v[212:215], v[116:119]
ds_read_b128 a[20:23], v18 offset:2048
s_add_u32 m0, s95, s71
v_mfma_f32_16x16x32_bf16 v[120:123], a[8:11], v[212:215], v[120:123]
ds_read_b128 a[24:27], v18 offset:4096
s_lshl_b32 s70, s68, 7
v_mfma_f32_16x16x32_bf16 v[124:127], a[12:15], v[212:215], v[124:127]
ds_read_b128 a[28:31], v18 offset:6144
s_waitcnt lgkmcnt(14)
v_mfma_f32_16x16x32_bf16 v[128:131], a[0:3], v[216:219], v[128:131]
buffer_load_dwordx4 v12, s[44:47], s69 offen offset:0 lds
v_mfma_f32_16x16x32_bf16 v[132:135], a[4:7], v[216:219], v[132:135]
ds_read_b64_tr_b16 v[192:193], v19 offset:10240
v_mfma_f32_16x16x32_bf16 v[136:139], a[8:11], v[216:219], v[136:139]
ds_read_b64_tr_b16 v[194:195], v19 offset:11520
v_mfma_f32_16x16x32_bf16 v[140:143], a[12:15], v[216:219], v[140:143]
ds_read_b64_tr_b16 v[196:197], v20 offset:10272
s_waitcnt lgkmcnt(15)
v_mfma_f32_16x16x32_bf16 v[144:147], a[0:3], v[220:223], v[144:147]
ds_read_b64_tr_b16 v[198:199], v20 offset:11552
v_mfma_f32_16x16x32_bf16 v[148:151], a[4:7], v[220:223], v[148:151]
ds_read_b64_tr_b16 v[200:201], v19 offset:10304
v_mfma_f32_16x16x32_bf16 v[152:155], a[8:11], v[220:223], v[152:155]
buffer_load_dwordx4 v13, s[44:47], s69 offen offset:1024 lds
v_mfma_f32_16x16x32_bf16 v[156:159], a[12:15], v[220:223], v[156:159]
ds_read_b64_tr_b16 v[202:203], v19 offset:11584
s_waitcnt lgkmcnt(15)
v_mfma_f32_16x16x32_bf16 v[160:163], a[0:3], v[224:227], v[160:163]
ds_read_b64_tr_b16 v[204:205], v20 offset:10336
v_mfma_f32_16x16x32_bf16 v[164:167], a[4:7], v[224:227], v[164:167]
ds_read_b64_tr_b16 v[206:207], v20 offset:11616
v_mfma_f32_16x16x32_bf16 v[168:171], a[8:11], v[224:227], v[168:171]
ds_read_b64_tr_b16 v[208:209], v19 offset:10368
v_mfma_f32_16x16x32_bf16 v[172:175], a[12:15], v[224:227], v[172:175]
ds_read_b64_tr_b16 v[210:211], v19 offset:11648
s_waitcnt lgkmcnt(15)
v_mfma_f32_16x16x32_bf16 v[176:179], a[0:3], v[228:231], v[176:179]
ds_read_b64_tr_b16 a[88:89], v24 offset:64
v_mfma_f32_16x16x32_bf16 v[180:183], a[4:7], v[228:231], v[180:183]
buffer_load_dwordx4 v14, s[44:47], s69 offen offset:2048 lds
v_mfma_f32_16x16x32_bf16 v[184:187], a[8:11], v[228:231], v[184:187]
ds_read_b64_tr_b16 a[90:91], v24 offset:1344
v_mfma_f32_16x16x32_bf16 v[188:191], a[12:15], v[228:231], v[188:191]
ds_read_b64_tr_b16 a[92:93], v25 offset:96
s_waitcnt lgkmcnt(11)
v_mfma_f32_16x16x32_bf16 v[32:35], a[16:19], v[192:195], v[32:35]
ds_read_b64_tr_b16 a[94:95], v25 offset:1376
s_add_u32 s68, s68, 1
v_mfma_f32_16x16x32_bf16 v[36:39], a[20:23], v[192:195], v[36:39]
ds_read_b64_tr_b16 a[96:97], v24 offset:128
s_add_u32 s93, s93, 1
v_mfma_f32_16x16x32_bf16 v[40:43], a[24:27], v[192:195], v[40:43]
ds_read_b64_tr_b16 a[98:99], v24 offset:1408
v_mfma_f32_16x16x32_bf16 v[44:47], a[28:31], v[192:195], v[44:47]
ds_read_b64_tr_b16 v[212:213], v20 offset:10400
s_waitcnt lgkmcnt(13)
v_mfma_f32_16x16x32_bf16 v[48:51], a[16:19], v[196:199], v[48:51]
buffer_load_dwordx4 v15, s[44:47], s69 offen offset:3072 lds
s_addk_i32 m0, 4096
v_mfma_f32_16x16x32_bf16 v[52:55], a[20:23], v[196:199], v[52:55]
ds_read_b64_tr_b16 v[214:215], v20 offset:11680
v_mfma_f32_16x16x32_bf16 v[56:59], a[24:27], v[196:199], v[56:59]
ds_read_b64_tr_b16 v[216:217], v19 offset:10432
v_mfma_f32_16x16x32_bf16 v[60:63], a[28:31], v[196:199], v[60:63]
ds_read_b64_tr_b16 v[218:219], v19 offset:11712
s_waitcnt lgkmcnt(14)
v_mfma_f32_16x16x32_bf16 v[64:67], a[16:19], v[200:203], v[64:67]
buffer_load_dwordx4 v16, s[44:47], s69 offen offset:0 lds
s_add_u32 m0, s96, s71
v_mfma_f32_16x16x32_bf16 v[68:71], a[20:23], v[200:203], v[68:71]
ds_read_b64_tr_b16 v[220:221], v20 offset:10464
v_mfma_f32_16x16x32_bf16 v[72:75], a[24:27], v[200:203], v[72:75]
ds_read_b64_tr_b16 v[222:223], v20 offset:11744
v_mfma_f32_16x16x32_bf16 v[76:79], a[28:31], v[200:203], v[76:79]
ds_read_b64_tr_b16 v[224:225], v19 offset:10496
s_waitcnt lgkmcnt(15)
v_mfma_f32_16x16x32_bf16 v[80:83], a[16:19], v[204:207], v[80:83]
ds_read_b64_tr_b16 v[226:227], v19 offset:11776
v_mfma_f32_16x16x32_bf16 v[84:87], a[20:23], v[204:207], v[84:87]
buffer_load_dwordx4 v4, s[40:43], s70 offen offset:0 lds
v_mfma_f32_16x16x32_bf16 v[88:91], a[24:27], v[204:207], v[88:91]
ds_read_b64_tr_b16 v[228:229], v20 offset:10528
v_mfma_f32_16x16x32_bf16 v[92:95], a[28:31], v[204:207], v[92:95]
ds_read_b64_tr_b16 v[230:231], v20 offset:11808
s_waitcnt lgkmcnt(15)
v_mfma_f32_16x16x32_bf16 v[96:99], a[16:19], v[208:211], v[96:99]
s_cmp_eq_u32 s68, 10
s_cselect_b32 s68, 0, s68
v_mfma_f32_16x16x32_bf16 v[100:103], a[20:23], v[208:211], v[100:103]
v_mfma_f32_16x16x32_bf16 v[104:107], a[24:27], v[208:211], v[104:107]
buffer_load_dwordx4 v5, s[40:43], s70 offen offset:1024 lds
v_mfma_f32_16x16x32_bf16 v[108:111], a[28:31], v[208:211], v[108:111]
s_waitcnt lgkmcnt(10)
v_mfma_f32_16x16x32_bf16 a[100:103], a[32:35], a[80:83], a[100:103]
v_add_u32 v17, s94, v17
v_add_u32 v19, s94, v19
v_mfma_f32_16x16x32_bf16 a[104:107], a[32:35], a[84:87], a[104:107]
v_add_u32 v20, s94, v20
v_add_u32 v18, s94, v18
v_mfma_f32_16x16x32_bf16 a[108:111], a[32:35], a[88:91], a[108:111]
s_add_u32 s71, s71, 53248
v_mfma_f32_16x16x32_bf16 a[112:115], a[32:35], a[92:95], a[112:115]
s_cmp_eq_u32 s71, 159744
s_cselect_b32 s71, 0, s71
v_mfma_f32_16x16x32_bf16 a[116:119], a[32:35], a[96:99], a[116:119]
s_waitcnt vmcnt(7) lgkmcnt(0)
s_barrier
v_mfma_f32_16x16x32_bf16 v[112:115], a[16:19], v[212:215], v[112:115]
ds_read_b128 a[0:3], v17 offset:0
v_add_u32 v24, s94, v24
v_mfma_f32_16x16x32_bf16 v[116:119], a[20:23], v[212:215], v[116:119]
ds_read_b128 a[4:7], v17 offset:2048
v_add_u32 v25, s94, v25
v_mfma_f32_16x16x32_bf16 v[120:123], a[24:27], v[212:215], v[120:123]
ds_read_b128 a[8:11], v17 offset:4096
v_mfma_f32_16x16x32_bf16 v[124:127], a[28:31], v[212:215], v[124:127]
ds_read_b128 a[12:15], v17 offset:6144
v_mfma_f32_16x16x32_bf16 v[128:131], a[16:19], v[216:219], v[128:131]
buffer_load_dwordx4 v6, s[40:43], s70 offen offset:2048 lds
v_mfma_f32_16x16x32_bf16 v[132:135], a[20:23], v[216:219], v[132:135]
ds_read_b64_tr_b16 v[192:193], v19 offset:0
v_mfma_f32_16x16x32_bf16 v[136:139], a[24:27], v[216:219], v[136:139]
ds_read_b64_tr_b16 v[194:195], v19 offset:1280
v_mfma_f32_16x16x32_bf16 v[140:143], a[28:31], v[216:219], v[140:143]
ds_read_b64_tr_b16 v[196:197], v20 offset:32
v_mfma_f32_16x16x32_bf16 v[144:147], a[16:19], v[220:223], v[144:147]
ds_read_b64_tr_b16 v[198:199], v20 offset:1312
v_mfma_f32_16x16x32_bf16 v[148:151], a[20:23], v[220:223], v[148:151]
ds_read_b64_tr_b16 v[200:201], v19 offset:64
v_mfma_f32_16x16x32_bf16 v[152:155], a[24:27], v[220:223], v[152:155]
buffer_load_dwordx4 v7, s[40:43], s70 offen offset:3072 lds
s_addk_i32 m0, 4096
v_mfma_f32_16x16x32_bf16 v[156:159], a[28:31], v[220:223], v[156:159]
ds_read_b64_tr_b16 v[202:203], v19 offset:1344
v_mfma_f32_16x16x32_bf16 v[160:163], a[16:19], v[224:227], v[160:163]
ds_read_b64_tr_b16 v[204:205], v20 offset:96
v_mfma_f32_16x16x32_bf16 v[164:167], a[20:23], v[224:227], v[164:167]
ds_read_b64_tr_b16 v[206:207], v20 offset:1376
v_mfma_f32_16x16x32_bf16 v[168:171], a[24:27], v[224:227], v[168:171]
ds_read_b64_tr_b16 v[208:209], v19 offset:128
v_mfma_f32_16x16x32_bf16 v[172:175], a[28:31], v[224:227], v[172:175]
ds_read_b64_tr_b16 v[210:211], v19 offset:1408
v_mfma_f32_16x16x32_bf16 v[176:179], a[16:19], v[228:231], v[176:179]
v_mfma_f32_16x16x32_bf16 v[180:183], a[20:23], v[228:231], v[180:183]
buffer_load_dwordx4 v8, s[40:43], s70 offen offset:0 lds
v_mfma_f32_16x16x32_bf16 v[184:187], a[24:27], v[228:231], v[184:187]
v_mfma_f32_16x16x32_bf16 v[188:191], a[28:31], v[228:231], v[188:191]
s_cmp_lt_u32 s93, 10
s_cbranch_scc1 L_kvloop
s_waitcnt lgkmcnt(8)
v_mfma_f32_16x16x32_bf16 v[32:35], a[0:3], v[192:195], v[32:35]
ds_read_b64_tr_b16 v[212:213], v20 offset:160
ds_read_b64_tr_b16 a[90:91], v24 offset:1344
v_mfma_f32_16x16x32_bf16 v[36:39], a[4:7], v[192:195], v[36:39]
ds_read_b64_tr_b16 v[214:215], v20 offset:1440
ds_read_b64_tr_b16 a[92:93], v25 offset:96
v_mfma_f32_16x16x32_bf16 v[40:43], a[8:11], v[192:195], v[40:43]
buffer_load_dwordx4 v9, s[40:43], s70 offen offset:1024 lds
v_mfma_f32_16x16x32_bf16 v[44:47], a[12:15], v[192:195], v[44:47]
ds_read_b64_tr_b16 v[216:217], v19 offset:192
s_waitcnt lgkmcnt(11)
v_mfma_f32_16x16x32_bf16 v[48:51], a[0:3], v[196:199], v[48:51]
ds_read_b64_tr_b16 v[218:219], v19 offset:1472
ds_read_b64_tr_b16 a[94:95], v25 offset:1376
v_mfma_f32_16x16x32_bf16 v[52:55], a[4:7], v[196:199], v[52:55]
ds_read_b64_tr_b16 v[220:221], v20 offset:224
ds_read_b64_tr_b16 a[96:97], v24 offset:128
v_mfma_f32_16x16x32_bf16 v[56:59], a[8:11], v[196:199], v[56:59]
buffer_load_dwordx4 v10, s[40:43], s70 offen offset:2048 lds
v_mfma_f32_16x16x32_bf16 v[60:63], a[12:15], v[196:199], v[60:63]
ds_read_b64_tr_b16 v[222:223], v20 offset:1504
s_waitcnt lgkmcnt(14)
v_mfma_f32_16x16x32_bf16 v[64:67], a[0:3], v[200:203], v[64:67]
ds_read_b64_tr_b16 v[224:225], v19 offset:256
ds_read_b64_tr_b16 a[98:99], v24 offset:1408
v_mfma_f32_16x16x32_bf16 v[68:71], a[4:7], v[200:203], v[68:71]
ds_read_b64_tr_b16 v[226:227], v19 offset:1536
v_and_b32 v248, 1, v1
v_mfma_f32_16x16x32_bf16 v[72:75], a[8:11], v[200:203], v[72:75]
buffer_load_dwordx4 v11, s[40:43], s70 offen offset:3072 lds
v_mfma_f32_16x16x32_bf16 v[76:79], a[12:15], v[200:203], v[76:79]
ds_read_b64_tr_b16 v[228:229], v20 offset:288
s_waitcnt lgkmcnt(15)
v_mfma_f32_16x16x32_bf16 v[80:83], a[0:3], v[204:207], v[80:83]
ds_read_b64_tr_b16 v[230:231], v20 offset:1568
s_lshr_b32 s11, s62, 5
v_mfma_f32_16x16x32_bf16 v[84:87], a[4:7], v[204:207], v[84:87]
ds_read_b64_tr_b16 a[80:81], v24 offset:0
v_add_u32 v248, s11, v248
v_mfma_f32_16x16x32_bf16 v[88:91], a[8:11], v[204:207], v[88:91]
buffer_store_dwordx2 v[250:251], v31, s[48:51], s83 offen sc1
v_mfma_f32_16x16x32_bf16 v[92:95], a[12:15], v[204:207], v[92:95]
ds_read_b64_tr_b16 a[86:87], v25 offset:1312
s_waitcnt lgkmcnt(15)
v_mfma_f32_16x16x32_bf16 v[96:99], a[0:3], v[208:211], v[96:99]
ds_read_b64_tr_b16 a[82:83], v24 offset:1280
v_lshlrev_b32 v248, 12, v248
v_mfma_f32_16x16x32_bf16 v[100:103], a[4:7], v[208:211], v[100:103]
ds_read_b64_tr_b16 a[84:85], v25 offset:32
v_lshlrev_b32 v249, 7, v3
v_mfma_f32_16x16x32_bf16 v[104:107], a[8:11], v[208:211], v[104:107]
v_lshlrev_b32 v254, 3, v1
buffer_load_dwordx2 v[252:253], off, s[56:59], 0 sc1
v_mfma_f32_16x16x32_bf16 v[108:111], a[12:15], v[208:211], v[108:111]
ds_read_b64_tr_b16 a[88:89], v24 offset:64
v_add_u32 v249, 589824, v249
s_mov_b32 vcc_lo, 0
s_mov_b32 vcc_hi, -1
v_cndmask_b32 v28, v248, v249, vcc
s_mov_b32 s15, 22151168
s_waitcnt lgkmcnt(15)
v_mfma_f32_16x16x32_bf16 v[112:115], a[0:3], v[212:215], v[112:115]
ds_read_b128 a[16:19], v18 offset:0
v_lshlrev_b32 v29, 2, v21
v_mfma_f32_16x16x32_bf16 v[116:119], a[4:7], v[212:215], v[116:119]
ds_read_b128 a[20:23], v18 offset:2048
v_and_b32 v30, 48, v1
v_mfma_f32_16x16x32_bf16 v[120:123], a[8:11], v[212:215], v[120:123]
ds_read_b128 a[24:27], v18 offset:4096
s_lshr_b32 s11, s3, 1
v_mfma_f32_16x16x32_bf16 v[124:127], a[12:15], v[212:215], v[124:127]
ds_read_b128 a[28:31], v18 offset:6144
s_waitcnt lgkmcnt(15)
v_mfma_f32_16x16x32_bf16 v[128:131], a[0:3], v[216:219], v[128:131]
ds_read_b64_tr_b16 v[192:193], v19 offset:10240
s_mul_i32 s11, s11, 640
v_mfma_f32_16x16x32_bf16 v[132:135], a[4:7], v[216:219], v[132:135]
ds_read_b64_tr_b16 v[194:195], v19 offset:11520
s_and_b32 s12, s3, 1
v_mfma_f32_16x16x32_bf16 v[136:139], a[8:11], v[216:219], v[136:139]
ds_read_b64_tr_b16 v[196:197], v20 offset:10272
s_lshl_b32 s12, s12, 6
v_mfma_f32_16x16x32_bf16 v[140:143], a[12:15], v[216:219], v[140:143]
ds_read_b64_tr_b16 v[198:199], v20 offset:11552
s_waitcnt lgkmcnt(15)
v_mfma_f32_16x16x32_bf16 v[144:147], a[0:3], v[220:223], v[144:147]
ds_read_b64_tr_b16 v[200:201], v19 offset:10304
s_add_u32 s11, s11, s12
v_mfma_f32_16x16x32_bf16 v[148:151], a[4:7], v[220:223], v[148:151]
ds_read_b64_tr_b16 v[202:203], v19 offset:11584
s_add_u32 s11, s11, 77824
v_mfma_f32_16x16x32_bf16 v[152:155], a[8:11], v[220:223], v[152:155]
ds_read_b64_tr_b16 v[204:205], v20 offset:10336
v_add_u32 v4, s11, v29
v_mfma_f32_16x16x32_bf16 v[156:159], a[12:15], v[220:223], v[156:159]
ds_read_b64_tr_b16 v[206:207], v20 offset:11616
s_waitcnt lgkmcnt(15)
v_mfma_f32_16x16x32_bf16 v[160:163], a[0:3], v[224:227], v[160:163]
buffer_load_dwordx2 v[6:7], v28, s[48:51], s15 offen sc1
v_mfma_f32_16x16x32_bf16 v[164:167], a[4:7], v[224:227], v[164:167]
ds_read_b64_tr_b16 v[208:209], v19 offset:10368
v_lshlrev_b32 v5, 2, v3
v_mfma_f32_16x16x32_bf16 v[168:171], a[8:11], v[224:227], v[168:171]
ds_read_b64_tr_b16 v[210:211], v19 offset:11648
v_add_u32 v5, 77824, v5
v_mfma_f32_16x16x32_bf16 v[172:175], a[12:15], v[224:227], v[172:175]
v_add_u32 v12, 57344, v26
s_waitcnt lgkmcnt(15)
v_mfma_f32_16x16x32_bf16 v[176:179], a[0:3], v[228:231], v[176:179]
v_mov_b64 v[8:9], 0
v_mov_b64 v[10:11], 0
v_mfma_f32_16x16x32_bf16 v[180:183], a[4:7], v[228:231], v[180:183]
v_mfma_f32_16x16x32_bf16 v[184:187], a[8:11], v[228:231], v[184:187]
v_mfma_f32_16x16x32_bf16 v[188:191], a[12:15], v[228:231], v[188:191]
s_waitcnt lgkmcnt(8)
v_mfma_f32_16x16x32_bf16 v[32:35], a[16:19], v[192:195], v[32:35]
ds_read_b64_tr_b16 v[212:213], v20 offset:10400
s_add_u32 s97, s97, 1
v_mfma_f32_16x16x32_bf16 v[36:39], a[20:23], v[192:195], v[36:39]
ds_read_b64_tr_b16 v[214:215], v20 offset:11680
v_mfma_f32_16x16x32_bf16 v[40:43], a[24:27], v[192:195], v[40:43]
ds_write_b128 v12, v[8:11] offset:0
v_mfma_f32_16x16x32_bf16 v[44:47], a[28:31], v[192:195], v[44:47]
ds_read_b64_tr_b16 v[216:217], v19 offset:10432
s_waitcnt lgkmcnt(10)
v_mfma_f32_16x16x32_bf16 v[48:51], a[16:19], v[196:199], v[48:51]
ds_read_b64_tr_b16 v[218:219], v19 offset:11712
v_mfma_f32_16x16x32_bf16 v[52:55], a[20:23], v[196:199], v[52:55]
ds_read_b64_tr_b16 v[220:221], v20 offset:10464
v_mfma_f32_16x16x32_bf16 v[56:59], a[24:27], v[196:199], v[56:59]
ds_write_b128 v12, v[8:11] offset:4096
v_mfma_f32_16x16x32_bf16 v[60:63], a[28:31], v[196:199], v[60:63]
ds_read_b64_tr_b16 v[222:223], v20 offset:11744
s_waitcnt lgkmcnt(12)
v_mfma_f32_16x16x32_bf16 v[64:67], a[16:19], v[200:203], v[64:67]
ds_read_b64_tr_b16 v[224:225], v19 offset:10496
v_mfma_f32_16x16x32_bf16 v[68:71], a[20:23], v[200:203], v[68:71]
ds_read_b64_tr_b16 v[226:227], v19 offset:11776
v_mfma_f32_16x16x32_bf16 v[72:75], a[24:27], v[200:203], v[72:75]
ds_write_b128 v12, v[8:11] offset:8192
v_mfma_f32_16x16x32_bf16 v[76:79], a[28:31], v[200:203], v[76:79]
ds_read_b64_tr_b16 v[228:229], v20 offset:10528
s_waitcnt lgkmcnt(14)
v_mfma_f32_16x16x32_bf16 v[80:83], a[16:19], v[204:207], v[80:83]
ds_read_b64_tr_b16 v[230:231], v20 offset:11808
v_mfma_f32_16x16x32_bf16 v[84:87], a[20:23], v[204:207], v[84:87]
s_cmp_eq_u32 s97, 3
s_cselect_b32 s94, -2, 1
v_mfma_f32_16x16x32_bf16 v[88:91], a[24:27], v[204:207], v[88:91]
ds_write_b128 v12, v[8:11] offset:12288
v_mfma_f32_16x16x32_bf16 v[92:95], a[28:31], v[204:207], v[92:95]
s_mul_i32 s94, s94, 53248
s_waitcnt lgkmcnt(14)
v_mfma_f32_16x16x32_bf16 v[96:99], a[16:19], v[208:211], v[96:99]
s_cmp_eq_u32 s97, 3
s_cselect_b32 s97, 0, s97
v_mfma_f32_16x16x32_bf16 v[100:103], a[20:23], v[208:211], v[100:103]
v_mfma_f32_16x16x32_bf16 v[104:107], a[24:27], v[208:211], v[104:107]
ds_write_b128 v12, v[8:11] offset:16384
v_mfma_f32_16x16x32_bf16 v[108:111], a[28:31], v[208:211], v[108:111]
v_mfma_f32_16x16x32_bf16 a[100:103], a[32:35], a[80:83], a[100:103]
v_add_u32 v17, s94, v17
v_add_u32 v19, s94, v19
v_mfma_f32_16x16x32_bf16 a[104:107], a[32:35], a[84:87], a[104:107]
v_add_u32 v20, s94, v20
v_add_u32 v18, s94, v18
v_mfma_f32_16x16x32_bf16 a[108:111], a[32:35], a[88:91], a[108:111]
v_mfma_f32_16x16x32_bf16 a[112:115], a[32:35], a[92:95], a[112:115]
v_mfma_f32_16x16x32_bf16 a[116:119], a[32:35], a[96:99], a[116:119]
s_waitcnt vmcnt(0) lgkmcnt(0)
s_barrier
s_mov_b32 s10, 0x20000
L_nonce9:
v_readfirstlane_b32 s8, v252
v_readfirstlane_b32 s9, v253
s_nop 0
s_cmp_lg_u32 s8, 0
s_cbranch_scc1 L_nonce9x
buffer_load_dwordx2 v[252:253], off, s[56:59], 0 sc1
s_sub_u32 s10, s10, 1
s_waitcnt vmcnt(0)
s_cbranch_scc0 L_nonce9
L_nonce9x:
v_cmp_ne_u64 vcc, s[8:9], v[6:7]
s_cbranch_vccz L_chk10x
s_mov_b32 s10, 0x20000
L_chk10:
buffer_load_dwordx2 v[6:7], v28, s[48:51], s15 offen sc1
s_sub_u32 s10, s10, 1
s_waitcnt vmcnt(0)
s_cbranch_scc1 L_chk10x
v_cmp_ne_u64 vcc, s[8:9], v[6:7]
s_cbranch_vccnz L_chk10
L_chk10x:
v_mfma_f32_16x16x32_bf16 v[112:115], a[16:19], v[212:215], v[112:115]
ds_read_b128 a[0:3], v17 offset:0
v_add_u32 v24, s94, v24
v_mfma_f32_16x16x32_bf16 v[116:119], a[20:23], v[212:215], v[116:119]
ds_read_b128 a[4:7], v17 offset:2048
v_add_u32 v25, s94, v25
v_mfma_f32_16x16x32_bf16 v[120:123], a[24:27], v[212:215], v[120:123]
buffer_load_dword v8, v29, s[48:51], s86 offen offset:0 sc1
v_mfma_f32_16x16x32_bf16 v[124:127], a[28:31], v[212:215], v[124:127]
ds_read_b128 a[8:11], v17 offset:4096
v_mfma_f32_16x16x32_bf16 v[128:131], a[16:19], v[216:219], v[128:131]
ds_read_b128 a[12:15], v17 offset:6144
v_mfma_f32_16x16x32_bf16 v[132:135], a[20:23], v[216:219], v[132:135]
buffer_load_dword v9, v29, s[48:51], s86 offen offset:64 sc1
v_mfma_f32_16x16x32_bf16 v[136:139], a[24:27], v[216:219], v[136:139]
ds_read_b64_tr_b16 v[192:193], v19 offset:0
v_mfma_f32_16x16x32_bf16 v[140:143], a[28:31], v[216:219], v[140:143]
ds_read_b64_tr_b16 v[194:195], v19 offset:1280
v_mfma_f32_16x16x32_bf16 v[144:147], a[16:19], v[220:223], v[144:147]
buffer_load_dword v10, v29, s[48:51], s86 offen offset:128 sc1
v_mfma_f32_16x16x32_bf16 v[148:151], a[20:23], v[220:223], v[148:151]
ds_read_b64_tr_b16 v[196:197], v20 offset:32
v_mfma_f32_16x16x32_bf16 v[152:155], a[24:27], v[220:223], v[152:155]
ds_read_b64_tr_b16 v[198:199], v20 offset:1312
v_mfma_f32_16x16x32_bf16 v[156:159], a[28:31], v[220:223], v[156:159]
ds_read_b64_tr_b16 v[200:201], v19 offset:64
v_mfma_f32_16x16x32_bf16 v[160:163], a[16:19], v[224:227], v[160:163]
buffer_load_dword v11, v29, s[48:51], s86 offen offset:192 sc1
v_mfma_f32_16x16x32_bf16 v[164:167], a[20:23], v[224:227], v[164:167]
ds_read_b64_tr_b16 v[202:203], v19 offset:1344
v_mfma_f32_16x16x32_bf16 v[168:171], a[24:27], v[224:227], v[168:171]
ds_read_b64_tr_b16 v[204:205], v20 offset:96
v_mfma_f32_16x16x32_bf16 v[172:175], a[28:31], v[224:227], v[172:175]
ds_read_b64_tr_b16 v[206:207], v20 offset:1376
v_mfma_f32_16x16x32_bf16 v[176:179], a[16:19], v[228:231], v[176:179]
s_mul_i32 s23, s0, 20
s_add_u32 s23, s23, s22
buffer_load_dwordx4 a[160:163], v22, s[48:51], s23 offen offset:0 sc1
v_mfma_f32_16x16x32_bf16 v[180:183], a[20:23], v[228:231], v[180:183]
ds_read_b64_tr_b16 v[208:209], v19 offset:128
v_mfma_f32_16x16x32_bf16 v[184:187], a[24:27], v[228:231], v[184:187]
buffer_load_dwordx4 a[164:167], v22, s[48:51], s23 offen offset:1024 sc1
v_mfma_f32_16x16x32_bf16 v[188:191], a[28:31], v[228:231], v[188:191]
ds_read_b64_tr_b16 v[210:211], v19 offset:1408
s_waitcnt lgkmcnt(8)
v_mfma_f32_16x16x32_bf16 v[32:35], a[0:3], v[192:195], v[32:35]
ds_read_b64_tr_b16 v[212:213], v20 offset:160
ds_read_b64_tr_b16 a[90:91], v24 offset:1344
v_mfma_f32_16x16x32_bf16 v[36:39], a[4:7], v[192:195], v[36:39]
ds_read_b64_tr_b16 v[214:215], v20 offset:1440
ds_read_b64_tr_b16 a[92:93], v25 offset:96
v_mfma_f32_16x16x32_bf16 v[40:43], a[8:11], v[192:195], v[40:43]
buffer_load_dwordx4 a[44:47], v30, s[48:51], s87 offen offset:0 sc1
buffer_load_dwordx4 a[48:51], v30, s[48:51], s87 offen offset:64 sc1
v_mfma_f32_16x16x32_bf16 v[44:47], a[12:15], v[192:195], v[44:47]
ds_read_b64_tr_b16 v[216:217], v19 offset:192
s_waitcnt lgkmcnt(11)
v_mfma_f32_16x16x32_bf16 v[48:51], a[0:3], v[196:199], v[48:51]
ds_read_b64_tr_b16 v[218:219], v19 offset:1472
ds_read_b64_tr_b16 a[94:95], v25 offset:1376
v_mfma_f32_16x16x32_bf16 v[52:55], a[4:7], v[196:199], v[52:55]
ds_read_b64_tr_b16 v[220:221], v20 offset:224
ds_read_b64_tr_b16 a[96:97], v24 offset:128
v_mfma_f32_16x16x32_bf16 v[56:59], a[8:11], v[196:199], v[56:59]
buffer_load_dwordx4 a[52:55], v30, s[48:51], s87 offen offset:128 sc1
buffer_load_dwordx4 a[56:59], v30, s[48:51], s87 offen offset:192 sc1
v_mfma_f32_16x16x32_bf16 v[60:63], a[12:15], v[196:199], v[60:63]
ds_read_b64_tr_b16 v[222:223], v20 offset:1504
s_waitcnt lgkmcnt(14)
v_mfma_f32_16x16x32_bf16 v[64:67], a[0:3], v[200:203], v[64:67]
ds_read_b64_tr_b16 v[224:225], v19 offset:256
ds_read_b64_tr_b16 a[98:99], v24 offset:1408
v_mfma_f32_16x16x32_bf16 v[68:71], a[4:7], v[200:203], v[68:71]
ds_read_b64_tr_b16 v[226:227], v19 offset:1536
v_mfma_f32_16x16x32_bf16 v[72:75], a[8:11], v[200:203], v[72:75]
buffer_load_dwordx4 a[168:171], v22, s[48:51], s23 offen offset:2048 sc1
v_mfma_f32_16x16x32_bf16 v[76:79], a[12:15], v[200:203], v[76:79]
ds_read_b64_tr_b16 v[228:229], v20 offset:288
s_waitcnt lgkmcnt(15)
v_mfma_f32_16x16x32_bf16 v[80:83], a[0:3], v[204:207], v[80:83]
ds_read_b64_tr_b16 v[230:231], v20 offset:1568
v_mfma_f32_16x16x32_bf16 v[84:87], a[4:7], v[204:207], v[84:87]
ds_read_b64_tr_b16 a[80:81], v24 offset:0
v_mfma_f32_16x16x32_bf16 v[88:91], a[8:11], v[204:207], v[88:91]
buffer_load_dwordx4 a[172:175], v22, s[48:51], s23 offen offset:3072 sc1
v_mfma_f32_16x16x32_bf16 v[92:95], a[12:15], v[204:207], v[92:95]
ds_read_b64_tr_b16 a[86:87], v25 offset:1312
s_waitcnt lgkmcnt(15)
v_mfma_f32_16x16x32_bf16 v[96:99], a[0:3], v[208:211], v[96:99]
ds_read_b64_tr_b16 a[82:83], v24 offset:1280
v_mfma_f32_16x16x32_bf16 v[100:103], a[4:7], v[208:211], v[100:103]
ds_read_b64_tr_b16 a[84:85], v25 offset:32
v_mfma_f32_16x16x32_bf16 v[104:107], a[8:11], v[208:211], v[104:107]
buffer_load_dwordx4 a[176:179], v23, s[48:51], s23 offen offset:0 sc1
v_mfma_f32_16x16x32_bf16 v[108:111], a[12:15], v[208:211], v[108:111]
ds_read_b64_tr_b16 a[88:89], v24 offset:64
s_waitcnt lgkmcnt(15)
v_mfma_f32_16x16x32_bf16 v[112:115], a[0:3], v[212:215], v[112:115]
ds_read_b128 a[16:19], v18 offset:0
s_waitcnt vmcnt(9)
v_mfma_f32_16x16x32_bf16 v[116:119], a[4:7], v[212:215], v[116:119]
ds_read_b128 a[20:23], v18 offset:2048
v_mul_f32 v8, -0.5, v8
v_mfma_f32_16x16x32_bf16 v[120:123], a[8:11], v[212:215], v[120:123]
s_mul_i32 s23, s1, 20
s_add_u32 s23, s23, s22
buffer_load_dwordx4 a[180:183], v22, s[48:51], s23 offen offset:0 sc1
v_mfma_f32_16x16x32_bf16 v[124:127], a[12:15], v[212:215], v[124:127]
ds_read_b128 a[24:27], v18 offset:4096
s_waitcnt lgkmcnt(15)
v_mfma_f32_16x16x32_bf16 v[128:131], a[0:3], v[216:219], v[128:131]
ds_read_b128 a[28:31], v18 offset:6144
v_cvt_pk_bf16_f32 v232, v8, v8
v_mfma_f32_16x16x32_bf16 v[132:135], a[4:7], v[216:219], v[132:135]
ds_read_b64_tr_b16 v[192:193], v19 offset:10240
v_and_b32 v248, 0xffff0000, v232
v_mfma_f32_16x16x32_bf16 v[136:139], a[8:11], v[216:219], v[136:139]
buffer_load_dwordx4 a[184:187], v22, s[48:51], s23 offen offset:1024 sc1
v_mfma_f32_16x16x32_bf16 v[140:143], a[12:15], v[216:219], v[140:143]
ds_read_b64_tr_b16 v[194:195], v19 offset:11520
s_waitcnt lgkmcnt(15)
v_mfma_f32_16x16x32_bf16 v[144:147], a[0:3], v[220:223], v[144:147]
ds_read_b64_tr_b16 v[196:197], v20 offset:10272
v_sub_f32 v248, v8, v248
v_mfma_f32_16x16x32_bf16 v[148:151], a[4:7], v[220:223], v[148:151]
ds_read_b64_tr_b16 v[198:199], v20 offset:11552
v_cvt_pk_bf16_f32 v233, v248, 0
v_mfma_f32_16x16x32_bf16 v[152:155], a[8:11], v[220:223], v[152:155]
buffer_load_dwordx4 a[188:191], v22, s[48:51], s23 offen offset:2048 sc1
v_mfma_f32_16x16x32_bf16 v[156:159], a[12:15], v[220:223], v[156:159]
ds_read_b64_tr_b16 v[200:201], v19 offset:10304
s_waitcnt lgkmcnt(15)
v_mfma_f32_16x16x32_bf16 v[160:163], a[0:3], v[224:227], v[160:163]
ds_read_b64_tr_b16 v[202:203], v19 offset:11584
v_mul_f32 v9, -0.5, v9
v_mfma_f32_16x16x32_bf16 v[164:167], a[4:7], v[224:227], v[164:167]
ds_read_b64_tr_b16 v[204:205], v20 offset:10336
v_cvt_pk_bf16_f32 v234, v9, v9
v_mfma_f32_16x16x32_bf16 v[168:171], a[8:11], v[224:227], v[168:171]
buffer_load_dwordx4 a[192:195], v22, s[48:51], s23 offen offset:3072 sc1
v_mfma_f32_16x16x32_bf16 v[172:175], a[12:15], v[224:227], v[172:175]
ds_read_b64_tr_b16 v[206:207], v20 offset:11616
s_waitcnt lgkmcnt(15)
v_mfma_f32_16x16x32_bf16 v[176:179], a[0:3], v[228:231], v[176:179]
ds_read_b64_tr_b16 v[208:209], v19 offset:10368
v_and_b32 v248, 0xffff0000, v234
v_mfma_f32_16x16x32_bf16 v[180:183], a[4:7], v[228:231], v[180:183]
ds_read_b64_tr_b16 v[210:211], v19 offset:11648
v_mfma_f32_16x16x32_bf16 v[184:187], a[8:11], v[228:231], v[184:187]
buffer_load_dwordx4 a[196:199], v23, s[48:51], s23 offen offset:0 sc1
v_mfma_f32_16x16x32_bf16 v[188:191], a[12:15], v[228:231], v[188:191]
s_waitcnt lgkmcnt(14)
v_mfma_f32_16x16x32_bf16 a[100:103], a[32:35], a[80:83], a[100:103]
v_sub_f32 v248, v9, v248
v_cvt_pk_bf16_f32 v235, v248, 0
v_mfma_f32_16x16x32_bf16 a[104:107], a[32:35], a[84:87], a[104:107]
v_mul_f32 v10, -0.5, v10
v_cvt_pk_bf16_f32 v236, v10, v10
v_mfma_f32_16x16x32_bf16 a[108:111], a[32:35], a[88:91], a[108:111]
v_and_b32 v248, 0xffff0000, v236
v_sub_f32 v248, v10, v248
v_mfma_f32_16x16x32_bf16 a[112:115], a[32:35], a[92:95], a[112:115]
v_cvt_pk_bf16_f32 v237, v248, 0
v_mul_f32 v11, -0.5, v11
v_mfma_f32_16x16x32_bf16 a[116:119], a[32:35], a[96:99], a[116:119]
s_waitcnt lgkmcnt(8)
v_mfma_f32_16x16x32_bf16 v[32:35], a[16:19], v[192:195], v[32:35]
ds_read_b64_tr_b16 v[212:213], v20 offset:10400
v_cvt_pk_bf16_f32 v238, v11, v11
v_mfma_f32_16x16x32_bf16 v[36:39], a[20:23], v[192:195], v[36:39]
ds_read_b64_tr_b16 v[214:215], v20 offset:11680
v_and_b32 v248, 0xffff0000, v238
v_mfma_f32_16x16x32_bf16 v[40:43], a[24:27], v[192:195], v[40:43]
s_mul_i32 s23, s18, 20
s_add_u32 s23, s23, s22
buffer_load_dwordx4 a[200:203], v22, s[48:51], s23 offen offset:0 sc1
v_mfma_f32_16x16x32_bf16 v[44:47], a[28:31], v[192:195], v[44:47]
ds_read_b64_tr_b16 v[216:217], v19 offset:10432
s_waitcnt lgkmcnt(9)
v_mfma_f32_16x16x32_bf16 v[48:51], a[16:19], v[196:199], v[48:51]
ds_read_b64_tr_b16 v[218:219], v19 offset:11712
v_sub_f32 v248, v11, v248
v_mfma_f32_16x16x32_bf16 v[52:55], a[20:23], v[196:199], v[52:55]
ds_read_b64_tr_b16 v[220:221], v20 offset:10464
v_cvt_pk_bf16_f32 v239, v248, 0
v_mfma_f32_16x16x32_bf16 v[56:59], a[24:27], v[196:199], v[56:59]
buffer_load_dwordx4 a[204:207], v22, s[48:51], s23 offen offset:1024 sc1
v_mfma_f32_16x16x32_bf16 v[60:63], a[28:31], v[196:199], v[60:63]
ds_read_b64_tr_b16 v[222:223], v20 offset:11744
s_waitcnt lgkmcnt(10)
v_mfma_f32_16x16x32_bf16 v[64:67], a[16:19], v[200:203], v[64:67]
ds_read_b64_tr_b16 v[224:225], v19 offset:10496
v_mfma_f32_16x16x32_bf16 v[68:71], a[20:23], v[200:203], v[68:71]
ds_read_b64_tr_b16 v[226:227], v19 offset:11776
v_mfma_f32_16x16x32_bf16 v[72:75], a[24:27], v[200:203], v[72:75]
buffer_load_dwordx4 a[208:211], v22, s[48:51], s23 offen offset:2048 sc1
v_mfma_f32_16x16x32_bf16 v[76:79], a[28:31], v[200:203], v[76:79]
ds_read_b64_tr_b16 v[228:229], v20 offset:10528
s_waitcnt lgkmcnt(11)
v_mfma_f32_16x16x32_bf16 v[80:83], a[16:19], v[204:207], v[80:83]
ds_read_b64_tr_b16 v[230:231], v20 offset:11808
v_mfma_f32_16x16x32_bf16 v[84:87], a[20:23], v[204:207], v[84:87]
ds_write_b32 v4, a100 offset:0
v_mfma_f32_16x16x32_bf16 v[88:91], a[24:27], v[204:207], v[88:91]
buffer_load_dwordx4 a[212:215], v22, s[48:51], s23 offen offset:3072 sc1
v_mfma_f32_16x16x32_bf16 v[92:95], a[28:31], v[204:207], v[92:95]
ds_write_b32 v4, a104 offset:128
s_waitcnt lgkmcnt(12)
v_mfma_f32_16x16x32_bf16 v[96:99], a[16:19], v[208:211], v[96:99]
ds_write_b32 v4, a108 offset:256
v_mfma_f32_16x16x32_bf16 v[100:103], a[20:23], v[208:211], v[100:103]
ds_write_b32 v4, a112 offset:384
v_mfma_f32_16x16x32_bf16 v[104:107], a[24:27], v[208:211], v[104:107]
buffer_load_dwordx4 a[216:219], v23, s[48:51], s23 offen offset:0 sc1
v_mfma_f32_16x16x32_bf16 v[108:111], a[28:31], v[208:211], v[108:111]
ds_write_b32 v4, a116 offset:512
s_waitcnt lgkmcnt(0)
s_barrier
v_mfma_f32_16x16x32_bf16 v[112:115], a[16:19], v[212:215], v[112:115]
ds_read_b32 v192, v5 offset:0
v_mfma_f32_16x16x32_bf16 v[116:119], a[20:23], v[212:215], v[116:119]
ds_read_b32 v194, v5 offset:128
v_mfma_f32_16x16x32_bf16 v[120:123], a[24:27], v[212:215], v[120:123]
s_mul_i32 s23, s19, 20
s_add_u32 s23, s23, s22
buffer_load_dwordx4 a[220:223], v22, s[48:51], s23 offen offset:0 sc1
v_mfma_f32_16x16x32_bf16 v[124:127], a[28:31], v[212:215], v[124:127]
ds_read_b32 v196, v5 offset:256
v_mfma_f32_16x16x32_bf16 v[128:131], a[16:19], v[216:219], v[128:131]
ds_read_b32 v198, v5 offset:384
v_mfma_f32_16x16x32_bf16 v[132:135], a[20:23], v[216:219], v[132:135]
ds_read_b32 v200, v5 offset:512
v_mfma_f32_16x16x32_bf16 v[136:139], a[24:27], v[216:219], v[136:139]
buffer_load_dwordx4 a[224:227], v22, s[48:51], s23 offen offset:1024 sc1
v_mfma_f32_16x16x32_bf16 v[140:143], a[28:31], v[216:219], v[140:143]
ds_read_b32 v202, v5 offset:640
v_mfma_f32_16x16x32_bf16 v[144:147], a[16:19], v[220:223], v[144:147]
ds_read_b32 v204, v5 offset:768
v_mfma_f32_16x16x32_bf16 v[148:151], a[20:23], v[220:223], v[148:151]
ds_read_b32 v206, v5 offset:896
s_waitcnt lgkmcnt(0)
v_mfma_f32_16x16x32_bf16 v[152:155], a[24:27], v[220:223], v[152:155]
buffer_load_dwordx4 a[228:231], v22, s[48:51], s23 offen offset:2048 sc1
v_mfma_f32_16x16x32_bf16 v[156:159], a[28:31], v[220:223], v[156:159]
ds_read_b32 v208, v5 offset:1024
v_mfma_f32_16x16x32_bf16 v[160:163], a[16:19], v[224:227], v[160:163]
ds_read_b32 v210, v5 offset:1152
v_cvt_pk_bf16_f32 v193, v192, v192
v_mfma_f32_16x16x32_bf16 v[164:167], a[20:23], v[224:227], v[164:167]
v_and_b32 v248, 0xffff0000, v193
v_sub_f32 v248, v192, v248
v_mfma_f32_16x16x32_bf16 v[168:171], a[24:27], v[224:227], v[168:171]
buffer_load_dwordx4 a[232:235], v22, s[48:51], s23 offen offset:3072 sc1
v_mfma_f32_16x16x32_bf16 v[172:175], a[28:31], v[224:227], v[172:175]
v_cvt_pk_bf16_f32 v192, v192, v248
v_mfma_f32_16x16x32_bf16 v[176:179], a[16:19], v[228:231], v[176:179]
v_cvt_pk_bf16_f32 v195, v194, v194
v_and_b32 v248, 0xffff0000, v195
v_mfma_f32_16x16x32_bf16 v[180:183], a[20:23], v[228:231], v[180:183]
v_sub_f32 v248, v194, v248
v_cvt_pk_bf16_f32 v194, v194, v248
v_mfma_f32_16x16x32_bf16 v[184:187], a[24:27], v[228:231], v[184:187]
buffer_load_dwordx4 a[236:239], v23, s[48:51], s23 offen offset:0 sc1
v_mfma_f32_16x16x32_bf16 v[188:191], a[28:31], v[228:231], v[188:191]
v_mfma_f32_16x16x16_bf16 v[32:35], v[232:233], v[192:193], v[32:35]
v_cvt_pk_bf16_f32 v197, v196, v196
v_and_b32 v248, 0xffff0000, v197
v_mfma_f32_16x16x16_bf16 v[36:39], v[234:235], v[192:193], v[36:39]
v_sub_f32 v248, v196, v248
v_cvt_pk_bf16_f32 v196, v196, v248
s_mul_i32 s23, s75, 20
s_add_u32 s23, s23, s31
s_add_u32 m0, s65, 0
s_nop 0
buffer_load_dwordx4 v22, s[48:51], s23 offen offset:0 sc1 lds
v_mfma_f32_16x16x16_bf16 v[40:43], v[236:237], v[192:193], v[40:43]
v_cvt_pk_bf16_f32 v199, v198, v198
v_and_b32 v248, 0xffff0000, v199
v_mfma_f32_16x16x16_bf16 v[44:47], v[238:239], v[192:193], v[44:47]
v_sub_f32 v248, v198, v248
v_cvt_pk_bf16_f32 v198, v198, v248
v_mfma_f32_16x16x16_bf16 v[48:51], v[232:233], v[194:195], v[48:51]
v_cvt_pk_bf16_f32 v201, v200, v200
v_and_b32 v248, 0xffff0000, v201
v_mfma_f32_16x16x16_bf16 v[52:55], v[234:235], v[194:195], v[52:55]
v_sub_f32 v248, v200, v248
v_cvt_pk_bf16_f32 v200, v200, v248
buffer_load_dwordx4 v22, s[48:51], s23 offen offset:1024 sc1 lds
v_mfma_f32_16x16x16_bf16 v[56:59], v[236:237], v[194:195], v[56:59]
v_cvt_pk_bf16_f32 v203, v202, v202
v_and_b32 v248, 0xffff0000, v203
v_mfma_f32_16x16x16_bf16 v[60:63], v[238:239], v[194:195], v[60:63]
v_sub_f32 v248, v202, v248
v_cvt_pk_bf16_f32 v202, v202, v248
v_mfma_f32_16x16x16_bf16 v[64:67], v[232:233], v[196:197], v[64:67]
v_cvt_pk_bf16_f32 v205, v204, v204
v_and_b32 v248, 0xffff0000, v205
v_mfma_f32_16x16x16_bf16 v[68:71], v[234:235], v[196:197], v[68:71]
v_sub_f32 v248, v204, v248
v_cvt_pk_bf16_f32 v204, v204, v248
buffer_load_dwordx4 v22, s[48:51], s23 offen offset:2048 sc1 lds
v_mfma_f32_16x16x16_bf16 v[72:75], v[236:237], v[196:197], v[72:75]
v_cvt_pk_bf16_f32 v207, v206, v206
v_and_b32 v248, 0xffff0000, v207
v_mfma_f32_16x16x16_bf16 v[76:79], v[238:239], v[196:197], v[76:79]
v_sub_f32 v248, v206, v248
v_cvt_pk_bf16_f32 v206, v206, v248
v_mfma_f32_16x16x16_bf16 v[80:83], v[232:233], v[198:199], v[80:83]
v_cvt_pk_bf16_f32 v209, v208, v208
v_and_b32 v248, 0xffff0000, v209
v_mfma_f32_16x16x16_bf16 v[84:87], v[234:235], v[198:199], v[84:87]
v_sub_f32 v248, v208, v248
v_cvt_pk_bf16_f32 v208, v208, v248
buffer_load_dwordx4 v22, s[48:51], s23 offen offset:3072 sc1 lds
v_mfma_f32_16x16x16_bf16 v[88:91], v[236:237], v[198:199], v[88:91]
v_cvt_pk_bf16_f32 v211, v210, v210
v_and_b32 v248, 0xffff0000, v211
v_mfma_f32_16x16x16_bf16 v[92:95], v[238:239], v[198:199], v[92:95]
v_sub_f32 v248, v210, v248
v_cvt_pk_bf16_f32 v210, v210, v248
v_mfma_f32_16x16x16_bf16 v[96:99], v[232:233], v[200:201], v[96:99]
s_waitcnt vmcnt(22)
v_mfma_f32_16x16x16_bf16 v[100:103], v[234:235], v[200:201], v[100:103]
v_accvgpr_read_b32 v8, a44
s_add_u32 m0, s65, 4096
s_nop 0
buffer_load_dwordx4 v23, s[48:51], s23 offen offset:0 sc1 lds
v_mfma_f32_16x16x16_bf16 v[104:107], v[236:237], v[200:201], v[104:107]
v_accvgpr_read_b32 v9, a45
v_mfma_f32_16x16x16_bf16 v[108:111], v[238:239], v[200:201], v[108:111]
v_accvgpr_read_b32 v10, a46
v_mfma_f32_16x16x16_bf16 v[112:115], v[232:233], v[202:203], v[112:115]
v_accvgpr_read_b32 v11, a47
v_mfma_f32_16x16x16_bf16 v[116:119], v[234:235], v[202:203], v[116:119]
v_accvgpr_read_b32 v12, a48
s_mul_i32 s23, s76, 20
s_add_u32 s23, s23, s31
s_add_u32 m0, s65, 5120
s_nop 0
buffer_load_dwordx4 v22, s[48:51], s23 offen offset:0 sc1 lds
v_mfma_f32_16x16x16_bf16 v[120:123], v[236:237], v[202:203], v[120:123]
v_accvgpr_read_b32 v13, a49
v_mfma_f32_16x16x16_bf16 v[124:127], v[238:239], v[202:203], v[124:127]
v_accvgpr_read_b32 v14, a50
v_mfma_f32_16x16x16_bf16 v[128:131], v[232:233], v[204:205], v[128:131]
v_accvgpr_read_b32 v15, a51
v_mfma_f32_16x16x16_bf16 v[132:135], v[234:235], v[204:205], v[132:135]
v_accvgpr_read_b32 v16, a52
buffer_load_dwordx4 v22, s[48:51], s23 offen offset:1024 sc1 lds
v_mfma_f32_16x16x16_bf16 v[136:139], v[236:237], v[204:205], v[136:139]
v_accvgpr_read_b32 v17, a53
v_mfma_f32_16x16x16_bf16 v[140:143], v[238:239], v[204:205], v[140:143]
v_accvgpr_read_b32 v18, a54
v_mfma_f32_16x16x16_bf16 v[144:147], v[232:233], v[206:207], v[144:147]
v_accvgpr_read_b32 v19, a55
v_mfma_f32_16x16x16_bf16 v[148:151], v[234:235], v[206:207], v[148:151]
v_accvgpr_read_b32 v24, a56
buffer_load_dwordx4 v22, s[48:51], s23 offen offset:2048 sc1 lds
v_mfma_f32_16x16x16_bf16 v[152:155], v[236:237], v[206:207], v[152:155]
v_accvgpr_read_b32 v25, a57
v_mfma_f32_16x16x16_bf16 v[156:159], v[238:239], v[206:207], v[156:159]
v_accvgpr_read_b32 v30, a58
v_mfma_f32_16x16x16_bf16 v[160:163], v[232:233], v[208:209], v[160:163]
v_accvgpr_read_b32 v31, a59
v_mfma_f32_16x16x16_bf16 v[164:167], v[234:235], v[208:209], v[164:167]
s_mov_b32 s88, 0x358637bd
buffer_load_dwordx4 v22, s[48:51], s23 offen offset:3072 sc1 lds
v_mfma_f32_16x16x16_bf16 v[168:171], v[236:237], v[208:209], v[168:171]
s_mov_b32 s89, 0x358637bd
v_mfma_f32_16x16x16_bf16 v[172:175], v[238:239], v[208:209], v[172:175]
s_mov_b32 s90, 0x3fb8aa3b
v_mfma_f32_16x16x16_bf16 v[176:179], v[232:233], v[210:211], v[176:179]
s_mov_b32 s91, 0x3fb8aa3b
v_mfma_f32_16x16x16_bf16 v[180:183], v[234:235], v[210:211], v[180:183]
s_add_u32 m0, s65, 9216
s_nop 0
buffer_load_dwordx4 v23, s[48:51], s23 offen offset:0 sc1 lds
v_mfma_f32_16x16x16_bf16 v[184:187], v[236:237], v[210:211], v[184:187]
v_mfma_f32_16x16x16_bf16 v[188:191], v[238:239], v[210:211], v[188:191]
v_pk_fma_f32 v[32:33], v[32:33], v[8:9], s[88:89]
v_pk_fma_f32 v[34:35], v[34:35], v[10:11], s[88:89]
v_pk_fma_f32 v[36:37], v[36:37], v[12:13], s[88:89]
v_pk_fma_f32 v[38:39], v[38:39], v[14:15], s[88:89]
v_pk_mul_f32 v[232:233], v[32:33], s[90:91]
v_pk_mul_f32 v[234:235], v[34:35], s[90:91]
v_pk_mul_f32 v[236:237], v[36:37], s[90:91]
v_pk_mul_f32 v[238:239], v[38:39], s[90:91]
v_exp_f32_e64 v232, v232 clamp
v_exp_f32_e64 v233, v233 clamp
v_exp_f32_e64 v234, v234 clamp
v_exp_f32_e64 v235, v235 clamp
v_exp_f32_e64 v236, v236 clamp
v_exp_f32_e64 v237, v237 clamp
v_exp_f32_e64 v238, v238 clamp
v_exp_f32_e64 v239, v239 clamp
v_max_f32 v32, s88, v32
v_max_f32 v33, s88, v33
v_max_f32 v34, s88, v34
v_max_f32 v35, s88, v35
v_max_f32 v36, s88, v36
v_max_f32 v37, s88, v37
v_max_f32 v38, s88, v38
v_max_f32 v39, s88, v39
v_pk_add_f32 v[32:33], v[32:33], v[232:233]
v_pk_add_f32 v[34:35], v[34:35], v[234:235]
s_mul_i32 s23, s77, 20
s_add_u32 s23, s23, s31
s_add_u32 m0, s65, 10240
s_nop 0
buffer_load_dwordx4 v22, s[48:51], s23 offen offset:0 sc1 lds
v_pk_add_f32 v[36:37], v[36:37], v[236:237]
v_pk_add_f32 v[38:39], v[38:39], v[238:239]
v_cvt_pk_bf16_f32 v192, v32, v33
v_cvt_pk_bf16_f32 v193, v34, v35
v_cvt_pk_bf16_f32 v194, v36, v37
v_cvt_pk_bf16_f32 v195, v38, v39
v_pk_fma_f32 v[40:41], v[40:41], v[16:17], s[88:89]
v_pk_fma_f32 v[42:43], v[42:43], v[18:19], s[88:89]
v_pk_fma_f32 v[44:45], v[44:45], v[24:25], s[88:89]
v_pk_fma_f32 v[46:47], v[46:47], v[30:31], s[88:89]
v_pk_mul_f32 v[232:233], v[40:41], s[90:91]
v_pk_mul_f32 v[234:235], v[42:43], s[90:91]
v_pk_mul_f32 v[236:237], v[44:45], s[90:91]
v_pk_mul_f32 v[238:239], v[46:47], s[90:91]
v_exp_f32_e64 v232, v232 clamp
v_exp_f32_e64 v233, v233 clamp
v_exp_f32_e64 v234, v234 clamp
v_exp_f32_e64 v235, v235 clamp
v_exp_f32_e64 v236, v236 clamp
v_exp_f32_e64 v237, v237 clamp
v_exp_f32_e64 v238, v238 clamp
v_exp_f32_e64 v239, v239 clamp
v_max_f32 v40, s88, v40
v_max_f32 v41, s88, v41
v_max_f32 v42, s88, v42
v_max_f32 v43, s88, v43
buffer_load_dwordx4 v22, s[48:51], s23 offen offset:1024 sc1 lds
v_max_f32 v44, s88, v44
v_max_f32 v45, s88, v45
v_max_f32 v46, s88, v46
v_max_f32 v47, s88, v47
v_pk_add_f32 v[40:41], v[40:41], v[232:233]
v_pk_add_f32 v[42:43], v[42:43], v[234:235]
v_pk_add_f32 v[44:45], v[44:45], v[236:237]
v_pk_add_f32 v[46:47], v[46:47], v[238:239]
v_cvt_pk_bf16_f32 v196, v40, v41
v_cvt_pk_bf16_f32 v197, v42, v43
v_cvt_pk_bf16_f32 v198, v44, v45
v_cvt_pk_bf16_f32 v199, v46, v47
v_pk_fma_f32 v[48:49], v[48:49], v[8:9], s[88:89]
v_pk_fma_f32 v[50:51], v[50:51], v[10:11], s[88:89]
v_pk_fma_f32 v[52:53], v[52:53], v[12:13], s[88:89]
v_pk_fma_f32 v[54:55], v[54:55], v[14:15], s[88:89]
v_pk_mul_f32 v[232:233], v[48:49], s[90:91]
v_pk_mul_f32 v[234:235], v[50:51], s[90:91]
v_pk_mul_f32 v[236:237], v[52:53], s[90:91]
v_pk_mul_f32 v[238:239], v[54:55], s[90:91]
v_exp_f32_e64 v232, v232 clamp
v_exp_f32_e64 v233, v233 clamp
v_exp_f32_e64 v234, v234 clamp
v_exp_f32_e64 v235, v235 clamp
v_exp_f32_e64 v236, v236 clamp
v_exp_f32_e64 v237, v237 clamp
buffer_load_dwordx4 v22, s[48:51], s23 offen offset:2048 sc1 lds
v_exp_f32_e64 v238, v238 clamp
v_exp_f32_e64 v239, v239 clamp
v_max_f32 v48, s88, v48
v_max_f32 v49, s88, v49
v_max_f32 v50, s88, v50
v_max_f32 v51, s88, v51
v_max_f32 v52, s88, v52
v_max_f32 v53, s88, v53
v_max_f32 v54, s88, v54
v_max_f32 v55, s88, v55
v_pk_add_f32 v[48:49], v[48:49], v[232:233]
v_pk_add_f32 v[50:51], v[50:51], v[234:235]
v_pk_add_f32 v[52:53], v[52:53], v[236:237]
v_pk_add_f32 v[54:55], v[54:55], v[238:239]
v_cvt_pk_bf16_f32 v200, v48, v49
v_cvt_pk_bf16_f32 v201, v50, v51
v_cvt_pk_bf16_f32 v202, v52, v53
v_cvt_pk_bf16_f32 v203, v54, v55
v_pk_fma_f32 v[56:57], v[56:57], v[16:17], s[88:89]
v_pk_fma_f32 v[58:59], v[58:59], v[18:19], s[88:89]
v_pk_fma_f32 v[60:61], v[60:61], v[24:25], s[88:89]
v_pk_fma_f32 v[62:63], v[62:63], v[30:31], s[88:89]
v_pk_mul_f32 v[232:233], v[56:57], s[90:91]
v_pk_mul_f32 v[234:235], v[58:59], s[90:91]
v_pk_mul_f32 v[236:237], v[60:61], s[90:91]
v_pk_mul_f32 v[238:239], v[62:63], s[90:91]
buffer_load_dwordx4 v22, s[48:51], s23 offen offset:3072 sc1 lds
v_exp_f32_e64 v232, v232 clamp
v_exp_f32_e64 v233, v233 clamp
v_exp_f32_e64 v234, v234 clamp
v_exp_f32_e64 v235, v235 clamp
v_exp_f32_e64 v236, v236 clamp
v_exp_f32_e64 v237, v237 clamp
v_exp_f32_e64 v238, v238 clamp
v_exp_f32_e64 v239, v239 clamp
v_max_f32 v56, s88, v56
v_max_f32 v57, s88, v57
v_max_f32 v58, s88, v58
v_max_f32 v59, s88, v59
v_max_f32 v60, s88, v60
v_max_f32 v61, s88, v61
v_max_f32 v62, s88, v62
v_max_f32 v63, s88, v63
v_pk_add_f32 v[56:57], v[56:57], v[232:233]
v_pk_add_f32 v[58:59], v[58:59], v[234:235]
v_pk_add_f32 v[60:61], v[60:61], v[236:237]
v_pk_add_f32 v[62:63], v[62:63], v[238:239]
v_cvt_pk_bf16_f32 v204, v56, v57
v_cvt_pk_bf16_f32 v205, v58, v59
v_cvt_pk_bf16_f32 v206, v60, v61
v_cvt_pk_bf16_f32 v207, v62, v63
v_pk_fma_f32 v[64:65], v[64:65], v[8:9], s[88:89]
v_pk_fma_f32 v[66:67], v[66:67], v[10:11], s[88:89]
s_add_u32 m0, s65, 14336
s_nop 0
buffer_load_dwordx4 v23, s[48:51], s23 offen offset:0 sc1 lds
v_pk_fma_f32 v[68:69], v[68:69], v[12:13], s[88:89]
v_pk_fma_f32 v[70:71], v[70:71], v[14:15], s[88:89]
v_pk_mul_f32 v[232:233], v[64:65], s[90:91]
v_pk_mul_f32 v[234:235], v[66:67], s[90:91]
v_pk_mul_f32 v[236:237], v[68:69], s[90:91]
v_pk_mul_f32 v[238:239], v[70:71], s[90:91]
v_exp_f32_e64 v232, v232 clamp
v_exp_f32_e64 v233, v233 clamp
v_exp_f32_e64 v234, v234 clamp
v_exp_f32_e64 v235, v235 clamp
v_exp_f32_e64 v236, v236 clamp
v_exp_f32_e64 v237, v237 clamp
v_exp_f32_e64 v238, v238 clamp
v_exp_f32_e64 v239, v239 clamp
v_max_f32 v64, s88, v64
v_max_f32 v65, s88, v65
v_max_f32 v66, s88, v66
v_max_f32 v67, s88, v67
v_max_f32 v68, s88, v68
v_max_f32 v69, s88, v69
v_max_f32 v70, s88, v70
v_max_f32 v71, s88, v71
v_pk_add_f32 v[64:65], v[64:65], v[232:233]
v_pk_add_f32 v[66:67], v[66:67], v[234:235]
v_pk_add_f32 v[68:69], v[68:69], v[236:237]
v_pk_add_f32 v[70:71], v[70:71], v[238:239]
s_mul_i32 s23, s0, 20
s_add_u32 s23, s23, s22
s_add_u32 s23, s23, 81920
s_add_u32 m0, s65, 15360
s_nop 0
buffer_load_dwordx4 v22, s[48:51], s23 offen offset:0 sc1 lds
v_cvt_pk_bf16_f32 v208, v64, v65
v_cvt_pk_bf16_f32 v209, v66, v67
v_cvt_pk_bf16_f32 v210, v68, v69
v_cvt_pk_bf16_f32 v211, v70, v71
v_pk_fma_f32 v[72:73], v[72:73], v[16:17], s[88:89]
v_pk_fma_f32 v[74:75], v[74:75], v[18:19], s[88:89]
v_pk_fma_f32 v[76:77], v[76:77], v[24:25], s[88:89]
v_pk_fma_f32 v[78:79], v[78:79], v[30:31], s[88:89]
v_pk_mul_f32 v[232:233], v[72:73], s[90:91]
v_pk_mul_f32 v[234:235], v[74:75], s[90:91]
v_pk_mul_f32 v[236:237], v[76:77], s[90:91]
v_pk_mul_f32 v[238:239], v[78:79], s[90:91]
v_exp_f32_e64 v232, v232 clamp
v_exp_f32_e64 v233, v233 clamp
v_exp_f32_e64 v234, v234 clamp
v_exp_f32_e64 v235, v235 clamp
v_exp_f32_e64 v236, v236 clamp
v_exp_f32_e64 v237, v237 clamp
v_exp_f32_e64 v238, v238 clamp
v_exp_f32_e64 v239, v239 clamp
v_max_f32 v72, s88, v72
v_max_f32 v73, s88, v73
v_max_f32 v74, s88, v74
v_max_f32 v75, s88, v75
v_max_f32 v76, s88, v76
v_max_f32 v77, s88, v77
buffer_load_dwordx4 v22, s[48:51], s23 offen offset:1024 sc1 lds
v_max_f32 v78, s88, v78
v_max_f32 v79, s88, v79
v_pk_add_f32 v[72:73], v[72:73], v[232:233]
v_pk_add_f32 v[74:75], v[74:75], v[234:235]
v_pk_add_f32 v[76:77], v[76:77], v[236:237]
v_pk_add_f32 v[78:79], v[78:79], v[238:239]
v_cvt_pk_bf16_f32 v212, v72, v73
v_cvt_pk_bf16_f32 v213, v74, v75
v_cvt_pk_bf16_f32 v214, v76, v77
v_cvt_pk_bf16_f32 v215, v78, v79
v_pk_fma_f32 v[80:81], v[80:81], v[8:9], s[88:89]
v_pk_fma_f32 v[82:83], v[82:83], v[10:11], s[88:89]
v_pk_fma_f32 v[84:85], v[84:85], v[12:13], s[88:89]
v_pk_fma_f32 v[86:87], v[86:87], v[14:15], s[88:89]
v_pk_mul_f32 v[232:233], v[80:81], s[90:91]
v_pk_mul_f32 v[234:235], v[82:83], s[90:91]
v_pk_mul_f32 v[236:237], v[84:85], s[90:91]
v_pk_mul_f32 v[238:239], v[86:87], s[90:91]
v_exp_f32_e64 v232, v232 clamp
v_exp_f32_e64 v233, v233 clamp
v_exp_f32_e64 v234, v234 clamp
v_exp_f32_e64 v235, v235 clamp
v_exp_f32_e64 v236, v236 clamp
v_exp_f32_e64 v237, v237 clamp
v_exp_f32_e64 v238, v238 clamp
v_exp_f32_e64 v239, v239 clamp
buffer_load_dwordx4 v22, s[48:51], s23 offen offset:2048 sc1 lds
v_max_f32 v80, s88, v80
v_max_f32 v81, s88, v81
v_max_f32 v82, s88, v82
v_max_f32 v83, s88, v83
v_max_f32 v84, s88, v84
v_max_f32 v85, s88, v85
v_max_f32 v86, s88, v86
v_max_f32 v87, s88, v87
v_pk_add_f32 v[80:81], v[80:81], v[232:233]
v_pk_add_f32 v[82:83], v[82:83], v[234:235]
v_pk_add_f32 v[84:85], v[84:85], v[236:237]
v_pk_add_f32 v[86:87], v[86:87], v[238:239]
v_cvt_pk_bf16_f32 v216, v80, v81
v_cvt_pk_bf16_f32 v217, v82, v83
v_cvt_pk_bf16_f32 v218, v84, v85
v_cvt_pk_bf16_f32 v219, v86, v87
v_pk_fma_f32 v[88:89], v[88:89], v[16:17], s[88:89]
v_pk_fma_f32 v[90:91], v[90:91], v[18:19], s[88:89]
v_pk_fma_f32 v[92:93], v[92:93], v[24:25], s[88:89]
v_pk_fma_f32 v[94:95], v[94:95], v[30:31], s[88:89]
v_pk_mul_f32 v[232:233], v[88:89], s[90:91]
v_pk_mul_f32 v[234:235], v[90:91], s[90:91]
v_pk_mul_f32 v[236:237], v[92:93], s[90:91]
v_pk_mul_f32 v[238:239], v[94:95], s[90:91]
v_exp_f32_e64 v232, v232 clamp
v_exp_f32_e64 v233, v233 clamp
buffer_load_dwordx4 v22, s[48:51], s23 offen offset:3072 sc1 lds
v_exp_f32_e64 v234, v234 clamp
v_exp_f32_e64 v235, v235 clamp
v_exp_f32_e64 v236, v236 clamp
v_exp_f32_e64 v237, v237 clamp
v_exp_f32_e64 v238, v238 clamp
v_exp_f32_e64 v239, v239 clamp
v_max_f32 v88, s88, v88
v_max_f32 v89, s88, v89
v_max_f32 v90, s88, v90
v_max_f32 v91, s88, v91
v_max_f32 v92, s88, v92
v_max_f32 v93, s88, v93
v_max_f32 v94, s88, v94
v_max_f32 v95, s88, v95
v_pk_add_f32 v[88:89], v[88:89], v[232:233]
v_pk_add_f32 v[90:91], v[90:91], v[234:235]
v_pk_add_f32 v[92:93], v[92:93], v[236:237]
v_pk_add_f32 v[94:95], v[94:95], v[238:239]
v_cvt_pk_bf16_f32 v220, v88, v89
v_cvt_pk_bf16_f32 v221, v90, v91
v_cvt_pk_bf16_f32 v222, v92, v93
v_cvt_pk_bf16_f32 v223, v94, v95
v_pk_fma_f32 v[96:97], v[96:97], v[8:9], s[88:89]
v_pk_fma_f32 v[98:99], v[98:99], v[10:11], s[88:89]
v_pk_fma_f32 v[100:101], v[100:101], v[12:13], s[88:89]
v_pk_fma_f32 v[102:103], v[102:103], v[14:15], s[88:89]
s_add_u32 m0, s65, 19456
s_nop 0
buffer_load_dwordx4 v23, s[48:51], s23 offen offset:0 sc1 lds
v_pk_mul_f32 v[232:233], v[96:97], s[90:91]
v_pk_mul_f32 v[234:235], v[98:99], s[90:91]
v_pk_mul_f32 v[236:237], v[100:101], s[90:91]
v_pk_mul_f32 v[238:239], v[102:103], s[90:91]
v_exp_f32_e64 v232, v232 clamp
v_exp_f32_e64 v233, v233 clamp
v_exp_f32_e64 v234, v234 clamp
v_exp_f32_e64 v235, v235 clamp
v_exp_f32_e64 v236, v236 clamp
v_exp_f32_e64 v237, v237 clamp
v_exp_f32_e64 v238, v238 clamp
v_exp_f32_e64 v239, v239 clamp
v_max_f32 v96, s88, v96
v_max_f32 v97, s88, v97
v_max_f32 v98, s88, v98
v_max_f32 v99, s88, v99
v_max_f32 v100, s88, v100
v_max_f32 v101, s88, v101
v_max_f32 v102, s88, v102
v_max_f32 v103, s88, v103
v_pk_add_f32 v[96:97], v[96:97], v[232:233]
v_pk_add_f32 v[98:99], v[98:99], v[234:235]
v_pk_add_f32 v[100:101], v[100:101], v[236:237]
v_pk_add_f32 v[102:103], v[102:103], v[238:239]
v_cvt_pk_bf16_f32 v224, v96, v97
v_cvt_pk_bf16_f32 v225, v98, v99
s_mul_i32 s23, s20, 20
s_add_u32 s23, s23, s22
buffer_load_dwordx4 a[240:243], v22, s[48:51], s23 offen offset:0 sc1
v_cvt_pk_bf16_f32 v226, v100, v101
v_cvt_pk_bf16_f32 v227, v102, v103
v_pk_fma_f32 v[104:105], v[104:105], v[16:17], s[88:89]
v_pk_fma_f32 v[106:107], v[106:107], v[18:19], s[88:89]
v_pk_fma_f32 v[108:109], v[108:109], v[24:25], s[88:89]
v_pk_fma_f32 v[110:111], v[110:111], v[30:31], s[88:89]
v_pk_mul_f32 v[232:233], v[104:105], s[90:91]
v_pk_mul_f32 v[234:235], v[106:107], s[90:91]
v_pk_mul_f32 v[236:237], v[108:109], s[90:91]
v_pk_mul_f32 v[238:239], v[110:111], s[90:91]
v_exp_f32_e64 v232, v232 clamp
v_exp_f32_e64 v233, v233 clamp
v_exp_f32_e64 v234, v234 clamp
v_exp_f32_e64 v235, v235 clamp
v_exp_f32_e64 v236, v236 clamp
v_exp_f32_e64 v237, v237 clamp
v_exp_f32_e64 v238, v238 clamp
v_exp_f32_e64 v239, v239 clamp
v_max_f32 v104, s88, v104
v_max_f32 v105, s88, v105
v_max_f32 v106, s88, v106
v_max_f32 v107, s88, v107
v_max_f32 v108, s88, v108
v_max_f32 v109, s88, v109
v_max_f32 v110, s88, v110
v_max_f32 v111, s88, v111
buffer_load_dwordx4 a[244:247], v22, s[48:51], s23 offen offset:1024 sc1
v_pk_add_f32 v[104:105], v[104:105], v[232:233]
v_pk_add_f32 v[106:107], v[106:107], v[234:235]
v_pk_add_f32 v[108:109], v[108:109], v[236:237]
v_pk_add_f32 v[110:111], v[110:111], v[238:239]
v_cvt_pk_bf16_f32 v228, v104, v105
v_cvt_pk_bf16_f32 v229, v106, v107
v_cvt_pk_bf16_f32 v230, v108, v109
v_cvt_pk_bf16_f32 v231, v110, v111
v_pk_mul_f32 v[112:113], v[112:113], v[8:9]
v_pk_mul_f32 v[114:115], v[114:115], v[10:11]
v_pk_mul_f32 v[116:117], v[116:117], v[12:13]
v_pk_mul_f32 v[118:119], v[118:119], v[14:15]
v_pk_mul_f32 v[120:121], v[120:121], v[16:17]
v_pk_mul_f32 v[122:123], v[122:123], v[18:19]
v_pk_mul_f32 v[124:125], v[124:125], v[24:25]
v_pk_mul_f32 v[126:127], v[126:127], v[30:31]
v_pk_mul_f32 v[128:129], v[128:129], v[8:9]
v_pk_mul_f32 v[130:131], v[130:131], v[10:11]
v_pk_mul_f32 v[132:133], v[132:133], v[12:13]
v_pk_mul_f32 v[134:135], v[134:135], v[14:15]
v_pk_mul_f32 v[136:137], v[136:137], v[16:17]
v_pk_mul_f32 v[138:139], v[138:139], v[18:19]
v_pk_mul_f32 v[140:141], v[140:141], v[24:25]
v_pk_mul_f32 v[142:143], v[142:143], v[30:31]
v_pk_mul_f32 v[144:145], v[144:145], v[8:9]
v_pk_mul_f32 v[146:147], v[146:147], v[10:11]
buffer_load_dwordx4 a[248:251], v22, s[48:51], s23 offen offset:2048 sc1
v_pk_mul_f32 v[148:149], v[148:149], v[12:13]
v_pk_mul_f32 v[150:151], v[150:151], v[14:15]
v_pk_mul_f32 v[152:153], v[152:153], v[16:17]
v_pk_mul_f32 v[154:155], v[154:155], v[18:19]
v_pk_mul_f32 v[156:157], v[156:157], v[24:25]
v_pk_mul_f32 v[158:159], v[158:159], v[30:31]
v_pk_mul_f32 v[160:161], v[160:161], v[8:9]
v_pk_mul_f32 v[162:163], v[162:163], v[10:11]
v_pk_mul_f32 v[164:165], v[164:165], v[12:13]
v_pk_mul_f32 v[166:167], v[166:167], v[14:15]
v_pk_mul_f32 v[168:169], v[168:169], v[16:17]
v_pk_mul_f32 v[170:171], v[170:171], v[18:19]
v_pk_mul_f32 v[172:173], v[172:173], v[24:25]
v_pk_mul_f32 v[174:175], v[174:175], v[30:31]
v_pk_mul_f32 v[176:177], v[176:177], v[8:9]
v_pk_mul_f32 v[178:179], v[178:179], v[10:11]
v_pk_mul_f32 v[180:181], v[180:181], v[12:13]
v_pk_mul_f32 v[182:183], v[182:183], v[14:15]
v_pk_mul_f32 v[184:185], v[184:185], v[16:17]
v_pk_mul_f32 v[186:187], v[186:187], v[18:19]
v_pk_mul_f32 v[188:189], v[188:189], v[24:25]
v_pk_mul_f32 v[190:191], v[190:191], v[30:31]
v_cvt_pk_bf16_f32 v32, v112, v113
v_cvt_pk_bf16_f32 v33, v114, v115
v_cvt_pk_bf16_f32 v34, v116, v117
v_cvt_pk_bf16_f32 v35, v118, v119
buffer_load_dwordx4 a[252:255], v22, s[48:51], s23 offen offset:3072 sc1
v_cvt_pk_bf16_f32 v36, v120, v121
v_cvt_pk_bf16_f32 v37, v122, v123
v_cvt_pk_bf16_f32 v38, v124, v125
v_cvt_pk_bf16_f32 v39, v126, v127
v_cvt_pk_bf16_f32 v40, v128, v129
v_cvt_pk_bf16_f32 v41, v130, v131
v_cvt_pk_bf16_f32 v42, v132, v133
v_cvt_pk_bf16_f32 v43, v134, v135
v_cvt_pk_bf16_f32 v44, v136, v137
v_cvt_pk_bf16_f32 v45, v138, v139
v_cvt_pk_bf16_f32 v46, v140, v141
v_cvt_pk_bf16_f32 v47, v142, v143
v_cvt_pk_bf16_f32 v48, v144, v145
v_cvt_pk_bf16_f32 v49, v146, v147
v_cvt_pk_bf16_f32 v50, v148, v149
v_cvt_pk_bf16_f32 v51, v150, v151
v_cvt_pk_bf16_f32 v52, v152, v153
v_cvt_pk_bf16_f32 v53, v154, v155
v_cvt_pk_bf16_f32 v54, v156, v157
v_cvt_pk_bf16_f32 v55, v158, v159
v_cvt_pk_bf16_f32 v56, v160, v161
v_cvt_pk_bf16_f32 v57, v162, v163
v_cvt_pk_bf16_f32 v58, v164, v165
v_cvt_pk_bf16_f32 v59, v166, v167
v_cvt_pk_bf16_f32 v60, v168, v169
v_cvt_pk_bf16_f32 v61, v170, v171
v_cvt_pk_bf16_f32 v62, v172, v173
v_cvt_pk_bf16_f32 v63, v174, v175
v_cvt_pk_bf16_f32 v64, v176, v177
v_cvt_pk_bf16_f32 v65, v178, v179
v_cvt_pk_bf16_f32 v66, v180, v181
v_cvt_pk_bf16_f32 v67, v182, v183
v_cvt_pk_bf16_f32 v68, v184, v185
v_cvt_pk_bf16_f32 v69, v186, v187
v_cvt_pk_bf16_f32 v70, v188, v189
v_cvt_pk_bf16_f32 v71, v190, v191
v_mfma_f32_16x16x32_bf16 v[124:127], v[192:195], a[120:123], 0
v_lshrrev_b32 v248, 4, v1
v_and_b32 v249, 1, v248
v_mfma_f32_16x16x32_bf16 v[124:127], v[196:199], a[120:123], v[124:127]
s_mul_i32 s11, s60, 80
s_lshr_b32 s11, s11, 6
v_mfma_f32_16x16x32_bf16 v[124:127], v[200:203], a[124:127], v[124:127]
v_add_u32 v250, s11, v2
v_lshlrev_b32 v250, 8, v250
v_mfma_f32_16x16x32_bf16 v[124:127], v[204:207], a[124:127], v[124:127]
v_lshl_add_u32 v18, v249, 12, v250
v_lshlrev_b32 v5, 9, v248
v_mfma_f32_16x16x32_bf16 v[124:127], v[208:211], a[128:131], v[124:127]
v_lshl_add_u32 v5, v21, 4, v5
v_add_u32 v6, 40960, v5
v_mfma_f32_16x16x32_bf16 v[124:127], v[212:215], a[128:131], v[124:127]
v_min_u32 v248, 7, v1
v_lshlrev_b32 v7, 7, v248
v_mfma_f32_16x16x32_bf16 v[124:127], v[216:219], a[132:135], v[124:127]
v_mul_u32_u24 v248, 208, v21
v_lshl_add_u32 v248, v2, 5, v248
v_mfma_f32_16x16x32_bf16 v[124:127], v[220:223], a[132:135], v[124:127]
v_and_b32 v249, 16, v1
v_lshlrev_b32 v16, 5, v249
v_mfma_f32_16x16x32_bf16 v[124:127], v[224:227], a[136:139], v[124:127]
v_lshrrev_b32 v249, 1, v249
v_add_u32 v248, 57344, v248
v_mfma_f32_16x16x32_bf16 v[124:127], v[228:231], a[136:139], v[124:127]
v_add_u32 v4, v248, v249
v_lshl_add_u32 v16, v2, 8, v16
v_mfma_f32_16x16x32_bf16 v[72:75], v[192:195], v[32:35], 0
v_lshl_add_u32 v16, v21, 4, v16
v_add_u32 v17, 4096, v16
v_mfma_f32_16x16x32_bf16 v[72:75], v[196:199], v[36:39], v[72:75]
s_nop 0
v_mfma_f32_16x16x32_bf16 v[76:79], v[192:195], v[40:43], 0
v_mfma_f32_16x16x32_bf16 v[76:79], v[196:199], v[44:47], v[76:79]
v_mfma_f32_16x16x32_bf16 v[80:83], v[200:203], v[32:35], 0
ds_write_b128 v26, v[124:127] offset:53248
v_mfma_f32_16x16x32_bf16 v[80:83], v[204:207], v[36:39], v[80:83]
v_mfma_f32_16x16x32_bf16 v[84:87], v[200:203], v[40:43], 0
s_nop 0
ds_write_b128 v26, v[72:75] offset:0
v_mfma_f32_16x16x32_bf16 v[84:87], v[204:207], v[44:47], v[84:87]
v_mfma_f32_16x16x32_bf16 v[88:91], v[200:203], v[48:51], 0
ds_write_b128 v26, v[76:79] offset:4096
v_mfma_f32_16x16x32_bf16 v[88:91], v[204:207], v[52:55], v[88:91]
v_mfma_f32_16x16x32_bf16 v[92:95], v[208:211], v[40:43], 0
ds_write_b128 v26, v[80:83] offset:8192
v_mfma_f32_16x16x32_bf16 v[92:95], v[212:215], v[44:47], v[92:95]
v_mfma_f32_16x16x32_bf16 v[96:99], v[208:211], v[48:51], 0
s_nop 0
ds_write_b128 v26, v[84:87] offset:12288
v_mfma_f32_16x16x32_bf16 v[96:99], v[212:215], v[52:55], v[96:99]
v_mfma_f32_16x16x32_bf16 v[100:103], v[208:211], v[56:59], 0
ds_write_b128 v26, v[88:91] offset:16384
v_mfma_f32_16x16x32_bf16 v[100:103], v[212:215], v[60:63], v[100:103]
v_mfma_f32_16x16x32_bf16 v[104:107], v[216:219], v[48:51], 0
ds_write_b128 v26, v[92:95] offset:20480
v_mfma_f32_16x16x32_bf16 v[104:107], v[220:223], v[52:55], v[104:107]
v_mfma_f32_16x16x32_bf16 v[108:111], v[216:219], v[56:59], 0
s_nop 0
ds_write_b128 v26, v[96:99] offset:24576
v_mfma_f32_16x16x32_bf16 v[108:111], v[220:223], v[60:63], v[108:111]
v_mfma_f32_16x16x32_bf16 v[112:115], v[216:219], v[64:67], 0
ds_write_b128 v26, v[100:103] offset:28672
v_mfma_f32_16x16x32_bf16 v[112:115], v[220:223], v[68:71], v[112:115]
v_mfma_f32_16x16x32_bf16 v[116:119], v[224:227], v[56:59], 0
ds_write_b128 v26, v[104:107] offset:32768
v_mfma_f32_16x16x32_bf16 v[116:119], v[228:231], v[60:63], v[116:119]
v_mfma_f32_16x16x32_bf16 v[120:123], v[224:227], v[64:67], 0
s_nop 0
ds_write_b128 v26, v[108:111] offset:36864
v_mfma_f32_16x16x32_bf16 v[120:123], v[228:231], v[68:71], v[120:123]
buffer_load_dwordx2 v[8:9], v18, s[48:51], s84 offen sc1
ds_write_b128 v26, v[112:115] offset:40960
s_nop 1
ds_write_b128 v26, v[116:119] offset:45056
s_nop 2
ds_write_b128 v26, v[120:123] offset:49152
s_waitcnt lgkmcnt(0)
s_barrier
ds_read_b128 v[32:35], v240 offset:0
ds_read_b128 v[36:39], v240 offset:1024
ds_read_b128 v[40:43], v240 offset:2048
ds_read_b128 v[44:47], v240 offset:3072
ds_read_b128 v[48:51], v241 offset:0
ds_read_b128 v[52:55], v241 offset:1024
ds_read_b128 v[56:59], v241 offset:2048
ds_read_b128 v[60:63], v241 offset:3072
s_waitcnt lgkmcnt(4)
v_pk_add_f32 v[32:33], v[32:33], v[36:37]
v_pk_add_f32 v[40:41], v[40:41], v[44:45]
v_pk_add_f32 v[34:35], v[34:35], v[38:39]
v_pk_add_f32 v[42:43], v[42:43], v[46:47]
v_pk_add_f32 v[32:33], v[32:33], v[40:41]
v_pk_add_f32 v[34:35], v[34:35], v[42:43]
buffer_store_dwordx4 v[32:35], v27, s[48:51], s81 offen offset:0 sc1
s_waitcnt lgkmcnt(0)
v_pk_add_f32 v[48:49], v[48:49], v[52:53]
v_pk_add_f32 v[56:57], v[56:57], v[60:61]
v_pk_add_f32 v[50:51], v[50:51], v[54:55]
v_pk_add_f32 v[58:59], v[58:59], v[62:63]
v_pk_add_f32 v[48:49], v[48:49], v[56:57]
v_pk_add_f32 v[50:51], v[50:51], v[58:59]
buffer_store_dwordx4 v[48:51], v27, s[48:51], s81 offen offset:1024 sc1
s_waitcnt vmcnt(2)
v_cmp_ne_u64 vcc, s[8:9], v[8:9]
s_cbranch_vccz L_chk11x
s_waitcnt vmcnt(0)
s_mov_b64 exec, 0xffff
buffer_store_dwordx2 v[252:253], v254, s[48:51], s83 offen sc1
s_mov_b64 exec, -1
s_mov_b32 s10, 0x20000
L_chk11:
buffer_load_dwordx2 v[8:9], v18, s[48:51], s84 offen sc1
s_sub_u32 s10, s10, 1
s_waitcnt vmcnt(0)
s_cbranch_scc1 L_chk11x
v_cmp_ne_u64 vcc, s[8:9], v[8:9]
s_cbranch_vccnz L_chk11
L_chk11x:
buffer_load_dwordx4 a[52:55], v5, s[48:51], s85 offen offset:0 sc1
buffer_load_dwordx4 a[56:59], v5, s[48:51], s85 offen offset:256 sc1
buffer_load_dwordx4 a[60:63], v6, s[48:51], s85 offen offset:0 sc1
buffer_load_dwordx4 a[64:67], v6, s[48:51], s85 offen offset:256 sc1
s_add_u32 s85, s85, 2048
buffer_load_dwordx4 a[68:71], v5, s[48:51], s85 offen offset:0 sc1
buffer_load_dwordx4 a[72:75], v5, s[48:51], s85 offen offset:256 sc1
buffer_load_dwordx4 a[76:79], v6, s[48:51], s85 offen offset:0 sc1
buffer_load_dwordx4 a[80:83], v6, s[48:51], s85 offen offset:256 sc1
s_add_u32 s85, s85, 2048
buffer_load_dwordx4 a[84:87], v5, s[48:51], s85 offen offset:0 sc1
buffer_load_dwordx4 a[88:91], v5, s[48:51], s85 offen offset:256 sc1
buffer_load_dwordx4 a[92:95], v6, s[48:51], s85 offen offset:0 sc1
buffer_load_dwordx4 a[96:99], v6, s[48:51], s85 offen offset:256 sc1
s_waitcnt vmcnt(12)
s_mov_b64 exec, 0xffff
buffer_store_dwordx2 v[252:253], v254, s[48:51], s83 offen sc1
s_mov_b64 exec, -1
buffer_load_dwordx4 v[160:163], v23, s[48:51], s23 offen offset:0 sc1
s_mul_i32 s23, s21, 20
s_add_u32 s23, s23, s22
buffer_load_dwordx4 v[164:167], v22, s[48:51], s23 offen offset:0 sc1
buffer_load_dwordx4 v[168:171], v22, s[48:51], s23 offen offset:1024 sc1
buffer_load_dwordx4 v[172:175], v22, s[48:51], s23 offen offset:2048 sc1
buffer_load_dwordx4 v[176:179], v22, s[48:51], s23 offen offset:3072 sc1
buffer_load_dwordx4 v[180:183], v23, s[48:51], s23 offen offset:0 sc1
s_mul_i32 s23, s73, 20
s_add_u32 s23, s23, s31
buffer_load_dwordx4 v[184:187], v22, s[48:51], s23 offen offset:0 sc1
buffer_load_dwordx4 v[188:191], v22, s[48:51], s23 offen offset:1024 sc1
buffer_load_dwordx4 v[192:195], v22, s[48:51], s23 offen offset:2048 sc1
buffer_load_dwordx4 v[196:199], v22, s[48:51], s23 offen offset:3072 sc1
s_mov_b32 s10, 0x20000
L_poll12:
buffer_load_dwordx2 v[248:249], v7, s[48:51], s82 offen sc1
s_sub_u32 s10, s10, 1
s_waitcnt vmcnt(0)
s_cbranch_scc1 L_poll12x
v_cmp_ne_u64 vcc, s[8:9], v[248:249]
s_cbranch_vccnz L_poll12
L_poll12x:
buffer_load_dwordx4 v[32:35], v27, s[48:51], s80 offen offset:0 sc1
buffer_load_dwordx4 v[64:67], v27, s[48:51], s80 offen offset:1024 sc1
s_add_u32 s80, s80, 8192
buffer_load_dwordx4 v[36:39], v27, s[48:51], s80 offen offset:0 sc1
buffer_load_dwordx4 v[68:71], v27, s[48:51], s80 offen offset:1024 sc1
s_add_u32 s80, s80, 8192
buffer_load_dwordx4 v[40:43], v27, s[48:51], s80 offen offset:0 sc1
buffer_load_dwordx4 v[72:75], v27, s[48:51], s80 offen offset:1024 sc1
s_add_u32 s80, s80, 8192
buffer_load_dwordx4 v[44:47], v27, s[48:51], s80 offen offset:0 sc1
buffer_load_dwordx4 v[76:79], v27, s[48:51], s80 offen offset:1024 sc1
s_add_u32 s80, s80, 8192
buffer_load_dwordx4 v[48:51], v27, s[48:51], s80 offen offset:0 sc1
buffer_load_dwordx4 v[80:83], v27, s[48:51], s80 offen offset:1024 sc1
s_add_u32 s80, s80, 8192
buffer_load_dwordx4 v[52:55], v27, s[48:51], s80 offen offset:0 sc1
buffer_load_dwordx4 v[84:87], v27, s[48:51], s80 offen offset:1024 sc1
s_add_u32 s80, s80, 8192
buffer_load_dwordx4 v[56:59], v27, s[48:51], s80 offen offset:0 sc1
buffer_load_dwordx4 v[88:91], v27, s[48:51], s80 offen offset:1024 sc1
s_add_u32 s80, s80, 8192
buffer_load_dwordx4 v[60:63], v27, s[48:51], s80 offen offset:0 sc1
buffer_load_dwordx4 v[92:95], v27, s[48:51], s80 offen offset:1024 sc1
s_mov_b64 s[86:87], 0xffff
s_mov_b32 s88, -1
s_mov_b32 s89, 0
s_mov_b32 s90, -1
s_mov_b32 s91, 0xffff
s_waitcnt vmcnt(12)
v_pk_add_f32 v[32:33], v[32:33], v[36:37]
v_pk_add_f32 v[34:35], v[34:35], v[38:39]
v_pk_add_f32 v[64:65], v[64:65], v[68:69]
v_pk_add_f32 v[66:67], v[66:67], v[70:71]
s_waitcnt vmcnt(10)
v_pk_add_f32 v[32:33], v[32:33], v[40:41]
v_pk_add_f32 v[34:35], v[34:35], v[42:43]
v_pk_add_f32 v[64:65], v[64:65], v[72:73]
v_pk_add_f32 v[66:67], v[66:67], v[74:75]
s_waitcnt vmcnt(8)
v_pk_add_f32 v[32:33], v[32:33], v[44:45]
v_pk_add_f32 v[34:35], v[34:35], v[46:47]
v_pk_add_f32 v[64:65], v[64:65], v[76:77]
v_pk_add_f32 v[66:67], v[66:67], v[78:79]
s_waitcnt vmcnt(6)
v_pk_add_f32 v[32:33], v[32:33], v[48:49]
v_pk_add_f32 v[34:35], v[34:35], v[50:51]
v_pk_add_f32 v[64:65], v[64:65], v[80:81]
v_pk_add_f32 v[66:67], v[66:67], v[82:83]
s_waitcnt vmcnt(4)
v_pk_add_f32 v[32:33], v[32:33], v[52:53]
v_pk_add_f32 v[34:35], v[34:35], v[54:55]
v_pk_add_f32 v[64:65], v[64:65], v[84:85]
v_pk_add_f32 v[66:67], v[66:67], v[86:87]
s_waitcnt vmcnt(2)
v_pk_add_f32 v[32:33], v[32:33], v[56:57]
v_pk_add_f32 v[34:35], v[34:35], v[58:59]
v_pk_add_f32 v[64:65], v[64:65], v[88:89]
v_pk_add_f32 v[66:67], v[66:67], v[90:91]
s_waitcnt vmcnt(0)
v_pk_add_f32 v[32:33], v[32:33], v[60:61]
v_pk_add_f32 v[34:35], v[34:35], v[62:63]
v_pk_add_f32 v[64:65], v[64:65], v[92:93]
v_pk_add_f32 v[66:67], v[66:67], v[94:95]
v_cvt_pk_bf16_f32 v32, v32, v33
v_cvt_pk_bf16_f32 v33, v34, v35
ds_write_b64 v242, v[32:33] offset:57344
v_cvt_pk_bf16_f32 v64, v64, v65
v_cvt_pk_bf16_f32 v65, v66, v67
ds_write_b64 v243, v[64:65] offset:57344
buffer_load_dwordx4 v[200:203], v23, s[48:51], s23 offen offset:0 sc1
s_mul_i32 s23, s74, 20
s_add_u32 s23, s23, s31
buffer_load_dwordx4 v[204:207], v22, s[48:51], s23 offen offset:0 sc1
s_waitcnt lgkmcnt(0)
s_barrier
ds_read_b64 a[144:145], v4 offset:16640
ds_read_b64 a[146:147], v4 offset:16656
ds_read_b64 a[100:101], v4 offset:0
ds_read_b64 a[102:103], v4 offset:16
ds_read_b64 a[108:109], v4 offset:3328
ds_read_b64 a[110:111], v4 offset:3344
ds_read_b64 a[116:117], v4 offset:6656
ds_read_b64 a[118:119], v4 offset:6672
ds_read_b64 a[148:149], v4 offset:16704
ds_read_b64 a[150:151], v4 offset:16720
ds_read_b64 a[104:105], v4 offset:64
ds_read_b64 a[106:107], v4 offset:80
ds_read_b64 a[112:113], v4 offset:3392
ds_read_b64 a[114:115], v4 offset:3408
ds_read_b64 a[120:121], v4 offset:6720
ds_read_b64 a[122:123], v4 offset:6736
ds_read_b64 a[128:129], v4 offset:10048
ds_read_b64 a[130:131], v4 offset:10064
ds_read_b64 a[136:137], v4 offset:13376
ds_read_b64 a[138:139], v4 offset:13392
ds_read_b64 a[152:153], v4 offset:16768
ds_read_b64 a[154:155], v4 offset:16784
ds_read_b64 a[124:125], v4 offset:6784
ds_read_b64 a[126:127], v4 offset:6800
ds_read_b64 a[132:133], v4 offset:10112
ds_read_b64 a[134:135], v4 offset:10128
ds_read_b64 a[140:141], v4 offset:13440
ds_read_b64 a[142:143], v4 offset:13456
s_waitcnt lgkmcnt(15)
v_mfma_f32_16x16x32_bf16 v[52:55], a[144:147], a[52:55], 0
v_mfma_f32_16x16x32_bf16 v[32:35], a[100:103], a[52:55], 0
v_mfma_f32_16x16x32_bf16 v[36:39], a[108:111], a[52:55], 0
v_mfma_f32_16x16x32_bf16 v[40:43], a[116:119], a[52:55], 0
buffer_load_dwordx4 v[208:211], v22, s[48:51], s23 offen offset:1024 sc1
v_mfma_f32_16x16x32_bf16 v[76:79], a[144:147], a[56:59], 0
v_mfma_f32_16x16x32_bf16 v[56:59], a[100:103], a[56:59], 0
v_mfma_f32_16x16x32_bf16 v[60:63], a[108:111], a[56:59], 0
v_mfma_f32_16x16x32_bf16 v[64:67], a[116:119], a[56:59], 0
buffer_load_dwordx4 v[212:215], v22, s[48:51], s23 offen offset:2048 sc1
s_waitcnt lgkmcnt(8)
v_mfma_f32_16x16x32_bf16 v[52:55], a[148:151], a[68:71], v[52:55]
v_mfma_f32_16x16x32_bf16 v[32:35], a[104:107], a[68:71], v[32:35]
v_mfma_f32_16x16x32_bf16 v[36:39], a[112:115], a[68:71], v[36:39]
v_mfma_f32_16x16x32_bf16 v[40:43], a[120:123], a[68:71], v[40:43]
buffer_load_dwordx4 v[216:219], v22, s[48:51], s23 offen offset:3072 sc1
v_mfma_f32_16x16x32_bf16 v[44:47], a[128:131], a[68:71], 0
v_mfma_f32_16x16x32_bf16 v[48:51], a[136:139], a[68:71], 0
v_mfma_f32_16x16x32_bf16 v[76:79], a[148:151], a[72:75], v[76:79]
v_mfma_f32_16x16x32_bf16 v[56:59], a[104:107], a[72:75], v[56:59]
buffer_load_dwordx4 v[220:223], v23, s[48:51], s23 offen offset:0 sc1
v_mfma_f32_16x16x32_bf16 v[60:63], a[112:115], a[72:75], v[60:63]
v_mfma_f32_16x16x32_bf16 v[64:67], a[120:123], a[72:75], v[64:67]
v_mfma_f32_16x16x32_bf16 v[68:71], a[128:131], a[72:75], 0
v_mfma_f32_16x16x32_bf16 v[72:75], a[136:139], a[72:75], 0
s_mul_i32 s23, s1, 20
s_add_u32 s23, s23, s22
s_add_u32 s23, s23, 81920
buffer_load_dwordx4 a[0:3], v22, s[48:51], s23 offen offset:0 sc1
s_waitcnt lgkmcnt(0)
v_mfma_f32_16x16x32_bf16 v[52:55], a[152:155], a[84:87], v[52:55]
v_mfma_f32_16x16x32_bf16 v[40:43], a[124:127], a[84:87], v[40:43]
v_mfma_f32_16x16x32_bf16 v[44:47], a[132:135], a[84:87], v[44:47]
v_mfma_f32_16x16x32_bf16 v[48:51], a[140:143], a[84:87], v[48:51]
buffer_load_dwordx4 a[4:7], v22, s[48:51], s23 offen offset:1024 sc1
v_mfma_f32_16x16x32_bf16 v[76:79], a[152:155], a[88:91], v[76:79]
v_mfma_f32_16x16x32_bf16 v[64:67], a[124:127], a[88:91], v[64:67]
v_mfma_f32_16x16x32_bf16 v[68:71], a[132:135], a[88:91], v[68:71]
v_mfma_f32_16x16x32_bf16 v[72:75], a[140:143], a[88:91], v[72:75]
buffer_load_dwordx4 a[8:11], v22, s[48:51], s23 offen offset:2048 sc1
v_mfma_f32_16x16x32_bf16 v[100:103], a[144:147], a[60:63], 0
v_add_f32 v52, 0x358637bd, v52
v_add_f32 v53, 0x358637bd, v53
v_mfma_f32_16x16x32_bf16 v[80:83], a[100:103], a[60:63], 0
v_add_f32 v54, 0x358637bd, v54
v_add_f32 v55, 0x358637bd, v55
v_mfma_f32_16x16x32_bf16 v[84:87], a[108:111], a[60:63], 0
v_rcp_f32 v52, v52
v_rcp_f32 v53, v53
v_mfma_f32_16x16x32_bf16 v[88:91], a[116:119], a[60:63], 0
buffer_load_dwordx4 a[12:15], v22, s[48:51], s23 offen offset:3072 sc1
v_rcp_f32 v54, v54
v_rcp_f32 v55, v55
v_mfma_f32_16x16x32_bf16 v[124:127], a[144:147], a[64:67], 0
v_cndmask_b32 v8, v53, v52, s[86:87]
v_cndmask_b32 v10, v54, v53, s[88:89]
v_mfma_f32_16x16x32_bf16 v[104:107], a[100:103], a[64:67], 0
v_cndmask_b32 v12, v55, v54, s[90:91]
v_mov_b32 v14, v55
v_mfma_f32_16x16x32_bf16 v[108:111], a[108:111], a[64:67], 0
v_mul_f32 v32, v32, v52
v_mul_f32 v33, v33, v52
v_mfma_f32_16x16x32_bf16 v[112:115], a[116:119], a[64:67], 0
buffer_load_dwordx4 a[16:19], v23, s[48:51], s23 offen offset:0 sc1
v_mul_f32 v34, v34, v52
v_mul_f32 v35, v35, v52
v_mfma_f32_16x16x32_bf16 v[100:103], a[148:151], a[76:79], v[100:103]
v_mul_f32 v36, v36, v8
v_mul_f32 v37, v37, v8
v_mfma_f32_16x16x32_bf16 v[80:83], a[104:107], a[76:79], v[80:83]
v_mul_f32 v38, v38, v8
v_mul_f32 v39, v39, v8
v_mfma_f32_16x16x32_bf16 v[84:87], a[112:115], a[76:79], v[84:87]
v_mul_f32 v40, v40, v10
v_mul_f32 v41, v41, v10
v_mfma_f32_16x16x32_bf16 v[88:91], a[120:123], a[76:79], v[88:91]
s_mul_i32 s23, s18, 20
s_add_u32 s23, s23, s22
s_add_u32 s23, s23, 81920
buffer_load_dwordx4 a[20:23], v22, s[48:51], s23 offen offset:0 sc1
v_mul_f32 v42, v42, v10
v_mul_f32 v43, v43, v10
v_mfma_f32_16x16x32_bf16 v[92:95], a[128:131], a[76:79], 0
v_mul_f32 v44, v44, v12
v_mul_f32 v45, v45, v12
v_mfma_f32_16x16x32_bf16 v[96:99], a[136:139], a[76:79], 0
v_mul_f32 v46, v46, v12
v_mul_f32 v47, v47, v12
v_mfma_f32_16x16x32_bf16 v[124:127], a[148:151], a[80:83], v[124:127]
v_mul_f32 v48, v48, v14
v_mul_f32 v49, v49, v14
v_mfma_f32_16x16x32_bf16 v[104:107], a[104:107], a[80:83], v[104:107]
buffer_load_dwordx4 a[24:27], v22, s[48:51], s23 offen offset:1024 sc1
v_mul_f32 v50, v50, v14
v_mul_f32 v51, v51, v14
v_mfma_f32_16x16x32_bf16 v[108:111], a[112:115], a[80:83], v[108:111]
v_cvt_pk_bf16_f32 v128, v32, v33
v_cvt_pk_bf16_f32 v129, v34, v35
v_mfma_f32_16x16x32_bf16 v[112:115], a[120:123], a[80:83], v[112:115]
v_cvt_pk_bf16_f32 v132, v36, v37
v_cvt_pk_bf16_f32 v133, v38, v39
v_mfma_f32_16x16x32_bf16 v[116:119], a[128:131], a[80:83], 0
v_cvt_pk_bf16_f32 v136, v40, v41
v_cvt_pk_bf16_f32 v137, v42, v43
v_mfma_f32_16x16x32_bf16 v[120:123], a[136:139], a[80:83], 0
buffer_load_dwordx4 a[28:31], v22, s[48:51], s23 offen offset:2048 sc1
v_cvt_pk_bf16_f32 v140, v44, v45
v_cvt_pk_bf16_f32 v141, v46, v47
v_mfma_f32_16x16x32_bf16 v[100:103], a[152:155], a[92:95], v[100:103]
v_cvt_pk_bf16_f32 v144, v48, v49
v_cvt_pk_bf16_f32 v145, v50, v51
v_mfma_f32_16x16x32_bf16 v[88:91], a[124:127], a[92:95], v[88:91]
v_add_f32 v76, 0x358637bd, v76
v_add_f32 v77, 0x358637bd, v77
v_mfma_f32_16x16x32_bf16 v[92:95], a[132:135], a[92:95], v[92:95]
v_add_f32 v78, 0x358637bd, v78
v_add_f32 v79, 0x358637bd, v79
v_mfma_f32_16x16x32_bf16 v[96:99], a[140:143], a[92:95], v[96:99]
buffer_load_dwordx4 a[32:35], v22, s[48:51], s23 offen offset:3072 sc1
v_rcp_f32 v76, v76
v_rcp_f32 v77, v77
v_mfma_f32_16x16x32_bf16 v[124:127], a[152:155], a[96:99], v[124:127]
v_rcp_f32 v78, v78
v_rcp_f32 v79, v79
v_mfma_f32_16x16x32_bf16 v[112:115], a[124:127], a[96:99], v[112:115]
v_cndmask_b32 v8, v77, v76, s[86:87]
v_cndmask_b32 v10, v78, v77, s[88:89]
v_mfma_f32_16x16x32_bf16 v[116:119], a[132:135], a[96:99], v[116:119]
v_cndmask_b32 v12, v79, v78, s[90:91]
v_mov_b32 v14, v79
v_mfma_f32_16x16x32_bf16 v[120:123], a[140:143], a[96:99], v[120:123]
buffer_load_dwordx4 a[36:39], v23, s[48:51], s23 offen offset:0 sc1
v_mul_f32 v56, v56, v76
v_mul_f32 v57, v57, v76
v_mul_f32 v58, v58, v76
v_mul_f32 v59, v59, v76
v_mul_f32 v60, v60, v8
v_mul_f32 v61, v61, v8
v_mul_f32 v62, v62, v8
v_mul_f32 v63, v63, v8
v_mul_f32 v64, v64, v10
v_mul_f32 v65, v65, v10
v_mul_f32 v66, v66, v10
v_mul_f32 v67, v67, v10
v_mul_f32 v68, v68, v12
v_mul_f32 v69, v69, v12
v_mul_f32 v70, v70, v12
v_mul_f32 v71, v71, v12
v_mul_f32 v72, v72, v14
v_mul_f32 v73, v73, v14
v_mul_f32 v74, v74, v14
v_mul_f32 v75, v75, v14
v_cvt_pk_bf16_f32 v130, v56, v57
v_cvt_pk_bf16_f32 v131, v58, v59
v_cvt_pk_bf16_f32 v134, v60, v61
v_cvt_pk_bf16_f32 v135, v62, v63
v_cvt_pk_bf16_f32 v138, v64, v65
v_cvt_pk_bf16_f32 v139, v66, v67
v_cvt_pk_bf16_f32 v142, v68, v69
v_cvt_pk_bf16_f32 v143, v70, v71
v_cvt_pk_bf16_f32 v146, v72, v73
v_cvt_pk_bf16_f32 v147, v74, v75
v_permlane32_swap_b32 v128, v130
v_permlane32_swap_b32 v129, v131
v_permlane32_swap_b32 v132, v134
v_permlane32_swap_b32 v133, v135
v_permlane32_swap_b32 v136, v138
v_permlane32_swap_b32 v137, v139
v_permlane32_swap_b32 v140, v142
v_permlane32_swap_b32 v141, v143
v_permlane32_swap_b32 v144, v146
v_permlane32_swap_b32 v145, v147
buffer_store_dwordx4 v[128:131], v16, s[48:51], s98 offen offset:0 sc1
buffer_store_dwordx4 v[132:135], v16, s[48:51], s98 offen offset:1024 sc1
buffer_store_dwordx4 v[136:139], v16, s[48:51], s98 offen offset:2048 sc1
buffer_store_dwordx4 v[140:143], v16, s[48:51], s98 offen offset:3072 sc1
buffer_store_dwordx4 v[144:147], v17, s[48:51], s98 offen offset:0 sc1
s_add_u32 s98, s98, 40960
v_add_f32 v100, 0x358637bd, v100
v_add_f32 v101, 0x358637bd, v101
v_add_f32 v102, 0x358637bd, v102
v_add_f32 v103, 0x358637bd, v103
v_rcp_f32 v100, v100
v_rcp_f32 v101, v101
v_rcp_f32 v102, v102
v_rcp_f32 v103, v103
v_cndmask_b32 v8, v101, v100, s[86:87]
v_cndmask_b32 v10, v102, v101, s[88:89]
v_cndmask_b32 v12, v103, v102, s[90:91]
v_mov_b32 v14, v103
v_pk_mul_f32 v[80:81], v[80:81], v[100:101] op_sel_hi:[1,0]
v_pk_mul_f32 v[82:83], v[82:83], v[100:101] op_sel_hi:[1,0]
s_mul_i32 s23, s19, 20
s_add_u32 s23, s23, s22
s_add_u32 s23, s23, 81920
buffer_load_dwordx4 a[40:43], v22, s[48:51], s23 offen offset:0 sc1
v_pk_mul_f32 v[84:85], v[84:85], v[8:9] op_sel_hi:[1,0]
v_pk_mul_f32 v[86:87], v[86:87], v[8:9] op_sel_hi:[1,0]
v_pk_mul_f32 v[88:89], v[88:89], v[10:11] op_sel_hi:[1,0]
v_pk_mul_f32 v[90:91], v[90:91], v[10:11] op_sel_hi:[1,0]
v_pk_mul_f32 v[92:93], v[92:93], v[12:13] op_sel_hi:[1,0]
v_pk_mul_f32 v[94:95], v[94:95], v[12:13] op_sel_hi:[1,0]
v_pk_mul_f32 v[96:97], v[96:97], v[14:15] op_sel_hi:[1,0]
v_pk_mul_f32 v[98:99], v[98:99], v[14:15] op_sel_hi:[1,0]
v_cvt_pk_bf16_f32 v224, v80, v81
v_cvt_pk_bf16_f32 v225, v82, v83
v_cvt_pk_bf16_f32 v228, v84, v85
v_cvt_pk_bf16_f32 v229, v86, v87
v_cvt_pk_bf16_f32 v232, v88, v89
v_cvt_pk_bf16_f32 v233, v90, v91
buffer_load_dwordx4 a[44:47], v22, s[48:51], s23 offen offset:1024 sc1
v_cvt_pk_bf16_f32 v236, v92, v93
v_cvt_pk_bf16_f32 v237, v94, v95
v_cvt_pk_bf16_f32 v240, v96, v97
v_cvt_pk_bf16_f32 v241, v98, v99
v_add_f32 v124, 0x358637bd, v124
v_add_f32 v125, 0x358637bd, v125
v_add_f32 v126, 0x358637bd, v126
v_add_f32 v127, 0x358637bd, v127
v_rcp_f32 v124, v124
v_rcp_f32 v125, v125
v_rcp_f32 v126, v126
v_rcp_f32 v127, v127
v_cndmask_b32 v8, v125, v124, s[86:87]
v_cndmask_b32 v10, v126, v125, s[88:89]
buffer_load_dwordx4 a[48:51], v22, s[48:51], s23 offen offset:2048 sc1
v_cndmask_b32 v12, v127, v126, s[90:91]
v_mov_b32 v14, v127
v_pk_mul_f32 v[104:105], v[104:105], v[124:125] op_sel_hi:[1,0]
v_pk_mul_f32 v[106:107], v[106:107], v[124:125] op_sel_hi:[1,0]
v_pk_mul_f32 v[108:109], v[108:109], v[8:9] op_sel_hi:[1,0]
v_pk_mul_f32 v[110:111], v[110:111], v[8:9] op_sel_hi:[1,0]
v_pk_mul_f32 v[112:113], v[112:113], v[10:11] op_sel_hi:[1,0]
v_pk_mul_f32 v[114:115], v[114:115], v[10:11] op_sel_hi:[1,0]
v_pk_mul_f32 v[116:117], v[116:117], v[12:13] op_sel_hi:[1,0]
v_pk_mul_f32 v[118:119], v[118:119], v[12:13] op_sel_hi:[1,0]
v_pk_mul_f32 v[120:121], v[120:121], v[14:15] op_sel_hi:[1,0]
v_pk_mul_f32 v[122:123], v[122:123], v[14:15] op_sel_hi:[1,0]
v_cvt_pk_bf16_f32 v226, v104, v105
v_cvt_pk_bf16_f32 v227, v106, v107
buffer_load_dwordx4 a[52:55], v22, s[48:51], s23 offen offset:3072 sc1
v_cvt_pk_bf16_f32 v230, v108, v109
v_cvt_pk_bf16_f32 v231, v110, v111
v_cvt_pk_bf16_f32 v234, v112, v113
v_cvt_pk_bf16_f32 v235, v114, v115
v_cvt_pk_bf16_f32 v238, v116, v117
v_cvt_pk_bf16_f32 v239, v118, v119
v_cvt_pk_bf16_f32 v242, v120, v121
v_cvt_pk_bf16_f32 v243, v122, v123
v_permlane32_swap_b32 v224, v226
v_permlane32_swap_b32 v225, v227
v_permlane32_swap_b32 v228, v230
v_permlane32_swap_b32 v229, v231
v_permlane32_swap_b32 v232, v234
v_permlane32_swap_b32 v233, v235
v_permlane32_swap_b32 v236, v238
v_permlane32_swap_b32 v237, v239
v_permlane32_swap_b32 v240, v242
v_permlane32_swap_b32 v241, v243
v_and_b32 v248, 1, v1
v_lshrrev_b32 v249, 1, v1
v_min_u32 v249, 2, v249
v_lshlrev_b32 v249, 8, v249
v_lshl_add_u32 v10, v248, 12, v249
v_lshlrev_b32 v11, 7, v248
s_lshl_b32 s83, s25, 13
s_mul_i32 s11, s3, 768
s_add_u32 s83, s83, s11
s_add_u32 s83, s83, 22413312
s_add_u32 s84, s83, 128
s_lshl_b32 s85, s25, 10
buffer_load_dwordx2 v[20:21], v10, s[48:51], s83 offen sc1
buffer_store_dwordx4 v[224:227], v16, s[48:51], s98 offen offset:0 sc1
buffer_store_dwordx4 v[228:231], v16, s[48:51], s98 offen offset:1024 sc1
buffer_store_dwordx4 v[232:235], v16, s[48:51], s98 offen offset:2048 sc1
buffer_store_dwordx4 v[236:239], v16, s[48:51], s98 offen offset:3072 sc1
buffer_store_dwordx4 v[240:243], v17, s[48:51], s98 offen offset:0 sc1
s_lshl_b32 s11, s3, 8
s_add_u32 s85, s85, s11
s_add_u32 s85, s85, 22708224
s_mul_i32 s86, s3, 24576
s_add_u32 s86, s86, 10485760
s_add_u32 s87, s86, 4096
s_mul_i32 s88, s3, 10240
s_add_u32 s88, s88, 7864320
v_lshl_add_u32 v29, v1, 4, s65
v_and_b32 v248, 15, v1
v_lshrrev_b32 v249, 4, v1
v_lshlrev_b32 v250, 9, v249
ds_read_b128 a[100:103], v29 offset:0
ds_read_b128 a[104:107], v29 offset:1024
ds_read_b128 a[108:111], v29 offset:2048
ds_read_b128 a[112:115], v29 offset:3072
ds_read_b128 a[116:119], v29 offset:4096
ds_read_b128 a[120:123], v29 offset:5120
ds_read_b128 a[124:127], v29 offset:6144
ds_read_b128 a[128:131], v29 offset:7168
ds_read_b128 a[132:135], v29 offset:8192
ds_read_b128 a[136:139], v29 offset:9216
ds_read_b128 a[140:143], v29 offset:10240
ds_read_b128 a[144:147], v29 offset:11264
ds_read_b128 a[148:151], v29 offset:12288
ds_read_b128 a[152:155], v29 offset:13312
ds_read_b128 a[156:159], v29 offset:14336
v_lshl_add_u32 v250, v248, 4, v250
s_add_u32 s11, s3, 0
s_and_b32 s11, s11, 3
s_lshr_b32 s12, s11, 1
s_lshl_b32 s13, s25, 1
s_add_u32 s12, s12, s13
s_and_b32 s13, s11, 1
s_lshl_b32 s13, s13, 8
s_mul_i32 s14, s12, 98304
s_add_u32 s14, s14, s13
v_add_u32 v12, s14, v250
s_mul_i32 s14, s12, 40960
buffer_load_dwordx4 a[56:59], v23, s[48:51], s23 offen offset:0 sc1
s_add_u32 s14, s14, s13
v_add_u32 v4, s14, v250
s_mul_i32 s89, s11, 15360
s_add_u32 s89, s89, 0
s_mul_i32 s13, s24, 5120
s_add_u32 s14, s14, s13
s_add_u32 s14, s14, 5242880
v_and_b32 v251, 1, v249
v_lshlrev_b32 v251, 9, v251
v_lshl_add_u32 v251, v248, 4, v251
v_lshl_add_u32 v251, v2, 3, v251
v_add_u32 v9, s14, v251
s_add_u32 s11, s3, 1
s_and_b32 s11, s11, 3
s_lshr_b32 s12, s11, 1
s_lshl_b32 s13, s25, 1
s_add_u32 s12, s12, s13
s_and_b32 s13, s11, 1
s_lshl_b32 s13, s13, 8
s_mul_i32 s14, s12, 98304
s_add_u32 s14, s14, s13
v_add_u32 v13, s14, v250
s_mul_i32 s14, s12, 40960
s_add_u32 s14, s14, s13
v_add_u32 v5, s14, v250
s_mul_i32 s90, s11, 15360
s_add_u32 s90, s90, 0
s_add_u32 s11, s3, 2
s_and_b32 s11, s11, 3
s_lshr_b32 s12, s11, 1
s_lshl_b32 s13, s25, 1
s_add_u32 s12, s12, s13
s_and_b32 s13, s11, 1
s_lshl_b32 s13, s13, 8
s_mul_i32 s14, s12, 98304
s_add_u32 s14, s14, s13
v_add_u32 v14, s14, v250
s_mul_i32 s14, s12, 40960
s_add_u32 s14, s14, s13
v_add_u32 v6, s14, v250
s_mul_i32 s91, s11, 15360
s_add_u32 s91, s91, 5120
s_add_u32 s11, s3, 3
s_and_b32 s11, s11, 3
s_lshr_b32 s12, s11, 1
s_lshl_b32 s13, s25, 1
s_add_u32 s12, s12, s13
s_and_b32 s13, s11, 1
s_lshl_b32 s13, s13, 8
s_mul_i32 s14, s12, 98304
s_add_u32 s14, s14, s13
v_add_u32 v15, s14, v250
s_mul_i32 s14, s12, 40960
s_add_u32 s14, s14, s13
v_add_u32 v7, s14, v250
s_mul_i32 s92, s11, 15360
s_add_u32 s92, s92, 10240
v_and_b32 v248, 15, v1
v_lshrrev_b32 v249, 4, v1
v_mul_u32_u24 v248, 160, v248
v_lshl_add_u32 v248, v249, 3, v248
v_add_u32 v26, s65, v248
s_lshl_b32 s11, s25, 2
s_add_u32 s11, s11, s3
s_mul_i32 s11, s11, 20480
s_mul_i32 s12, s24, 160
s_add_u32 s11, s11, s12
s_movk_i32 s13, 1120
v_add_u32 v248, 0, v1
v_mul_u32_u24 v249, 205, v248
v_lshrrev_b32 v249, 11, v249
v_lshl_add_u32 v248, v248, 4, s11
v_mad_u32_u24 v25, v249, s13, v248
v_add_u32 v248, 64, v1
v_mul_u32_u24 v249, 205, v248
v_lshrrev_b32 v249, 11, v249
v_lshl_add_u32 v248, v248, 4, s11
v_mad_u32_u24 v27, v249, s13, v248
v_add_u32 v248, 128, v1
v_mul_u32_u24 v249, 205, v248
v_lshrrev_b32 v249, 11, v249
v_lshl_add_u32 v248, v248, 4, s11
v_mad_u32_u24 v31, v249, s13, v248
s_mov_b32 s40, s16
s_mov_b32 s41, s17
s_mov_b32 s42, 2621440
s_mov_b32 s43, 0x20000
s_waitcnt lgkmcnt(0)
s_add_u32 m0, s65, 0
s_nop 0
buffer_load_dwordx4 v25, s[40:43], 0 offen lds
s_add_u32 m0, s65, 1024
s_nop 0
buffer_load_dwordx4 v27, s[40:43], 0 offen lds
s_add_u32 m0, s65, 2048
s_nop 0
buffer_load_dwordx4 v31, s[40:43], 0 offen lds
s_waitcnt vmcnt(9)
v_cmp_ne_u64 vcc, s[8:9], v[20:21]
s_cbranch_vccz L_chk13x
s_waitcnt vmcnt(0)
s_mov_b64 exec, 0xffff
buffer_store_dwordx2 v[252:253], v254, s[48:51], s99 offen sc1
s_mov_b64 exec, -1
s_mov_b32 s10, 0x20000
L_chk13:
buffer_load_dwordx2 v[20:21], v10, s[48:51], s83 offen sc1
s_sub_u32 s10, s10, 1
s_waitcnt vmcnt(0)
s_cbranch_scc1 L_chk13x
v_cmp_ne_u64 vcc, s[8:9], v[20:21]
s_cbranch_vccnz L_chk13
L_chk13x:
buffer_load_dwordx2 v[240:241], v9, s[48:51], 0 offen offset:0 sc1
buffer_load_dwordx2 v[242:243], v9, s[48:51], 0 offen offset:1024 sc1
buffer_load_dwordx2 v[244:245], v9, s[48:51], 0 offen offset:2048 sc1
buffer_load_dwordx2 v[246:247], v9, s[48:51], 0 offen offset:3072 sc1
s_movk_i32 s12, 0x1000
buffer_load_dwordx2 v[250:251], v9, s[48:51], s12 offen offset:0 sc1
s_waitcnt vmcnt(9)
s_mov_b64 exec, 0xffff
buffer_store_dwordx2 v[252:253], v254, s[48:51], s99 offen sc1
s_mov_b64 exec, -1
s_waitcnt vmcnt(6)
s_add_u32 s7, s86, s0
buffer_load_dwordx4 v[112:115], v12, s[48:51], s7 offen sc1
ds_read_b64 v[52:53], v26 offset:0
ds_read_b64 v[54:55], v26 offset:32
buffer_load_dwordx4 v[116:119], v13, s[48:51], s7 offen sc1
ds_read_b64 v[56:57], v26 offset:64
ds_read_b64 v[58:59], v26 offset:96
buffer_load_dwordx4 v[120:123], v14, s[48:51], s7 offen sc1
ds_read_b64 v[60:61], v26 offset:128
buffer_load_dwordx4 v[124:127], v15, s[48:51], s7 offen sc1
s_add_u32 s7, s86, s1
buffer_load_dwordx4 v[128:131], v12, s[48:51], s7 offen sc1
s_waitcnt lgkmcnt(0)
buffer_load_dwordx4 v[132:135], v13, s[48:51], s7 offen sc1
v_lshlrev_b32 v32, 16, v52
v_and_b32 v33, 0xffff0000, v52
buffer_load_dwordx4 v[136:139], v14, s[48:51], s7 offen sc1
v_lshlrev_b32 v34, 16, v53
v_and_b32 v35, 0xffff0000, v53
buffer_load_dwordx4 v[140:143], v15, s[48:51], s7 offen sc1
v_lshlrev_b32 v36, 16, v54
v_and_b32 v37, 0xffff0000, v54
s_add_u32 s7, s86, s18
buffer_load_dwordx4 v[144:147], v12, s[48:51], s7 offen sc1
v_lshlrev_b32 v38, 16, v55
v_and_b32 v39, 0xffff0000, v55
buffer_load_dwordx4 v[148:151], v13, s[48:51], s7 offen sc1
v_lshlrev_b32 v40, 16, v56
v_and_b32 v41, 0xffff0000, v56
buffer_load_dwordx4 v[152:155], v14, s[48:51], s7 offen sc1
v_lshlrev_b32 v42, 16, v57
v_and_b32 v43, 0xffff0000, v57
buffer_load_dwordx4 v[156:159], v15, s[48:51], s7 offen sc1
v_lshlrev_b32 v44, 16, v58
v_and_b32 v45, 0xffff0000, v58
v_lshlrev_b32 v46, 16, v59
v_and_b32 v47, 0xffff0000, v59
v_lshlrev_b32 v48, 16, v60
v_and_b32 v49, 0xffff0000, v60
v_lshlrev_b32 v50, 16, v61
v_and_b32 v51, 0xffff0000, v61
s_mov_b32 s71, 2130706432
s_branch L_b4
L_g3:
s_and_b32 s68, s2, 7
s_lshl_b32 s77, s63, 3
s_add_u32 s77, s77, s68
s_lshl_b32 s11, s77, 2
s_add_u32 s69, s11, s3
s_sub_u32 s69, 127, s69
s_mul_i32 s70, s3, 24576
s_add_u32 s70, s70, 8192
v_lshl_add_u32 v4, v250, 4, v248
s_mov_b32 s55, 0x20000
v_add_u32 v5, 9216, v4
v_add_u32 v6, 18432, v4
v_add_u32 v7, 27648, v4
s_waitcnt lgkmcnt(0)
v_lshlrev_b32 v30, 21, v1
s_mov_b32 s56, s36
s_mov_b32 s57, s37
s_mov_b32 s58, 23068672
s_mov_b32 s59, 0x20000
buffer_load_dword a97, v30, s[56:59], 0 offen
s_mov_b32 s56, s32
s_mov_b32 s57, s33
s_mov_b32 s58, 2621440
s_mov_b32 s59, 0x20000
buffer_load_dword a97, v30, s[56:59], 0 offen
s_mov_b32 s56, s28
s_mov_b32 s57, s29
s_mov_b32 s58, 1966080
s_mov_b32 s59, 0x20000
buffer_load_dword a97, v30, s[56:59], 0 offen
s_mov_b32 s56, s26
s_mov_b32 s57, s27
s_mov_b32 s58, 819200
s_mov_b32 s59, 0x20000
buffer_load_dword a97, v30, s[56:59], 0 offen
s_mov_b32 s56, s18
s_mov_b32 s57, s19
s_mov_b32 s58, 2457600
s_mov_b32 s59, 0x20000
buffer_load_dword a97, v30, s[56:59], 0 offen
s_mov_b32 s56, s34
s_mov_b32 s57, s35
s_mov_b32 s58, 256
s_mov_b32 s59, 0x20000
buffer_load_dword a97, v30, s[56:59], 0 offen
s_mov_b32 s44, s18
s_mov_b32 s45, s19
s_mov_b32 s46, 2457600
s_mov_b32 s47, 0x20000
s_mov_b32 s40, s26
s_mov_b32 s41, s27
s_mov_b32 s42, 819200
s_mov_b32 s43, 0x20000
s_lshl_b32 s11, s69, 13
v_lshl_add_u32 v9, v1, 7, s11
s_mov_b32 s11, 1048576
s_mov_b32 s12, 2097152
buffer_load_dword a98, v9, s[44:47], 0 offen
buffer_load_dword a98, v9, s[44:47], s11 offen
buffer_load_dword a98, v9, s[44:47], s12 offen
buffer_load_dword a98, v9, s[40:43], 0 offen
s_add_u32 s11, s69, 0
s_mul_i32 s12, s11, 6554
s_lshr_b32 s12, s12, 16
s_mul_i32 s13, s12, 10
s_sub_u32 s13, s11, s13
s_lshl_b32 s78, s11, 12
s_add_u32 s78, s78, 16777216
s_cmp_ge_u32 s11, 680
s_cselect_b32 s78, 2130706432, s78
s_cmp_ge_u32 s12, 48
s_cselect_b32 s52, s20, s30
s_cselect_b32 s53, s21, s31
s_cselect_b32 s14, 48, 0
s_cselect_b32 s54, 5, 12
s_mul_i32 s54, s54, 163840
s_sub_u32 s12, s12, s14
s_mul_i32 s12, s12, 40960
s_lshl_b32 s13, s13, 7
s_add_u32 s12, s12, s13
s_add_u32 m0, s70, 0
s_nop 0
buffer_load_dwordx4 v4, s[52:55], s12 offen offset:0 lds
buffer_load_dwordx4 v5, s[52:55], s12 offen offset:1024 lds
buffer_load_dwordx4 v6, s[52:55], s12 offen offset:2048 lds
buffer_load_dwordx4 v7, s[52:55], s12 offen offset:3072 lds
s_add_u32 s11, s69, 128
s_mul_i32 s12, s11, 6554
s_lshr_b32 s12, s12, 16
s_mul_i32 s13, s12, 10
s_sub_u32 s13, s11, s13
s_lshl_b32 s79, s11, 12
s_add_u32 s79, s79, 16777216
s_cmp_ge_u32 s11, 680
s_cselect_b32 s79, 2130706432, s79
s_cmp_ge_u32 s12, 48
s_cselect_b32 s52, s20, s30
s_cselect_b32 s53, s21, s31
s_cselect_b32 s14, 48, 0
s_cselect_b32 s54, 5, 12
s_mul_i32 s54, s54, 163840
s_sub_u32 s12, s12, s14
s_mul_i32 s12, s12, 40960
s_lshl_b32 s13, s13, 7
s_add_u32 s12, s12, s13
s_add_u32 m0, s70, 4096
s_nop 0
buffer_load_dwordx4 v4, s[52:55], s12 offen offset:0 lds
buffer_load_dwordx4 v5, s[52:55], s12 offen offset:1024 lds
buffer_load_dwordx4 v6, s[52:55], s12 offen offset:2048 lds
buffer_load_dwordx4 v7, s[52:55], s12 offen offset:3072 lds
s_add_u32 s11, s69, 256
s_mul_i32 s12, s11, 6554
s_lshr_b32 s12, s12, 16
s_mul_i32 s13, s12, 10
s_sub_u32 s13, s11, s13
s_lshl_b32 s80, s11, 12
s_add_u32 s80, s80, 16777216
s_cmp_ge_u32 s11, 680
s_cselect_b32 s80, 2130706432, s80
s_cmp_ge_u32 s12, 48
s_cselect_b32 s52, s20, s30
s_cselect_b32 s53, s21, s31
s_cselect_b32 s14, 48, 0
s_cselect_b32 s54, 5, 12
s_mul_i32 s54, s54, 163840
s_sub_u32 s12, s12, s14
s_mul_i32 s12, s12, 40960
s_lshl_b32 s13, s13, 7
s_add_u32 s12, s12, s13
s_add_u32 m0, s70, 8192
s_nop 0
buffer_load_dwordx4 v4, s[52:55], s12 offen offset:0 lds
buffer_load_dwordx4 v5, s[52:55], s12 offen offset:1024 lds
buffer_load_dwordx4 v6, s[52:55], s12 offen offset:2048 lds
buffer_load_dwordx4 v7, s[52:55], s12 offen offset:3072 lds
s_add_u32 s11, s69, 384
s_mul_i32 s12, s11, 6554
s_lshr_b32 s12, s12, 16
s_mul_i32 s13, s12, 10
s_sub_u32 s13, s11, s13
s_lshl_b32 s81, s11, 12
s_add_u32 s81, s81, 16777216
s_cmp_ge_u32 s11, 680
s_cselect_b32 s81, 2130706432, s81
s_cmp_ge_u32 s12, 48
s_cselect_b32 s52, s20, s30
s_cselect_b32 s53, s21, s31
s_cselect_b32 s14, 48, 0
s_cselect_b32 s54, 5, 12
s_mul_i32 s54, s54, 163840
s_sub_u32 s12, s12, s14
s_mul_i32 s12, s12, 40960
s_lshl_b32 s13, s13, 7
s_add_u32 s12, s12, s13
s_add_u32 m0, s70, 12288
s_nop 0
buffer_load_dwordx4 v4, s[52:55], s12 offen offset:0 lds
buffer_load_dwordx4 v5, s[52:55], s12 offen offset:1024 lds
buffer_load_dwordx4 v6, s[52:55], s12 offen offset:2048 lds
buffer_load_dwordx4 v7, s[52:55], s12 offen offset:3072 lds
s_add_u32 s11, s69, 512
s_mul_i32 s12, s11, 6554
s_lshr_b32 s12, s12, 16
s_mul_i32 s13, s12, 10
s_sub_u32 s13, s11, s13
s_lshl_b32 s82, s11, 12
s_add_u32 s82, s82, 16777216
s_cmp_ge_u32 s11, 680
s_cselect_b32 s82, 2130706432, s82
s_cmp_ge_u32 s12, 48
s_cselect_b32 s52, s20, s30
s_cselect_b32 s53, s21, s31
s_cselect_b32 s14, 48, 0
s_cselect_b32 s54, 5, 12
s_mul_i32 s54, s54, 163840
s_sub_u32 s12, s12, s14
s_mul_i32 s12, s12, 40960
s_lshl_b32 s13, s13, 7
s_add_u32 s12, s12, s13
s_add_u32 m0, s70, 16384
s_nop 0
buffer_load_dwordx4 v4, s[52:55], s12 offen offset:0 lds
buffer_load_dwordx4 v5, s[52:55], s12 offen offset:1024 lds
buffer_load_dwordx4 v6, s[52:55], s12 offen offset:2048 lds
buffer_load_dwordx4 v7, s[52:55], s12 offen offset:3072 lds
s_add_u32 s11, s69, 640
s_mul_i32 s12, s11, 6554
s_lshr_b32 s12, s12, 16
s_mul_i32 s13, s12, 10
s_sub_u32 s13, s11, s13
s_lshl_b32 s83, s11, 12
s_add_u32 s83, s83, 16777216
s_cmp_ge_u32 s11, 680
s_cselect_b32 s83, 2130706432, s83
s_cmp_ge_u32 s12, 48
s_cselect_b32 s52, s20, s30
s_cselect_b32 s53, s21, s31
s_cselect_b32 s14, 48, 0
s_cselect_b32 s54, 5, 12
s_mul_i32 s54, s54, 163840
s_sub_u32 s12, s12, s14
s_mul_i32 s12, s12, 40960
s_lshl_b32 s13, s13, 7
s_add_u32 s12, s12, s13
s_add_u32 m0, s70, 20480
s_nop 0
buffer_load_dwordx4 v4, s[52:55], s12 offen offset:0 lds
buffer_load_dwordx4 v5, s[52:55], s12 offen offset:1024 lds
buffer_load_dwordx4 v6, s[52:55], s12 offen offset:2048 lds
buffer_load_dwordx4 v7, s[52:55], s12 offen offset:3072 lds
s_mov_b32 s48, s36
s_mov_b32 s49, s37
s_mov_b32 s50, 23068672
s_mov_b32 s51, 0x20000
s_mov_b32 s56, s34
s_mov_b32 s57, s35
s_mov_b32 s58, 256
s_mov_b32 s59, 0x20000
s_mov_b32 s44, s28
s_mov_b32 s45, s29
s_mov_b32 s46, 1966080
s_mov_b32 s47, 0x20000
v_lshlrev_b32 v9, 4, v1
v_lshrrev_b32 v248, 3, v1
v_mul_u32_u24 v248, 3072, v248
v_lshl_add_u32 v10, v250, 4, v248
s_mul_i32 s71, s3, 491520
s_lshl_b32 s11, s77, 7
s_add_u32 s71, s71, s11
s_add_u32 s76, s11, 22740992
s_cmp_ge_u32 s77, 24
s_cselect_b32 s71, 2130706432, s71
s_cmp_lg_u32 s3, 0
s_cselect_b32 s76, 2130706432, s76
s_add_u32 s73, s76, 4096
s_mov_b32 s74, 0x3f80
s_mov_b32 s75, 0x3f800000
v_and_b32 v248, 15, v1
v_lshrrev_b32 v249, 2, v3
v_lshl_add_u32 v249, v2, 4, v249
v_and_b32 v248, 3, v248
v_lshlrev_b32 v248, 3, v248
v_lshl_add_u32 v248, v249, 7, v248
v_add_u32 v8, s70, v248
v_and_b32 v248, 15, v1
v_lshlrev_b32 v248, 3, v248
s_sub_u32 s14, s73, s76
v_mul_lo_u32 v249, v2, s14
v_mov_b64 v[250:251], 0
v_add_u32 v248, v248, v249
buffer_store_dwordx2 v[250:251], v248, s[48:51], s76 offen sc1
v_lshlrev_b32 v254, 3, v1
buffer_load_dwordx2 v[252:253], off, s[56:59], 0 sc1
s_waitcnt vmcnt(22)
ds_read_b64_tr_b16 v[32:33], v8 offset:0
ds_read_b64_tr_b16 v[34:35], v8 offset:1024
ds_read_b64_tr_b16 v[36:37], v8 offset:32
ds_read_b64_tr_b16 v[38:39], v8 offset:1056
ds_read_b64_tr_b16 v[40:41], v8 offset:64
ds_read_b64_tr_b16 v[42:43], v8 offset:1088
ds_read_b64_tr_b16 v[44:45], v8 offset:96
ds_read_b64_tr_b16 v[46:47], v8 offset:1120
s_waitcnt lgkmcnt(0)
buffer_store_dwordx4 v[32:35], v9, s[48:51], s78 offen offset:0 sc1
buffer_store_dwordx4 v[36:39], v9, s[48:51], s78 offen offset:1024 sc1
buffer_store_dwordx4 v[40:43], v9, s[48:51], s78 offen offset:2048 sc1
buffer_store_dwordx4 v[44:47], v9, s[48:51], s78 offen offset:3072 sc1
s_waitcnt vmcnt(22)
ds_read_b64_tr_b16 v[48:49], v8 offset:4096
ds_read_b64_tr_b16 v[50:51], v8 offset:5120
ds_read_b64_tr_b16 v[52:53], v8 offset:4128
ds_read_b64_tr_b16 v[54:55], v8 offset:5152
ds_read_b64_tr_b16 v[56:57], v8 offset:4160
ds_read_b64_tr_b16 v[58:59], v8 offset:5184
ds_read_b64_tr_b16 v[60:61], v8 offset:4192
ds_read_b64_tr_b16 v[62:63], v8 offset:5216
s_waitcnt lgkmcnt(0)
buffer_store_dwordx4 v[48:51], v9, s[48:51], s79 offen offset:0 sc1
buffer_store_dwordx4 v[52:55], v9, s[48:51], s79 offen offset:1024 sc1
buffer_store_dwordx4 v[56:59], v9, s[48:51], s79 offen offset:2048 sc1
buffer_store_dwordx4 v[60:63], v9, s[48:51], s79 offen offset:3072 sc1
s_waitcnt vmcnt(22)
ds_read_b64_tr_b16 v[64:65], v8 offset:8192
ds_read_b64_tr_b16 v[66:67], v8 offset:9216
ds_read_b64_tr_b16 v[68:69], v8 offset:8224
ds_read_b64_tr_b16 v[70:71], v8 offset:9248
ds_read_b64_tr_b16 v[72:73], v8 offset:8256
ds_read_b64_tr_b16 v[74:75], v8 offset:9280
ds_read_b64_tr_b16 v[76:77], v8 offset:8288
ds_read_b64_tr_b16 v[78:79], v8 offset:9312
s_waitcnt lgkmcnt(0)
buffer_store_dwordx4 v[64:67], v9, s[48:51], s80 offen offset:0 sc1
buffer_store_dwordx4 v[68:71], v9, s[48:51], s80 offen offset:1024 sc1
buffer_store_dwordx4 v[72:75], v9, s[48:51], s80 offen offset:2048 sc1
buffer_store_dwordx4 v[76:79], v9, s[48:51], s80 offen offset:3072 sc1
s_waitcnt vmcnt(22)
ds_read_b64_tr_b16 v[80:81], v8 offset:12288
ds_read_b64_tr_b16 v[82:83], v8 offset:13312
ds_read_b64_tr_b16 v[84:85], v8 offset:12320
ds_read_b64_tr_b16 v[86:87], v8 offset:13344
ds_read_b64_tr_b16 v[88:89], v8 offset:12352
ds_read_b64_tr_b16 v[90:91], v8 offset:13376
ds_read_b64_tr_b16 v[92:93], v8 offset:12384
ds_read_b64_tr_b16 v[94:95], v8 offset:13408
s_waitcnt lgkmcnt(0)
buffer_store_dwordx4 v[80:83], v9, s[48:51], s81 offen offset:0 sc1
buffer_store_dwordx4 v[84:87], v9, s[48:51], s81 offen offset:1024 sc1
buffer_store_dwordx4 v[88:91], v9, s[48:51], s81 offen offset:2048 sc1
buffer_store_dwordx4 v[92:95], v9, s[48:51], s81 offen offset:3072 sc1
s_waitcnt vmcnt(22)
ds_read_b64_tr_b16 v[96:97], v8 offset:16384
ds_read_b64_tr_b16 v[98:99], v8 offset:17408
ds_read_b64_tr_b16 v[100:101], v8 offset:16416
ds_read_b64_tr_b16 v[102:103], v8 offset:17440
ds_read_b64_tr_b16 v[104:105], v8 offset:16448
ds_read_b64_tr_b16 v[106:107], v8 offset:17472
ds_read_b64_tr_b16 v[108:109], v8 offset:16480
ds_read_b64_tr_b16 v[110:111], v8 offset:17504
s_waitcnt lgkmcnt(0)
buffer_store_dwordx4 v[96:99], v9, s[48:51], s82 offen offset:0 sc1
buffer_store_dwordx4 v[100:103], v9, s[48:51], s82 offen offset:1024 sc1
buffer_store_dwordx4 v[104:107], v9, s[48:51], s82 offen offset:2048 sc1
buffer_store_dwordx4 v[108:111], v9, s[48:51], s82 offen offset:3072 sc1
s_waitcnt vmcnt(22)
ds_read_b64_tr_b16 v[112:113], v8 offset:20480
ds_read_b64_tr_b16 v[114:115], v8 offset:21504
ds_read_b64_tr_b16 v[116:117], v8 offset:20512
ds_read_b64_tr_b16 v[118:119], v8 offset:21536
ds_read_b64_tr_b16 v[120:121], v8 offset:20544
ds_read_b64_tr_b16 v[122:123], v8 offset:21568
ds_read_b64_tr_b16 v[124:125], v8 offset:20576
ds_read_b64_tr_b16 v[126:127], v8 offset:21600
s_waitcnt lgkmcnt(0)
buffer_store_dwordx4 v[112:115], v9, s[48:51], s83 offen offset:0 sc1
buffer_store_dwordx4 v[116:119], v9, s[48:51], s83 offen offset:1024 sc1
buffer_store_dwordx4 v[120:123], v9, s[48:51], s83 offen offset:2048 sc1
buffer_store_dwordx4 v[124:127], v9, s[48:51], s83 offen offset:3072 sc1
buffer_load_dwordx4 v[128:131], v10, s[44:47], s71 offen
s_add_u32 s71, s71, 24576
buffer_load_dwordx4 v[132:135], v10, s[44:47], s71 offen
s_add_u32 s71, s71, 24576
buffer_load_dwordx4 v[136:139], v10, s[44:47], s71 offen
s_add_u32 s71, s71, 24576
buffer_load_dwordx4 v[140:143], v10, s[44:47], s71 offen
s_add_u32 s71, s71, 24576
buffer_load_dwordx4 v[144:147], v10, s[44:47], s71 offen
s_add_u32 s71, s71, 24576
buffer_load_dwordx4 v[148:151], v10, s[44:47], s71 offen
s_add_u32 s71, s71, 24576
buffer_load_dwordx4 v[152:155], v10, s[44:47], s71 offen
s_add_u32 s71, s71, 24576
buffer_load_dwordx4 v[156:159], v10, s[44:47], s71 offen
s_add_u32 s71, s71, 24576
s_waitcnt vmcnt(8)
s_mov_b32 s10, 0x20000
L_nonce14:
v_readfirstlane_b32 s8, v252
v_readfirstlane_b32 s9, v253
s_nop 0
s_cmp_lg_u32 s8, 0
s_cbranch_scc1 L_nonce14x
buffer_load_dwordx2 v[252:253], off, s[56:59], 0 sc1
s_sub_u32 s10, s10, 1
s_waitcnt vmcnt(0)
s_cbranch_scc0 L_nonce14
L_nonce14x:
s_barrier
s_mov_b64 exec, 0xffff
buffer_store_dwordx2 v[252:253], v254, s[48:51], s76 offen sc1
s_mov_b64 exec, -1
buffer_load_dwordx4 v[160:163], v10, s[44:47], s71 offen
s_add_u32 s71, s71, 24576
buffer_load_dwordx4 v[164:167], v10, s[44:47], s71 offen
s_add_u32 s71, s71, 24576
buffer_load_dwordx4 v[168:171], v10, s[44:47], s71 offen
s_add_u32 s71, s71, 24576
buffer_load_dwordx4 v[172:175], v10, s[44:47], s71 offen
s_add_u32 s71, s71, 24576
buffer_load_dwordx4 v[176:179], v10, s[44:47], s71 offen
s_add_u32 s71, s71, 24576
buffer_load_dwordx4 v[180:183], v10, s[44:47], s71 offen
s_add_u32 s71, s71, 24576
buffer_load_dwordx4 v[184:187], v10, s[44:47], s71 offen
s_add_u32 s71, s71, 24576
buffer_load_dwordx4 v[188:191], v10, s[44:47], s71 offen
s_add_u32 s71, s71, 24576
buffer_load_dwordx4 v[192:195], v10, s[44:47], s71 offen
s_add_u32 s71, s71, 24576
buffer_load_dwordx4 v[196:199], v10, s[44:47], s71 offen
s_add_u32 s71, s71, 24576
buffer_load_dwordx4 v[200:203], v10, s[44:47], s71 offen
s_add_u32 s71, s71, 24576
buffer_load_dwordx4 v[204:207], v10, s[44:47], s71 offen
s_add_u32 s71, s71, 24576
v_mov_b64 v[16:17], 0
v_mov_b64 v[18:19], 0
v_mov_b64 v[20:21], 0
v_mov_b64 v[22:23], 0
s_waitcnt vmcnt(20)
v_dot2c_f32_bf16 v16, s74, v128
v_dot2c_f32_bf16 v17, s75, v128
v_dot2c_f32_bf16 v18, s74, v129
v_dot2c_f32_bf16 v19, s75, v129
v_dot2c_f32_bf16 v20, s74, v130
v_dot2c_f32_bf16 v21, s75, v130
v_dot2c_f32_bf16 v22, s74, v131
v_dot2c_f32_bf16 v23, s75, v131
s_waitcnt vmcnt(19)
v_dot2c_f32_bf16 v16, s74, v132
v_dot2c_f32_bf16 v17, s75, v132
v_dot2c_f32_bf16 v18, s74, v133
v_dot2c_f32_bf16 v19, s75, v133
v_dot2c_f32_bf16 v20, s74, v134
v_dot2c_f32_bf16 v21, s75, v134
v_dot2c_f32_bf16 v22, s74, v135
v_dot2c_f32_bf16 v23, s75, v135
s_waitcnt vmcnt(18)
v_dot2c_f32_bf16 v16, s74, v136
v_dot2c_f32_bf16 v17, s75, v136
v_dot2c_f32_bf16 v18, s74, v137
v_dot2c_f32_bf16 v19, s75, v137
v_dot2c_f32_bf16 v20, s74, v138
v_dot2c_f32_bf16 v21, s75, v138
v_dot2c_f32_bf16 v22, s74, v139
v_dot2c_f32_bf16 v23, s75, v139
s_waitcnt vmcnt(17)
v_dot2c_f32_bf16 v16, s74, v140
v_dot2c_f32_bf16 v17, s75, v140
v_dot2c_f32_bf16 v18, s74, v141
v_dot2c_f32_bf16 v19, s75, v141
v_dot2c_f32_bf16 v20, s74, v142
v_dot2c_f32_bf16 v21, s75, v142
v_dot2c_f32_bf16 v22, s74, v143
v_dot2c_f32_bf16 v23, s75, v143
s_waitcnt vmcnt(16)
v_dot2c_f32_bf16 v16, s74, v144
v_dot2c_f32_bf16 v17, s75, v144
v_dot2c_f32_bf16 v18, s74, v145
v_dot2c_f32_bf16 v19, s75, v145
v_dot2c_f32_bf16 v20, s74, v146
v_dot2c_f32_bf16 v21, s75, v146
v_dot2c_f32_bf16 v22, s74, v147
v_dot2c_f32_bf16 v23, s75, v147
s_waitcnt vmcnt(15)
v_dot2c_f32_bf16 v16, s74, v148
v_dot2c_f32_bf16 v17, s75, v148
v_dot2c_f32_bf16 v18, s74, v149
v_dot2c_f32_bf16 v19, s75, v149
v_dot2c_f32_bf16 v20, s74, v150
v_dot2c_f32_bf16 v21, s75, v150
v_dot2c_f32_bf16 v22, s74, v151
v_dot2c_f32_bf16 v23, s75, v151
s_waitcnt vmcnt(14)
v_dot2c_f32_bf16 v16, s74, v152
v_dot2c_f32_bf16 v17, s75, v152
v_dot2c_f32_bf16 v18, s74, v153
v_dot2c_f32_bf16 v19, s75, v153
v_dot2c_f32_bf16 v20, s74, v154
v_dot2c_f32_bf16 v21, s75, v154
v_dot2c_f32_bf16 v22, s74, v155
v_dot2c_f32_bf16 v23, s75, v155
s_waitcnt vmcnt(13)
v_dot2c_f32_bf16 v16, s74, v156
v_dot2c_f32_bf16 v17, s75, v156
v_dot2c_f32_bf16 v18, s74, v157
v_dot2c_f32_bf16 v19, s75, v157
v_dot2c_f32_bf16 v20, s74, v158
v_dot2c_f32_bf16 v21, s75, v158
v_dot2c_f32_bf16 v22, s74, v159
v_dot2c_f32_bf16 v23, s75, v159
s_waitcnt vmcnt(11)
v_dot2c_f32_bf16 v16, s74, v160
v_dot2c_f32_bf16 v17, s75, v160
v_dot2c_f32_bf16 v18, s74, v161
v_dot2c_f32_bf16 v19, s75, v161
v_dot2c_f32_bf16 v20, s74, v162
v_dot2c_f32_bf16 v21, s75, v162
v_dot2c_f32_bf16 v22, s74, v163
v_dot2c_f32_bf16 v23, s75, v163
s_waitcnt vmcnt(10)
v_dot2c_f32_bf16 v16, s74, v164
v_dot2c_f32_bf16 v17, s75, v164
v_dot2c_f32_bf16 v18, s74, v165
v_dot2c_f32_bf16 v19, s75, v165
v_dot2c_f32_bf16 v20, s74, v166
v_dot2c_f32_bf16 v21, s75, v166
v_dot2c_f32_bf16 v22, s74, v167
v_dot2c_f32_bf16 v23, s75, v167
s_waitcnt vmcnt(9)
v_dot2c_f32_bf16 v16, s74, v168
v_dot2c_f32_bf16 v17, s75, v168
v_dot2c_f32_bf16 v18, s74, v169
v_dot2c_f32_bf16 v19, s75, v169
v_dot2c_f32_bf16 v20, s74, v170
v_dot2c_f32_bf16 v21, s75, v170
v_dot2c_f32_bf16 v22, s74, v171
v_dot2c_f32_bf16 v23, s75, v171
s_waitcnt vmcnt(8)
v_dot2c_f32_bf16 v16, s74, v172
v_dot2c_f32_bf16 v17, s75, v172
v_dot2c_f32_bf16 v18, s74, v173
v_dot2c_f32_bf16 v19, s75, v173
v_dot2c_f32_bf16 v20, s74, v174
v_dot2c_f32_bf16 v21, s75, v174
v_dot2c_f32_bf16 v22, s74, v175
v_dot2c_f32_bf16 v23, s75, v175
s_waitcnt vmcnt(7)
v_dot2c_f32_bf16 v16, s74, v176
v_dot2c_f32_bf16 v17, s75, v176
v_dot2c_f32_bf16 v18, s74, v177
v_dot2c_f32_bf16 v19, s75, v177
v_dot2c_f32_bf16 v20, s74, v178
v_dot2c_f32_bf16 v21, s75, v178
v_dot2c_f32_bf16 v22, s74, v179
v_dot2c_f32_bf16 v23, s75, v179
s_waitcnt vmcnt(6)
v_dot2c_f32_bf16 v16, s74, v180
v_dot2c_f32_bf16 v17, s75, v180
v_dot2c_f32_bf16 v18, s74, v181
v_dot2c_f32_bf16 v19, s75, v181
v_dot2c_f32_bf16 v20, s74, v182
v_dot2c_f32_bf16 v21, s75, v182
v_dot2c_f32_bf16 v22, s74, v183
v_dot2c_f32_bf16 v23, s75, v183
s_waitcnt vmcnt(5)
v_dot2c_f32_bf16 v16, s74, v184
v_dot2c_f32_bf16 v17, s75, v184
v_dot2c_f32_bf16 v18, s74, v185
v_dot2c_f32_bf16 v19, s75, v185
v_dot2c_f32_bf16 v20, s74, v186
v_dot2c_f32_bf16 v21, s75, v186
v_dot2c_f32_bf16 v22, s74, v187
v_dot2c_f32_bf16 v23, s75, v187
s_waitcnt vmcnt(4)
v_dot2c_f32_bf16 v16, s74, v188
v_dot2c_f32_bf16 v17, s75, v188
v_dot2c_f32_bf16 v18, s74, v189
v_dot2c_f32_bf16 v19, s75, v189
v_dot2c_f32_bf16 v20, s74, v190
v_dot2c_f32_bf16 v21, s75, v190
v_dot2c_f32_bf16 v22, s74, v191
v_dot2c_f32_bf16 v23, s75, v191
s_waitcnt vmcnt(3)
v_dot2c_f32_bf16 v16, s74, v192
v_dot2c_f32_bf16 v17, s75, v192
v_dot2c_f32_bf16 v18, s74, v193
v_dot2c_f32_bf16 v19, s75, v193
v_dot2c_f32_bf16 v20, s74, v194
v_dot2c_f32_bf16 v21, s75, v194
v_dot2c_f32_bf16 v22, s74, v195
v_dot2c_f32_bf16 v23, s75, v195
s_waitcnt vmcnt(2)
v_dot2c_f32_bf16 v16, s74, v196
v_dot2c_f32_bf16 v17, s75, v196
v_dot2c_f32_bf16 v18, s74, v197
v_dot2c_f32_bf16 v19, s75, v197
v_dot2c_f32_bf16 v20, s74, v198
v_dot2c_f32_bf16 v21, s75, v198
v_dot2c_f32_bf16 v22, s74, v199
v_dot2c_f32_bf16 v23, s75, v199
s_waitcnt vmcnt(1)
v_dot2c_f32_bf16 v16, s74, v200
v_dot2c_f32_bf16 v17, s75, v200
v_dot2c_f32_bf16 v18, s74, v201
v_dot2c_f32_bf16 v19, s75, v201
v_dot2c_f32_bf16 v20, s74, v202
v_dot2c_f32_bf16 v21, s75, v202
v_dot2c_f32_bf16 v22, s74, v203
v_dot2c_f32_bf16 v23, s75, v203
s_waitcnt vmcnt(0)
v_dot2c_f32_bf16 v16, s74, v204
v_dot2c_f32_bf16 v17, s75, v204
v_dot2c_f32_bf16 v18, s74, v205
v_dot2c_f32_bf16 v19, s75, v205
v_dot2c_f32_bf16 v20, s74, v206
v_dot2c_f32_bf16 v21, s75, v206
v_dot2c_f32_bf16 v22, s74, v207
v_dot2c_f32_bf16 v23, s75, v207
s_lshl_b32 s11, s3, 11
v_lshl_add_u32 v11, v1, 5, s11
ds_write_b128 v11, v[16:19]
ds_write_b128 v11, v[20:23] offset:16
v_lshlrev_b32 v12, 2, v1
s_lshl_b32 s12, s77, 8
s_add_u32 s12, s12, 21626880
s_cmp_lg_u32 s3, 0
s_cselect_b32 s12, 2130706432, s12
s_waitcnt lgkmcnt(0)
s_barrier
ds_read_b32 v128, v12 offset:0
ds_read_b32 v129, v12 offset:256
ds_read_b32 v130, v12 offset:512
ds_read_b32 v131, v12 offset:768
ds_read_b32 v132, v12 offset:1024
ds_read_b32 v133, v12 offset:1280
ds_read_b32 v134, v12 offset:1536
ds_read_b32 v135, v12 offset:1792
ds_read_b32 v136, v12 offset:2048
ds_read_b32 v137, v12 offset:2304
ds_read_b32 v138, v12 offset:2560
ds_read_b32 v139, v12 offset:2816
ds_read_b32 v140, v12 offset:3072
ds_read_b32 v141, v12 offset:3328
ds_read_b32 v142, v12 offset:3584
ds_read_b32 v143, v12 offset:3840
ds_read_b32 v144, v12 offset:4096
ds_read_b32 v145, v12 offset:4352
ds_read_b32 v146, v12 offset:4608
ds_read_b32 v147, v12 offset:4864
ds_read_b32 v148, v12 offset:5120
ds_read_b32 v149, v12 offset:5376
ds_read_b32 v150, v12 offset:5632
ds_read_b32 v151, v12 offset:5888
ds_read_b32 v152, v12 offset:6144
ds_read_b32 v153, v12 offset:6400
ds_read_b32 v154, v12 offset:6656
ds_read_b32 v155, v12 offset:6912
ds_read_b32 v156, v12 offset:7168
ds_read_b32 v157, v12 offset:7424
ds_read_b32 v158, v12 offset:7680
ds_read_b32 v159, v12 offset:7936
s_waitcnt lgkmcnt(0)
s_barrier
v_pk_add_f32 v[128:129], v[128:129], v[144:145]
v_pk_add_f32 v[130:131], v[130:131], v[146:147]
v_pk_add_f32 v[132:133], v[132:133], v[148:149]
v_pk_add_f32 v[134:135], v[134:135], v[150:151]
v_pk_add_f32 v[136:137], v[136:137], v[152:153]
v_pk_add_f32 v[138:139], v[138:139], v[154:155]
v_pk_add_f32 v[140:141], v[140:141], v[156:157]
v_pk_add_f32 v[142:143], v[142:143], v[158:159]
v_pk_add_f32 v[128:129], v[128:129], v[136:137]
v_pk_add_f32 v[130:131], v[130:131], v[138:139]
v_pk_add_f32 v[132:133], v[132:133], v[140:141]
v_pk_add_f32 v[134:135], v[134:135], v[142:143]
v_pk_add_f32 v[128:129], v[128:129], v[132:133]
v_pk_add_f32 v[130:131], v[130:131], v[134:135]
v_pk_add_f32 v[128:129], v[128:129], v[130:131]
v_add_f32 v16, v128, v129
v_cvt_pk_bf16_f32 v18, v16, v16
v_and_b32 v17, 0xffff0000, v18
v_sub_f32 v17, v16, v17
v_cvt_pk_bf16_f32 v18, v16, v17
v_mov_b32 v19, v18
buffer_store_dword v18, v12, s[48:51], s12 offen sc1
v_min_u32 v248, 49, v1
v_mul_u32_u24 v249, 52, v248
v_lshrrev_b32 v249, 8, v249
v_mul_u32_u24 v249, 1792, v249
v_lshl_add_u32 v13, v248, 8, v249
s_lshl_b32 s11, s63, 2
s_add_u32 s11, s11, s3
s_mul_i32 s11, s11, 122880
s_mul_i32 s12, s4, 1536
s_add_u32 s11, s11, s12
buffer_load_dword a98, v13, s[44:47], s11 offen offset:128
s_waitcnt vmcnt(1)
s_mov_b64 exec, 0xffff
buffer_store_dwordx2 v[252:253], v254, s[48:51], s73 offen sc1
s_mov_b64 exec, -1
s_add_u32 s11, s11, 30720
buffer_load_dword a98, v13, s[44:47], s11 offen offset:128
s_add_u32 s11, s11, 30720
buffer_load_dword a98, v13, s[44:47], s11 offen offset:128
s_add_u32 s11, s11, 30720
buffer_load_dword a98, v13, s[44:47], s11 offen offset:128
s_lshl_b32 s11, s5, 2
s_add_u32 s11, s11, s63
s_lshl_b32 s62, s11, 2
s_add_u32 s62, s62, s3
s_mul_i32 s63, s4, 6
s_add_u32 s63, s63, 5
s_lshl_b32 s11, s62, 12
s_lshl_b32 s12, s63, 8
s_add_u32 s11, s11, s12
s_add_u32 s11, s11, 22413312
v_and_b32 v248, 31, v1
v_lshlrev_b32 v248, 3, v248
s_sub_u32 s14, s11, s11
v_mul_lo_u32 v249, v2, s14
v_mov_b64 v[250:251], 0
v_add_u32 v248, v248, v249
buffer_store_dwordx2 v[250:251], v248, s[48:51], s11 offen sc1
s_mov_b32 s72, 2130706432
s_mov_b32 s52, s28
s_mov_b32 s53, s29
s_mov_b32 s54, 1966080
s_lshl_b32 s99, s3, 12
v_lshrrev_b32 v248, 3, v1
v_mul_u32_u24 v248, 3072, v248
v_lshrrev_b32 v249, 2, v1
v_and_b32 v249, 4, v249
v_and_b32 v250, 7, v1
v_xor_b32 v249, v249, v250
v_lshl_add_u32 v120, v249, 4, v248
v_add_u32 v121, 23552, v120
v_add_u32 v122, 47104, v120
v_add_u32 v123, 70656, v120
s_lshl_b32 s14, s63, 8
s_lshl_b32 s11, s3, 5
s_lshl_b32 s12, s64, 6
s_add_u32 s12, s12, s11
s_add_u32 s11, s12, 0
s_cmp_ge_u32 s11, 640
s_cselect_b32 s13, 640, 0
s_sub_u32 s11, s11, s13
s_mul_i32 s11, s11, 3072
s_add_u32 s93, s11, s14
s_add_u32 s11, s12, 128
s_cmp_ge_u32 s11, 640
s_cselect_b32 s13, 640, 0
s_sub_u32 s11, s11, s13
s_mul_i32 s11, s11, 3072
s_add_u32 s94, s11, s14
s_add_u32 s11, s12, 256
s_cmp_ge_u32 s11, 640
s_cselect_b32 s13, 640, 0
s_sub_u32 s11, s11, s13
s_mul_i32 s11, s11, 3072
s_add_u32 s95, s11, s14
s_add_u32 s11, s12, 384
s_cmp_ge_u32 s11, 640
s_cselect_b32 s13, 640, 0
s_sub_u32 s11, s11, s13
s_mul_i32 s11, s11, 3072
s_add_u32 s96, s11, s14
s_add_u32 s11, s12, 512
s_cmp_ge_u32 s11, 640
s_cselect_b32 s13, 640, 0
s_sub_u32 s11, s11, s13
s_mul_i32 s11, s11, 3072
s_add_u32 s97, s11, s14
s_add_u32 m0, s99, 81920
s_nop 0
buffer_load_dwordx4 v120, s[52:55], s93 offen offset:0 lds
buffer_load_dwordx4 v121, s[52:55], s93 offen offset:1024 lds
buffer_load_dwordx4 v122, s[52:55], s93 offen offset:2048 lds
buffer_load_dwordx4 v123, s[52:55], s93 offen offset:3072 lds
s_add_u32 m0, s99, 98304
s_nop 0
buffer_load_dwordx4 v120, s[52:55], s94 offen offset:0 lds
buffer_load_dwordx4 v121, s[52:55], s94 offen offset:1024 lds
buffer_load_dwordx4 v122, s[52:55], s94 offen offset:2048 lds
buffer_load_dwordx4 v123, s[52:55], s94 offen offset:3072 lds
s_add_u32 m0, s99, 114688
s_nop 0
buffer_load_dwordx4 v120, s[52:55], s95 offen offset:0 lds
buffer_load_dwordx4 v121, s[52:55], s95 offen offset:1024 lds
buffer_load_dwordx4 v122, s[52:55], s95 offen offset:2048 lds
buffer_load_dwordx4 v123, s[52:55], s95 offen offset:3072 lds
s_add_u32 m0, s99, 131072
s_nop 0
buffer_load_dwordx4 v120, s[52:55], s96 offen offset:0 lds
buffer_load_dwordx4 v121, s[52:55], s96 offen offset:1024 lds
buffer_load_dwordx4 v122, s[52:55], s96 offen offset:2048 lds
buffer_load_dwordx4 v123, s[52:55], s96 offen offset:3072 lds
s_add_u32 m0, s99, 147456
s_nop 0
buffer_load_dwordx4 v120, s[52:55], s97 offen offset:0 lds
buffer_load_dwordx4 v121, s[52:55], s97 offen offset:1024 lds
buffer_load_dwordx4 v122, s[52:55], s97 offen offset:2048 lds
buffer_load_dwordx4 v123, s[52:55], s97 offen offset:3072 lds
s_add_u32 s78, s93, 128
s_add_u32 s79, s94, 128
s_add_u32 s80, s95, 128
s_add_u32 s81, s96, 128
s_add_u32 s82, s97, 128
s_add_u32 m0, s99, 0
s_nop 0
buffer_load_dwordx4 v120, s[52:55], s78 offen offset:0 lds
buffer_load_dwordx4 v121, s[52:55], s78 offen offset:1024 lds
buffer_load_dwordx4 v122, s[52:55], s78 offen offset:2048 lds
buffer_load_dwordx4 v123, s[52:55], s78 offen offset:3072 lds
s_add_u32 m0, s99, 16384
s_nop 0
buffer_load_dwordx4 v120, s[52:55], s79 offen offset:0 lds
buffer_load_dwordx4 v121, s[52:55], s79 offen offset:1024 lds
buffer_load_dwordx4 v122, s[52:55], s79 offen offset:2048 lds
buffer_load_dwordx4 v123, s[52:55], s79 offen offset:3072 lds
s_add_u32 m0, s99, 32768
s_nop 0
buffer_load_dwordx4 v120, s[52:55], s80 offen offset:0 lds
buffer_load_dwordx4 v121, s[52:55], s80 offen offset:1024 lds
buffer_load_dwordx4 v122, s[52:55], s80 offen offset:2048 lds
buffer_load_dwordx4 v123, s[52:55], s80 offen offset:3072 lds
s_add_u32 m0, s99, 49152
s_nop 0
buffer_load_dwordx4 v120, s[52:55], s81 offen offset:0 lds
buffer_load_dwordx4 v121, s[52:55], s81 offen offset:1024 lds
buffer_load_dwordx4 v122, s[52:55], s81 offen offset:2048 lds
buffer_load_dwordx4 v123, s[52:55], s81 offen offset:3072 lds
s_add_u32 m0, s99, 65536
s_nop 0
buffer_load_dwordx4 v120, s[52:55], s82 offen offset:0 lds
buffer_load_dwordx4 v121, s[52:55], s82 offen offset:1024 lds
buffer_load_dwordx4 v122, s[52:55], s82 offen offset:2048 lds
buffer_load_dwordx4 v123, s[52:55], s82 offen offset:3072 lds
s_lshl_b32 s83, s64, 12
s_add_u32 s84, s83, 4096
s_cmp_eq_u32 s84, 40960
s_cselect_b32 s84, 0, s84
s_add_u32 s85, s84, 4096
s_cmp_eq_u32 s85, 40960
s_cselect_b32 s85, 0, s85
s_add_u32 s86, s85, 4096
s_cmp_eq_u32 s86, 40960
s_cselect_b32 s86, 0, s86
s_add_u32 s87, s86, 4096
s_cmp_eq_u32 s87, 40960
s_cselect_b32 s87, 0, s87
s_add_u32 s88, s87, 4096
s_cmp_eq_u32 s88, 40960
s_cselect_b32 s88, 0, s88
s_add_u32 s89, s88, 4096
s_cmp_eq_u32 s89, 40960
s_cselect_b32 s89, 0, s89
s_add_u32 s90, s89, 4096
s_cmp_eq_u32 s90, 40960
s_cselect_b32 s90, 0, s90
s_add_u32 s91, s90, 4096
s_cmp_eq_u32 s91, 40960
s_cselect_b32 s91, 0, s91
s_add_u32 s92, s91, 4096
s_cmp_eq_u32 s92, 40960
s_cselect_b32 s92, 0, s92
s_add_u32 s83, s83, 5242880
s_add_u32 s84, s84, 5242880
s_add_u32 s85, s85, 5242880
s_add_u32 s86, s86, 5242880
s_add_u32 s87, s87, 5242880
s_add_u32 s88, s88, 5242880
s_add_u32 s89, s89, 5242880
s_add_u32 s90, s90, 5242880
s_add_u32 s91, s91, 5242880
s_add_u32 s92, s92, 5242880
s_mul_i32 s68, s62, 40960
v_lshl_add_u32 v8, v1, 4, s68
v_lshlrev_b32 v11, 2, v3
v_and_b32 v248, 15, v1
v_lshrrev_b32 v249, 2, v248
v_and_b32 v248, 3, v248
v_lshlrev_b32 v248, 3, v248
v_and_b32 v250, 16, v1
v_lshl_add_u32 v248, v250, 1, v248
v_mad_u32_u24 v250, v2, 4, v249
v_lshl_add_u32 v248, v250, 7, v248
v_lshrrev_b32 v249, 1, v249
v_lshl_add_u32 v248, v249, 6, v248
v_add_u32 v16, 81920, v248
v_xor_b32 v17, 64, v16
v_add_u32 v18, 65536, v16
v_add_u32 v19, 65536, v17
s_lshr_b32 s13, s6, 2
s_lshl_b32 s25, s5, 3
s_add_u32 s25, s25, s13
s_and_b32 s11, s6, 3
s_lshl_b32 s24, s4, 2
s_add_u32 s24, s24, s11
s_mul_i32 s22, s3, 491520
s_add_u32 s22, s22, 16777216
s_mul_i32 s31, s3, 204800
s_add_u32 s31, s31, 18743296
s_mul_i32 s65, s3, 20480
s_add_u32 s65, s65, 81920
s_mul_i32 s11, s11, 3
s_add_u32 s11, s11, 1
s_lshr_b32 s11, s11, 1
s_add_u32 s11, s11, s13
s_mul_i32 s12, s11, 52
s_lshr_b32 s12, s12, 8
s_mul_i32 s12, s12, 5
s_sub_u32 s30, s11, s12
s_mul_i32 s12, s11, 43
s_lshr_b32 s12, s12, 8
s_mul_i32 s12, s12, 6
s_sub_u32 s11, s11, s12
s_and_b32 s12, s11, 6
s_add_u32 s12, s12, s11
s_lshl_b32 s0, s12, 11
s_add_u32 s11, s11, 1
s_cmp_eq_u32 s11, 6
s_cselect_b32 s11, 0, s11
s_and_b32 s12, s11, 6
s_add_u32 s12, s12, s11
s_lshl_b32 s1, s12, 11
s_add_u32 s11, s11, 1
s_cmp_eq_u32 s11, 6
s_cselect_b32 s11, 0, s11
s_and_b32 s12, s11, 6
s_add_u32 s12, s12, s11
s_lshl_b32 s18, s12, 11
s_add_u32 s11, s11, 1
s_cmp_eq_u32 s11, 6
s_cselect_b32 s11, 0, s11
s_and_b32 s12, s11, 6
s_add_u32 s12, s12, s11
s_lshl_b32 s19, s12, 11
s_add_u32 s11, s11, 1
s_cmp_eq_u32 s11, 6
s_cselect_b32 s11, 0, s11
s_and_b32 s12, s11, 6
s_add_u32 s12, s12, s11
s_lshl_b32 s20, s12, 11
s_add_u32 s11, s11, 1
s_cmp_eq_u32 s11, 6
s_cselect_b32 s11, 0, s11
s_and_b32 s12, s11, 6
s_add_u32 s12, s12, s11
s_lshl_b32 s21, s12, 11
s_mul_i32 s23, s24, 5120
v_lshl_add_u32 v22, v1, 4, s23
v_add_u32 v23, 4096, v22
s_lshl_b32 s73, s30, 11
s_add_u32 s74, s73, 2048
s_cmp_eq_u32 s74, 10240
s_cselect_b32 s74, 0, s74
s_add_u32 s75, s74, 2048
s_cmp_eq_u32 s75, 10240
s_cselect_b32 s75, 0, s75
s_add_u32 s76, s75, 2048
s_cmp_eq_u32 s76, 10240
s_cselect_b32 s76, 0, s76
s_add_u32 s77, s76, 2048
s_cmp_eq_u32 s77, 10240
s_cselect_b32 s77, 0, s77
v_lshlrev_b32 v9, 7, v3
s_mov_b32 s15, 22740992
s_mov_b32 s10, 0x20000
L_poll15:
buffer_load_dwordx2 v[248:249], v9, s[48:51], s15 offen sc1
s_sub_u32 s10, s10, 1
s_waitcnt vmcnt(0)
s_cbranch_scc1 L_poll15x
v_cmp_ne_u64 vcc, s[8:9], v[248:249]
s_cbranch_vccnz L_poll15
L_poll15x:
s_mul_i32 s23, s0, 20
s_add_u32 s23, s23, s22
buffer_load_dwordx4 a[160:163], v22, s[48:51], s23 offen offset:0 sc1
buffer_load_dwordx4 a[164:167], v22, s[48:51], s23 offen offset:1024 sc1
buffer_load_dwordx4 a[168:171], v22, s[48:51], s23 offen offset:2048 sc1
buffer_load_dwordx4 a[172:175], v22, s[48:51], s23 offen offset:3072 sc1
buffer_load_dwordx4 a[176:179], v23, s[48:51], s23 offen offset:0 sc1
s_mul_i32 s23, s1, 20
s_add_u32 s23, s23, s22
buffer_load_dwordx4 a[180:183], v22, s[48:51], s23 offen offset:0 sc1
buffer_load_dwordx4 a[184:187], v22, s[48:51], s23 offen offset:1024 sc1
buffer_load_dwordx4 a[188:191], v22, s[48:51], s23 offen offset:2048 sc1
v_and_b32 v249, 15, v1
v_min_u32 v249, 9, v249
s_lshl_b32 s15, s62, 12
v_lshl_add_u32 v9, v249, 8, s15
s_mov_b32 s15, 22151296
buffer_load_dwordx2 v[20:21], v9, s[48:51], s15 offen sc1
s_waitcnt vmcnt(0)
s_branch L_b3
L_fin:
L_end:
s_endpgm
.section .rodata,"a"
.p2align 6
.amdhsa_kernel parallel_sum__linear_attn_block__mixer_s_mlp__prompt_kernel
  .amdhsa_next_free_vgpr 512
  .amdhsa_next_free_sgpr 102
  .amdhsa_accum_offset 256
  .amdhsa_group_segment_fixed_size 0
  .amdhsa_kernarg_size 88
  .amdhsa_user_sgpr_count 2
  .amdhsa_user_sgpr_kernarg_segment_ptr 1
  .amdhsa_system_sgpr_workgroup_id_x 1
.end_amdhsa_kernel
```
